```python
import torch

def _softmax(x, axis=-1):
    return torch.softmax(x, dim=axis)
def _gelu(x):
    return torch.nn.functional.gelu(x, approximate="tanh")
def _silu(x):
    return torch.nn.functional.silu(x)
def _sigmoid(x):
    return torch.sigmoid(x)
def _layernorm(x, axis=-1, eps=1e-5):
    m = x.mean(dim=axis, keepdim=True)
    v = x.var(dim=axis, keepdim=True, unbiased=False)
    return (x - m) / torch.sqrt(v + eps)
def _scatter_add(tgt, idx, src, axis=0):
    return tgt.clone().index_add_(axis, idx, src)
def _segment_sum(src, seg, n):
    out = torch.zeros((n,) + src.shape[1:], dtype=src.dtype)
    return out.index_add_(0, seg, src)
def _pad(x, pw):
    flat = tuple(v for pair in reversed(pw) for v in pair)
    return torch.nn.functional.pad(x, flat)

kernel_name = 'interleave_layers__sliding_block__glu_gated_glu__prompt'

def setup_inputs():

    _w = (lambda a: (lambda t: t.to(torch.bfloat16) if t.is_floating_point() else t)(torch.as_tensor(a)))
    def _A_setup():
        B, S, D = 1, 2048, 512
        return {
            "x": _w((lambda *s: torch.randn(*s, dtype=torch.bfloat16) * 0.05)(B, S, D)),
            "wqkv": _w((lambda *s: torch.randn(*s, dtype=torch.bfloat16) * 0.05)(D, 3 * D)),
            "wo": _w((lambda *s: torch.randn(*s, dtype=torch.bfloat16) * 0.05)(D, D)),
        }
    _A_in = _A_setup()

    def _B_setup():
        B, S, D, F = 1, 2048, 512, 1792
        return {
            "x": _w((lambda *s: torch.randn(*s, dtype=torch.bfloat16) * 0.05)(B, S, D)),
            "w_gate": _w((lambda *s: torch.randn(*s, dtype=torch.bfloat16) * 0.05)(D, F)),
            "w_up": _w((lambda *s: torch.randn(*s, dtype=torch.bfloat16) * 0.05)(D, F)),
            "w_down": _w((lambda *s: torch.randn(*s, dtype=torch.bfloat16) * 0.05)(F, D)),
        }
    _B_in = _B_setup()

    return {
        "A_x": _A_in["x"],
        "A_wqkv": _A_in["wqkv"],
        "A_wo": _A_in["wo"],
        "B_x": _B_in["x"],
        "B_w_gate": _B_in["w_gate"],
        "B_w_up": _B_in["w_up"],
        "B_w_down": _B_in["w_down"],
    }

def reference(A_x, A_wqkv, A_wo, B_x, B_w_gate, B_w_up, B_w_down):
    def _A_ref(x, wqkv, wo):
        B, S, D = x.shape
        H = 32; Dh = D // H; W = 256
        qkv = (lambda x, *d: x.permute(*d))((x @ wqkv).reshape(B, S, 3, H, Dh), 2, 0, 3, 1, 4)
        q, k, v = qkv[0], qkv[1], qkv[2]
        scores = torch.einsum("bhqd,bhkd->bhqk", q, k) * (Dh ** -0.5)
        idx = torch.arange(S)
        mask = (idx[:, None] - idx[None, :] >= 0) & (idx[:, None] - idx[None, :] < W)
        scores = torch.where(mask[None, None], scores, -1e9)
        p = _softmax(scores, axis=-1)
        o = torch.einsum("bhqk,bhkd->bhqd", p, v)
        return (lambda x, *d: x.permute(*d))(o, 0, 2, 1, 3).reshape(B, S, D) @ wo

    def _B_ref(x, w_gate, w_up, w_down):
        g = torch.einsum("bsd,df->bsf", x, w_gate)
        u = torch.einsum("bsd,df->bsf", x, w_up)
        h = _sigmoid(g) * u
        return torch.einsum("bsf,fd->bsd", h, w_down)

    x = A_x
    x = x + _A_ref(_layernorm(x, axis=-1), A_wqkv, A_wo)
    x = x + _B_ref(_layernorm(x, axis=-1), B_w_gate, B_w_up, B_w_down)
    x = x + _A_ref(_layernorm(x, axis=-1), A_wqkv, A_wo)
    x = x + _B_ref(_layernorm(x, axis=-1), B_w_gate, B_w_up, B_w_down)
    return x
```

```asm
; @launch grid=(256,1,1) block=(512,1,1) lds=163840
.amdgcn_target "amdgcn-amd-amdhsa--gfx950"
.text
.globl interleave_layers__sliding_block__glu_gated_glu__prompt_kernel
.p2align 8
.type interleave_layers__sliding_block__glu_gated_glu__prompt_kernel,@function
interleave_layers__sliding_block__glu_gated_glu__prompt_kernel:
    s_cmp_ge_u32 s2, 256
    s_cbranch_scc1 L_end
    s_load_dwordx4 s[64:67], s[0:1], 0
    s_load_dwordx2 s[8:9], s[0:1], 72
    s_load_dwordx2 s[68:69], s[0:1], 16
    s_load_dwordx8 s[72:79], s[0:1], 32
    s_load_dwordx2 s[70:71], s[0:1], 64
    v_lshrrev_b32 v1, 6, v0
    v_and_b32 v2, 63, v0
    v_readfirstlane_b32 s3, v1
    s_getpc_b64 s[42:43]
L_pc:
    s_sub_u32 s42, s42, L_pc-interleave_layers__sliding_block__glu_gated_glu__prompt_kernel
    s_subb_u32 s43, s43, 0
    s_lshr_b32 s40, s2, 3
    s_lshl_b32 s40, s40, 11
    v_lshlrev_b32 v10, 7, v2
    v_add_u32 v10, s40, v10
    v_min_u32 v10, L_code_end-interleave_layers__sliding_block__glu_gated_glu__prompt_kernel-4, v10
    v_mov_b32 v11, s43
    v_add_co_u32 v10, vcc, s42, v10
    s_nop 1
    v_addc_co_u32 v11, vcc, 0, v11, vcc
    s_cmp_lg_u32 s3, 6
    s_cbranch_scc1 L_nopf
    s_mov_b64 exec, 0xffff
    global_load_dword v31, v[10:11], off
    s_mov_b64 exec, -1
L_nopf:
    s_mov_b32 s10, 268435456
    s_mov_b32 s11, 0x20000
    v_lshlrev_b32 v3, 4, v2
    s_and_b32 s4, s2, 7
    s_lshr_b32 s5, s2, 3
    s_and_b32 s6, s3, 3
    s_lshl_b32 s16, s4, 1
    s_lshr_b32 s40, s5, 4
    s_add_u32 s16, s16, s40
    s_and_b32 s17, s5, 15
    s_lshr_b32 s18, s17, 3
    s_and_b32 s19, s17, 7
    s_mov_b32 s20, 0x3f803f80
    s_mov_b32 s21, 0
    s_mov_b32 s22, 0
    s_mov_b32 s23, 0
    s_lshl_b32 s26, s16, 9
    s_add_u32 s26, s26, 1703936
    s_lshl_b32 s24, s17, 5
    s_lshl_b32 s40, s3, 2
    s_add_u32 s24, s24, s40
    s_add_u32 s24, s24, s26
    s_lshl_b32 s25, s6, 10
    s_lshl_b32 s27, s16, 2
    s_add_u32 s27, s27, s6
    s_add_u32 s28, s16, s17
    s_lshl_b32 s28, s28, 2
    s_and_b32 s28, s28, 31
    s_mov_b32 s35, 0
    s_mov_b32 s36, 0
    s_xor_b32 s40, s3, 4
    s_lshl_b32 s40, s40, 2
    s_add_u32 s40, s40, 163456
    v_lshlrev_b32 v0, 2, v2
    v_add_u32 v0, 163584, v0
    v_writelane_b32 v0, s40, 0
    v_mov_b32 v9, 0
    s_mov_b32 s7, 0
    s_mov_b32 s38, 0
    ds_write_b32 v0, v9
    s_waitcnt lgkmcnt(0)
    s_barrier
    s_cmp_ge_u32 s3, 4
    s_cbranch_scc1 L_helper
    s_setprio 2
    v_and_b32 v104, 31, v2
    v_lshrrev_b32 v105, 5, v2
    v_lshlrev_b32 v8, 10, v104
    v_lshl_add_u32 v8, v105, 4, v8
    s_lshl_b32 s55, s27, 15
    s_mov_b32 s46, 2097152
    s_mov_b32 s47, 0x20000
    v_lshrrev_b32 v79, 4, v2
    v_and_b32 v76, 7, v2
    v_xor_b32 v76, v79, v76
    v_lshlrev_b32 v76, 4, v76
    v_lshrrev_b32 v79, 3, v2
    v_lshl_add_u32 v76, v79, 10, v76
    v_xor_b32 v77, 64, v76
    s_lshl_b32 s42, s6, 12
    s_waitcnt lgkmcnt(0)
    s_mov_b64 s[44:45], s[64:65]
    s_add_u32 s41, s28, 0
    s_and_b32 s41, s41, 31
    s_lshl_b32 s41, s41, 5
    s_add_u32 s41, s41, s55
    s_add_u32 s40, s41, 0
    s_add_u32 m0, s42, 98304
    s_nop 0
    buffer_load_dwordx4 v76, s[44:47], s40 offen lds
    s_add_u32 s40, s41, 8192
    s_add_u32 m0, s42, 99328
    s_nop 0
    buffer_load_dwordx4 v77, s[44:47], s40 offen lds
    s_add_u32 s40, s41, 16384
    s_add_u32 m0, s42, 100352
    s_nop 0
    buffer_load_dwordx4 v76, s[44:47], s40 offen lds
    s_add_u32 s40, s41, 24576
    s_add_u32 m0, s42, 101376
    s_nop 0
    buffer_load_dwordx4 v77, s[44:47], s40 offen lds
    s_mov_b32 s14, 2097152
    s_mov_b32 s15, 0x20000
    s_lshr_b32 s50, s6, 1
    s_and_b32 s51, s6, 1
    s_lshl_b32 s48, s18, 1
    s_add_u32 s48, s48, s50
    s_mov_b32 s52, s48
    s_lshl_b32 s40, s16, 2
    s_add_u32 s48, s48, s40
    s_lshl_b32 s49, s19, 1
    s_add_u32 s49, s49, s51
    s_lshl_b32 s53, s48, 15
    s_lshl_b32 s40, s49, 11
    s_add_u32 s53, s53, s40
    s_lshl_b32 s54, s48, 12
    s_lshr_b32 s40, s49, 2
    s_lshl_b32 s40, s40, 10
    s_add_u32 s54, s54, s40
    s_and_b32 s40, s49, 3
    s_lshl_b32 s40, s40, 2
    s_add_u32 s54, s54, s40
    v_mov_b32 v4, v3
    v_add_u32 v5, 0x10000, v3
    v_lshrrev_b32 v106, 5, v2
    v_lshlrev_b32 v6, 9, v106
    v_bfe_u32 v106, v2, 2, 2
    v_lshl_add_u32 v6, v106, 6, v6
    v_bfe_u32 v106, v2, 4, 1
    v_lshl_add_u32 v6, v106, 5, v6
    v_and_b32 v106, 1, v2
    v_lshl_add_u32 v6, v106, 4, v6
    v_bfe_u32 v106, v2, 1, 1
    v_lshl_add_u32 v6, v106, 3, v6
    v_add_u32 v7, 0x10000, v6
    v_lshlrev_b32 v32, 10, v105
    v_bfe_u32 v106, v2, 2, 2
    v_lshl_add_u32 v32, v106, 7, v32
    v_bfe_u32 v106, v2, 3, 1
    v_xor_b32 v106, s51, v106
    v_lshl_add_u32 v32, v106, 6, v32
    v_and_b32 v106, 63, v6
    v_add_u32 v32, v106, v32
    s_lshl_b32 s40, s51, 11
    v_add_u32 v32, s40, v32
    v_add_u32 v33, 0x10000, v32
    v_add_u32 v34, 0x20000, v32
    v_bfe_u32 v106, v2, 1, 3
    v_and_b32 v107, 1, v2
    v_and_b32 v108, 7, v2
    s_lshl_b32 s40, s50, 8
    s_lshl_b32 s41, s51, 3
    s_add_u32 s40, s40, s41
    v_lshlrev_b32 v20, 5, v106
    v_lshl_add_u32 v20, v107, 2, v20
    v_add_u32 v20, s40, v20
    s_lshl_b32 s40, s51, 8
    s_lshl_b32 s41, s52, 2
    s_add_u32 s40, s40, s41
    v_lshlrev_b32 v21, 5, v108
    v_add_u32 v21, s40, v21
    v_lshlrev_b32 v22, 3, v104
    v_add_u32 v22, 160512, v22
    v_mov_b32 v18, 0
    v_mov_b32 v19, 0
    v_cmp_gt_u32 s[62:63], 32, v2
    v_lshlrev_b32 v106, 3, v105
    v_sub_u32 v106, v104, v106
    s_mov_b64 s[12:13], s[78:79]
    v_cmp_le_i32 s[64:65], 0, v106
    v_cmp_le_i32 s[66:67], 1, v106
    v_cmp_le_i32 s[68:69], 2, v106
    v_cmp_le_i32 s[70:71], 3, v106
    v_cmp_le_i32 s[72:73], 4, v106
    v_cmp_le_i32 s[74:75], 5, v106
    v_cmp_le_i32 s[76:77], 6, v106
    v_cmp_le_i32 s[78:79], 7, v106
    v_cmp_le_i32 s[80:81], 16, v106
    v_cmp_le_i32 s[82:83], 17, v106
    v_cmp_le_i32 s[84:85], 18, v106
    v_cmp_le_i32 s[86:87], 19, v106
    v_cmp_le_i32 s[88:89], 20, v106
    v_cmp_le_i32 s[90:91], 21, v106
    v_cmp_le_i32 s[92:93], 22, v106
    v_cmp_le_i32 s[94:95], 23, v106
    v_and_b32 v35, 3, v2
    v_lshlrev_b32 v35, 2, v35
    v_add_u32 v35, 163456, v35
    s_add_u32 s41, s28, 4
    s_and_b32 s41, s41, 31
    s_lshl_b32 s41, s41, 5
    s_add_u32 s41, s41, s55
    s_add_u32 s40, s41, 0
    s_add_u32 m0, s42, 114688
    s_nop 0
    buffer_load_dwordx4 v76, s[44:47], s40 offen lds
    s_add_u32 s40, s41, 8192
    s_add_u32 m0, s42, 115712
    s_nop 0
    buffer_load_dwordx4 v77, s[44:47], s40 offen lds
    s_add_u32 s40, s41, 16384
    s_add_u32 m0, s42, 116736
    s_nop 0
    buffer_load_dwordx4 v76, s[44:47], s40 offen lds
    s_add_u32 s40, s41, 24576
    s_add_u32 m0, s42, 117760
    s_nop 0
    buffer_load_dwordx4 v77, s[44:47], s40 offen lds
    s_add_u32 s41, s28, 8
    s_and_b32 s41, s41, 31
    s_lshl_b32 s41, s41, 5
    s_add_u32 s41, s41, s55
    s_add_u32 s40, s41, 0
    s_add_u32 m0, s42, 131072
    s_nop 0
    buffer_load_dwordx4 v76, s[44:47], s40 offen lds
    s_add_u32 s40, s41, 8192
    s_add_u32 m0, s42, 132096
    s_nop 0
    buffer_load_dwordx4 v77, s[44:47], s40 offen lds
    s_add_u32 s40, s41, 16384
    s_add_u32 m0, s42, 133120
    s_nop 0
    buffer_load_dwordx4 v76, s[44:47], s40 offen lds
    s_add_u32 s40, s41, 24576
    s_add_u32 m0, s42, 134144
    s_nop 0
    buffer_load_dwordx4 v77, s[44:47], s40 offen lds
    v_mov_b32 v72, 0
    v_mov_b32 v73, 0
    v_mov_b32 v74, 0
    v_mov_b32 v75, 0
    v_bfe_u32 v78, v2, 1, 3
    v_lshrrev_b32 v79, 5, v2
    v_xor_b32 v78, v79, v78
    v_lshlrev_b32 v78, 4, v78
    v_and_b32 v79, 31, v2
    v_lshl_add_u32 v78, v79, 7, v78
    s_add_u32 s41, s42, 98304
    v_add_u32 v78, s41, v78
    v_xor_b32 v79, 32, v78
    v_xor_b32 v80, 64, v78
    v_xor_b32 v81, 96, v78
    v_subrev_u32 v82, 98304, v78
    v_subrev_u32 v83, 98304, v79
    v_subrev_u32 v84, 98304, v80
    v_subrev_u32 v85, 98304, v81
    s_add_u32 s41, s28, 12
    s_and_b32 s41, s41, 31
    s_lshl_b32 s41, s41, 5
    s_add_u32 s41, s41, s55
    s_add_u32 s40, s41, 0
    s_add_u32 m0, s42, 0
    s_nop 0
    buffer_load_dwordx4 v76, s[44:47], s40 offen lds
    s_add_u32 s40, s41, 8192
    s_add_u32 m0, s42, 1024
    s_nop 0
    buffer_load_dwordx4 v77, s[44:47], s40 offen lds
    s_add_u32 s40, s41, 16384
    s_add_u32 m0, s42, 2048
    s_nop 0
    buffer_load_dwordx4 v76, s[44:47], s40 offen lds
    s_add_u32 s40, s41, 24576
    s_add_u32 m0, s42, 3072
    s_nop 0
    buffer_load_dwordx4 v77, s[44:47], s40 offen lds
    s_add_u32 s41, s28, 16
    s_and_b32 s41, s41, 31
    s_lshl_b32 s41, s41, 5
    s_add_u32 s41, s41, s55
    s_add_u32 s40, s41, 0
    s_add_u32 m0, s42, 16384
    s_nop 0
    buffer_load_dwordx4 v76, s[44:47], s40 offen lds
    s_add_u32 s40, s41, 8192
    s_add_u32 m0, s42, 17408
    s_nop 0
    buffer_load_dwordx4 v77, s[44:47], s40 offen lds
    s_add_u32 s40, s41, 16384
    s_add_u32 m0, s42, 18432
    s_nop 0
    buffer_load_dwordx4 v76, s[44:47], s40 offen lds
    s_add_u32 s40, s41, 24576
    s_add_u32 m0, s42, 19456
    s_nop 0
    buffer_load_dwordx4 v77, s[44:47], s40 offen lds
    ds_read_b32 v1, v35 offset:0
    s_waitcnt vmcnt(16)
    ds_read_b128 v[128:131], v78 offset:0
    ds_read_b128 v[132:135], v79 offset:0
    s_waitcnt lgkmcnt(2)
    s_add_u32 s39, s7, 1
    v_cmp_gt_u32 s[30:31], s39, v1
    ds_read_b128 v[136:139], v80 offset:0
    ds_read_b128 v[140:143], v81 offset:0
    s_cmp_eq_u64 s[30:31], 0
    s_cbranch_scc1 L2
L1:
    s_add_u32 s38, s38, 1
    s_cmp_gt_u32 s38, 6400000
    s_cbranch_scc1 L2
    ds_read_b32 v1, v35 offset:0
    s_waitcnt lgkmcnt(0)
    v_cmp_gt_u32 vcc, s39, v1
    s_cbranch_vccnz L1
L2:
    ds_read_b64_tr_b16 v[96:97], v6 offset:32768
    ds_read_b64_tr_b16 v[98:99], v6 offset:33024
    ds_read_b64_tr_b16 v[100:101], v7 offset:0
    ds_read_b64_tr_b16 v[102:103], v7 offset:256
    ds_read_b64_tr_b16 v[104:105], v6 offset:33792
    ds_read_b64_tr_b16 v[106:107], v6 offset:34048
    ds_read_b64_tr_b16 v[108:109], v7 offset:1024
    ds_read_b64_tr_b16 v[110:111], v7 offset:1280
    ds_read_b64_tr_b16 v[112:113], v6 offset:34816
    ds_read_b64_tr_b16 v[114:115], v6 offset:35072
    s_waitcnt lgkmcnt(8)
    v_mfma_f32_32x32x16_bf16 v[40:55], v[96:99], v[128:131], 0
    ds_read_b64_tr_b16 v[116:117], v7 offset:2048
    ds_read_b64_tr_b16 v[118:119], v7 offset:2304
    s_add_u32 s33, s28, 20
    s_and_b32 s33, s33, 31
    s_lshl_b32 s33, s33, 5
    s_add_u32 s33, s33, s55
    s_add_u32 s40, s33, 0
    s_add_u32 m0, s42, 98304
    s_nop 0
    buffer_load_dwordx4 v76, s[44:47], s40 offen lds
    s_waitcnt lgkmcnt(8)
    v_mfma_f32_32x32x16_bf16 v[56:71], v[100:103], v[128:131], 0
    ds_read_b64_tr_b16 v[120:121], v6 offset:35840
    ds_read_b64_tr_b16 v[122:123], v6 offset:36096
    s_add_u32 s40, s33, 8192
    s_add_u32 m0, s42, 99328
    s_nop 0
    buffer_load_dwordx4 v77, s[44:47], s40 offen lds
    s_waitcnt lgkmcnt(8)
    v_mfma_f32_32x32x16_bf16 v[40:55], v[104:107], v[132:135], v[40:55]
    ds_read_b64_tr_b16 v[124:125], v7 offset:3072
    ds_read_b64_tr_b16 v[126:127], v7 offset:3328
    s_add_u32 s40, s33, 16384
    s_add_u32 m0, s42, 100352
    s_nop 0
    buffer_load_dwordx4 v76, s[44:47], s40 offen lds
    s_waitcnt lgkmcnt(8)
    v_mfma_f32_32x32x16_bf16 v[56:71], v[108:111], v[132:135], v[56:71]
    s_waitcnt vmcnt(15)
    ds_read_b128 v[144:147], v78 offset:16384
    ds_read_b128 v[148:151], v79 offset:16384
    s_add_u32 s40, s33, 24576
    s_add_u32 m0, s42, 101376
    s_nop 0
    buffer_load_dwordx4 v77, s[44:47], s40 offen lds
    s_waitcnt lgkmcnt(8)
    v_mfma_f32_32x32x16_bf16 v[40:55], v[112:115], v[136:139], v[40:55]
    ds_read_b128 v[152:155], v80 offset:16384
    ds_read_b128 v[156:159], v81 offset:16384
    s_waitcnt lgkmcnt(8)
    v_mfma_f32_32x32x16_bf16 v[56:71], v[116:119], v[136:139], v[56:71]
    ds_read_b64_tr_b16 v[96:97], v6 offset:36864
    ds_read_b64_tr_b16 v[98:99], v6 offset:37120
    s_waitcnt lgkmcnt(8)
    v_mfma_f32_32x32x16_bf16 v[40:55], v[120:123], v[140:143], v[40:55]
    ds_read_b64_tr_b16 v[100:101], v7 offset:4096
    ds_read_b64_tr_b16 v[102:103], v7 offset:4352
    s_waitcnt lgkmcnt(8)
    v_mfma_f32_32x32x16_bf16 v[56:71], v[124:127], v[140:143], v[56:71]
    ds_read_b64_tr_b16 v[104:105], v6 offset:37888
    ds_read_b64_tr_b16 v[106:107], v6 offset:38144
    ds_read_b64_tr_b16 v[108:109], v7 offset:5120
    ds_read_b64_tr_b16 v[110:111], v7 offset:5376
    ds_read_b64_tr_b16 v[112:113], v6 offset:38912
    ds_read_b64_tr_b16 v[114:115], v6 offset:39168
    v_dot2c_f32_bf16 v72, s20, v128
    v_dot2c_f32_bf16 v73, v128, v128
    v_dot2c_f32_bf16 v74, s20, v129
    v_dot2c_f32_bf16 v75, v129, v129
    v_dot2c_f32_bf16 v72, s20, v130
    v_dot2c_f32_bf16 v73, v130, v130
    v_dot2c_f32_bf16 v74, s20, v131
    v_dot2c_f32_bf16 v75, v131, v131
    v_dot2c_f32_bf16 v72, s20, v132
    v_dot2c_f32_bf16 v73, v132, v132
    v_dot2c_f32_bf16 v74, s20, v133
    v_dot2c_f32_bf16 v75, v133, v133
    v_dot2c_f32_bf16 v72, s20, v134
    v_dot2c_f32_bf16 v73, v134, v134
    v_dot2c_f32_bf16 v74, s20, v135
    v_dot2c_f32_bf16 v75, v135, v135
    v_dot2c_f32_bf16 v72, s20, v136
    v_dot2c_f32_bf16 v73, v136, v136
    v_dot2c_f32_bf16 v74, s20, v137
    v_dot2c_f32_bf16 v75, v137, v137
    v_dot2c_f32_bf16 v72, s20, v138
    v_dot2c_f32_bf16 v73, v138, v138
    v_dot2c_f32_bf16 v74, s20, v139
    v_dot2c_f32_bf16 v75, v139, v139
    v_dot2c_f32_bf16 v72, s20, v140
    v_dot2c_f32_bf16 v73, v140, v140
    v_dot2c_f32_bf16 v74, s20, v141
    v_dot2c_f32_bf16 v75, v141, v141
    v_dot2c_f32_bf16 v72, s20, v142
    v_dot2c_f32_bf16 v73, v142, v142
    v_dot2c_f32_bf16 v74, s20, v143
    v_dot2c_f32_bf16 v75, v143, v143
    s_waitcnt lgkmcnt(8)
    v_mfma_f32_32x32x16_bf16 v[40:55], v[96:99], v[144:147], v[40:55]
    ds_read_b32 v1, v35 offset:0
    ds_read_b64_tr_b16 v[116:117], v7 offset:6144
    ds_read_b64_tr_b16 v[118:119], v7 offset:6400
    s_add_u32 s33, s28, 24
    s_and_b32 s33, s33, 31
    s_lshl_b32 s33, s33, 5
    s_add_u32 s33, s33, s55
    s_add_u32 s40, s33, 0
    s_add_u32 m0, s42, 114688
    s_nop 0
    buffer_load_dwordx4 v76, s[44:47], s40 offen lds
    s_waitcnt lgkmcnt(9)
    v_mfma_f32_32x32x16_bf16 v[56:71], v[100:103], v[144:147], v[56:71]
    ds_read_b64_tr_b16 v[120:121], v6 offset:39936
    ds_read_b64_tr_b16 v[122:123], v6 offset:40192
    s_add_u32 s40, s33, 8192
    s_add_u32 m0, s42, 115712
    s_nop 0
    buffer_load_dwordx4 v77, s[44:47], s40 offen lds
    s_waitcnt lgkmcnt(9)
    v_mfma_f32_32x32x16_bf16 v[40:55], v[104:107], v[148:151], v[40:55]
    ds_read_b64_tr_b16 v[124:125], v7 offset:7168
    ds_read_b64_tr_b16 v[126:127], v7 offset:7424
    s_add_u32 s40, s33, 16384
    s_add_u32 m0, s42, 116736
    s_nop 0
    buffer_load_dwordx4 v76, s[44:47], s40 offen lds
    s_waitcnt lgkmcnt(9)
    v_mfma_f32_32x32x16_bf16 v[56:71], v[108:111], v[148:151], v[56:71]
    s_waitcnt vmcnt(15)
    ds_read_b128 v[160:163], v78 offset:32768
    ds_read_b128 v[164:167], v79 offset:32768
    s_add_u32 s40, s33, 24576
    s_add_u32 m0, s42, 117760
    s_nop 0
    buffer_load_dwordx4 v77, s[44:47], s40 offen lds
    s_waitcnt lgkmcnt(9)
    v_mfma_f32_32x32x16_bf16 v[40:55], v[112:115], v[152:155], v[40:55]
    s_waitcnt lgkmcnt(8)
    s_add_u32 s39, s7, 2
    v_cmp_gt_u32 s[30:31], s39, v1
    ds_read_b128 v[168:171], v80 offset:32768
    ds_read_b128 v[172:175], v81 offset:32768
    s_waitcnt lgkmcnt(8)
    v_mfma_f32_32x32x16_bf16 v[56:71], v[116:119], v[152:155], v[56:71]
    s_cmp_eq_u64 s[30:31], 0
    s_cbranch_scc1 L4
L3:
    s_add_u32 s38, s38, 1
    s_cmp_gt_u32 s38, 6400000
    s_cbranch_scc1 L4
    ds_read_b32 v1, v35 offset:0
    s_waitcnt lgkmcnt(0)
    v_cmp_gt_u32 vcc, s39, v1
    s_cbranch_vccnz L3
L4:
    ds_read_b64_tr_b16 v[96:97], v6 offset:40960
    ds_read_b64_tr_b16 v[98:99], v6 offset:41216
    s_waitcnt lgkmcnt(8)
    v_mfma_f32_32x32x16_bf16 v[40:55], v[120:123], v[156:159], v[40:55]
    ds_read_b64_tr_b16 v[100:101], v7 offset:8192
    ds_read_b64_tr_b16 v[102:103], v7 offset:8448
    s_waitcnt lgkmcnt(8)
    v_mfma_f32_32x32x16_bf16 v[56:71], v[124:127], v[156:159], v[56:71]
    ds_read_b64_tr_b16 v[104:105], v6 offset:41984
    ds_read_b64_tr_b16 v[106:107], v6 offset:42240
    ds_read_b64_tr_b16 v[108:109], v7 offset:9216
    ds_read_b64_tr_b16 v[110:111], v7 offset:9472
    ds_read_b64_tr_b16 v[112:113], v6 offset:43008
    ds_read_b64_tr_b16 v[114:115], v6 offset:43264
    v_dot2c_f32_bf16 v72, s20, v144
    v_dot2c_f32_bf16 v73, v144, v144
    v_dot2c_f32_bf16 v74, s20, v145
    v_dot2c_f32_bf16 v75, v145, v145
    v_dot2c_f32_bf16 v72, s20, v146
    v_dot2c_f32_bf16 v73, v146, v146
    v_dot2c_f32_bf16 v74, s20, v147
    v_dot2c_f32_bf16 v75, v147, v147
    v_dot2c_f32_bf16 v72, s20, v148
    v_dot2c_f32_bf16 v73, v148, v148
    v_dot2c_f32_bf16 v74, s20, v149
    v_dot2c_f32_bf16 v75, v149, v149
    v_dot2c_f32_bf16 v72, s20, v150
    v_dot2c_f32_bf16 v73, v150, v150
    v_dot2c_f32_bf16 v74, s20, v151
    v_dot2c_f32_bf16 v75, v151, v151
    v_dot2c_f32_bf16 v72, s20, v152
    v_dot2c_f32_bf16 v73, v152, v152
    v_dot2c_f32_bf16 v74, s20, v153
    v_dot2c_f32_bf16 v75, v153, v153
    v_dot2c_f32_bf16 v72, s20, v154
    v_dot2c_f32_bf16 v73, v154, v154
    v_dot2c_f32_bf16 v74, s20, v155
    v_dot2c_f32_bf16 v75, v155, v155
    v_dot2c_f32_bf16 v72, s20, v156
    v_dot2c_f32_bf16 v73, v156, v156
    v_dot2c_f32_bf16 v74, s20, v157
    v_dot2c_f32_bf16 v75, v157, v157
    v_dot2c_f32_bf16 v72, s20, v158
    v_dot2c_f32_bf16 v73, v158, v158
    v_dot2c_f32_bf16 v74, s20, v159
    v_dot2c_f32_bf16 v75, v159, v159
    s_waitcnt lgkmcnt(8)
    v_mfma_f32_32x32x16_bf16 v[40:55], v[96:99], v[160:163], v[40:55]
    ds_read_b64_tr_b16 v[116:117], v7 offset:10240
    ds_read_b64_tr_b16 v[118:119], v7 offset:10496
    s_add_u32 s33, s28, 28
    s_and_b32 s33, s33, 31
    s_lshl_b32 s33, s33, 5
    s_add_u32 s33, s33, s55
    s_add_u32 s40, s33, 0
    s_add_u32 m0, s42, 131072
    s_nop 0
    buffer_load_dwordx4 v76, s[44:47], s40 offen lds
    s_waitcnt lgkmcnt(8)
    v_mfma_f32_32x32x16_bf16 v[56:71], v[100:103], v[160:163], v[56:71]
    ds_read_b64_tr_b16 v[120:121], v6 offset:44032
    ds_read_b64_tr_b16 v[122:123], v6 offset:44288
    s_add_u32 s40, s33, 8192
    s_add_u32 m0, s42, 132096
    s_nop 0
    buffer_load_dwordx4 v77, s[44:47], s40 offen lds
    s_waitcnt lgkmcnt(8)
    v_mfma_f32_32x32x16_bf16 v[40:55], v[104:107], v[164:167], v[40:55]
    ds_read_b64_tr_b16 v[124:125], v7 offset:11264
    ds_read_b64_tr_b16 v[126:127], v7 offset:11520
    s_add_u32 s40, s33, 16384
    s_add_u32 m0, s42, 133120
    s_nop 0
    buffer_load_dwordx4 v76, s[44:47], s40 offen lds
    s_waitcnt lgkmcnt(8)
    v_mfma_f32_32x32x16_bf16 v[56:71], v[108:111], v[164:167], v[56:71]
    s_waitcnt vmcnt(15)
    ds_read_b128 v[176:179], v82 offset:0
    ds_read_b128 v[180:183], v83 offset:0
    s_add_u32 s40, s33, 24576
    s_add_u32 m0, s42, 134144
    s_nop 0
    buffer_load_dwordx4 v77, s[44:47], s40 offen lds
    s_waitcnt lgkmcnt(8)
    v_mfma_f32_32x32x16_bf16 v[40:55], v[112:115], v[168:171], v[40:55]
    ds_read_b128 v[184:187], v84 offset:0
    ds_read_b128 v[188:191], v85 offset:0
    s_waitcnt lgkmcnt(8)
    v_mfma_f32_32x32x16_bf16 v[56:71], v[116:119], v[168:171], v[56:71]
    ds_read_b64_tr_b16 v[96:97], v6 offset:45056
    ds_read_b64_tr_b16 v[98:99], v6 offset:45312
    s_waitcnt lgkmcnt(8)
    v_mfma_f32_32x32x16_bf16 v[40:55], v[120:123], v[172:175], v[40:55]
    ds_read_b64_tr_b16 v[100:101], v7 offset:12288
    ds_read_b64_tr_b16 v[102:103], v7 offset:12544
    s_waitcnt lgkmcnt(8)
    v_mfma_f32_32x32x16_bf16 v[56:71], v[124:127], v[172:175], v[56:71]
    ds_read_b64_tr_b16 v[104:105], v6 offset:46080
    ds_read_b64_tr_b16 v[106:107], v6 offset:46336
    ds_read_b64_tr_b16 v[108:109], v7 offset:13312
    ds_read_b64_tr_b16 v[110:111], v7 offset:13568
    ds_read_b64_tr_b16 v[112:113], v6 offset:47104
    ds_read_b64_tr_b16 v[114:115], v6 offset:47360
    v_add_u32 v13, 1, v9
    ds_write_b32 v0, v13
    v_dot2c_f32_bf16 v72, s20, v160
    v_dot2c_f32_bf16 v73, v160, v160
    v_dot2c_f32_bf16 v74, s20, v161
    v_dot2c_f32_bf16 v75, v161, v161
    v_dot2c_f32_bf16 v72, s20, v162
    v_dot2c_f32_bf16 v73, v162, v162
    v_dot2c_f32_bf16 v74, s20, v163
    v_dot2c_f32_bf16 v75, v163, v163
    v_dot2c_f32_bf16 v72, s20, v164
    v_dot2c_f32_bf16 v73, v164, v164
    v_dot2c_f32_bf16 v74, s20, v165
    v_dot2c_f32_bf16 v75, v165, v165
    v_dot2c_f32_bf16 v72, s20, v166
    v_dot2c_f32_bf16 v73, v166, v166
    v_dot2c_f32_bf16 v74, s20, v167
    v_dot2c_f32_bf16 v75, v167, v167
    v_dot2c_f32_bf16 v72, s20, v168
    v_dot2c_f32_bf16 v73, v168, v168
    v_dot2c_f32_bf16 v74, s20, v169
    v_dot2c_f32_bf16 v75, v169, v169
    v_dot2c_f32_bf16 v72, s20, v170
    v_dot2c_f32_bf16 v73, v170, v170
    v_dot2c_f32_bf16 v74, s20, v171
    v_dot2c_f32_bf16 v75, v171, v171
    v_dot2c_f32_bf16 v72, s20, v172
    v_dot2c_f32_bf16 v73, v172, v172
    v_dot2c_f32_bf16 v74, s20, v173
    v_dot2c_f32_bf16 v75, v173, v173
    v_dot2c_f32_bf16 v72, s20, v174
    v_dot2c_f32_bf16 v73, v174, v174
    v_dot2c_f32_bf16 v74, s20, v175
    v_dot2c_f32_bf16 v75, v175, v175
    s_waitcnt lgkmcnt(8)
    v_mfma_f32_32x32x16_bf16 v[40:55], v[96:99], v[176:179], v[40:55]
    ds_read_b32 v1, v35 offset:0
    ds_read_b64_tr_b16 v[116:117], v7 offset:14336
    ds_read_b64_tr_b16 v[118:119], v7 offset:14592
    s_waitcnt lgkmcnt(9)
    v_mfma_f32_32x32x16_bf16 v[56:71], v[100:103], v[176:179], v[56:71]
    ds_read_b64_tr_b16 v[120:121], v6 offset:48128
    ds_read_b64_tr_b16 v[122:123], v6 offset:48384
    s_waitcnt lgkmcnt(9)
    v_mfma_f32_32x32x16_bf16 v[40:55], v[104:107], v[180:183], v[40:55]
    ds_read_b64_tr_b16 v[124:125], v7 offset:15360
    ds_read_b64_tr_b16 v[126:127], v7 offset:15616
    s_waitcnt lgkmcnt(9)
    v_mfma_f32_32x32x16_bf16 v[56:71], v[108:111], v[180:183], v[56:71]
    s_waitcnt vmcnt(12)
    ds_read_b128 v[192:195], v82 offset:16384
    ds_read_b128 v[196:199], v83 offset:16384
    s_waitcnt lgkmcnt(9)
    v_mfma_f32_32x32x16_bf16 v[40:55], v[112:115], v[184:187], v[40:55]
    s_waitcnt lgkmcnt(8)
    s_add_u32 s39, s7, 3
    v_cmp_gt_u32 s[30:31], s39, v1
    ds_read_b128 v[200:203], v84 offset:16384
    ds_read_b128 v[204:207], v85 offset:16384
    s_waitcnt lgkmcnt(8)
    v_mfma_f32_32x32x16_bf16 v[56:71], v[116:119], v[184:187], v[56:71]
    s_cmp_eq_u64 s[30:31], 0
    s_cbranch_scc1 L6
L5:
    s_add_u32 s38, s38, 1
    s_cmp_gt_u32 s38, 6400000
    s_cbranch_scc1 L6
    ds_read_b32 v1, v35 offset:0
    s_waitcnt lgkmcnt(0)
    v_cmp_gt_u32 vcc, s39, v1
    s_cbranch_vccnz L5
L6:
    ds_read_b64_tr_b16 v[96:97], v6 offset:49152
    ds_read_b64_tr_b16 v[98:99], v6 offset:49408
    s_waitcnt lgkmcnt(8)
    v_mfma_f32_32x32x16_bf16 v[40:55], v[120:123], v[188:191], v[40:55]
    ds_read_b64_tr_b16 v[100:101], v7 offset:16384
    ds_read_b64_tr_b16 v[102:103], v7 offset:16640
    s_waitcnt lgkmcnt(8)
    v_mfma_f32_32x32x16_bf16 v[56:71], v[124:127], v[188:191], v[56:71]
    ds_read_b64_tr_b16 v[104:105], v6 offset:50176
    ds_read_b64_tr_b16 v[106:107], v6 offset:50432
    ds_read_b64_tr_b16 v[108:109], v7 offset:17408
    ds_read_b64_tr_b16 v[110:111], v7 offset:17664
    ds_read_b64_tr_b16 v[112:113], v6 offset:51200
    ds_read_b64_tr_b16 v[114:115], v6 offset:51456
    v_dot2c_f32_bf16 v72, s20, v176
    v_dot2c_f32_bf16 v73, v176, v176
    v_dot2c_f32_bf16 v74, s20, v177
    v_dot2c_f32_bf16 v75, v177, v177
    v_dot2c_f32_bf16 v72, s20, v178
    v_dot2c_f32_bf16 v73, v178, v178
    v_dot2c_f32_bf16 v74, s20, v179
    v_dot2c_f32_bf16 v75, v179, v179
    v_dot2c_f32_bf16 v72, s20, v180
    v_dot2c_f32_bf16 v73, v180, v180
    v_dot2c_f32_bf16 v74, s20, v181
    v_dot2c_f32_bf16 v75, v181, v181
    v_dot2c_f32_bf16 v72, s20, v182
    v_dot2c_f32_bf16 v73, v182, v182
    v_dot2c_f32_bf16 v74, s20, v183
    v_dot2c_f32_bf16 v75, v183, v183
    v_dot2c_f32_bf16 v72, s20, v184
    v_dot2c_f32_bf16 v73, v184, v184
    v_dot2c_f32_bf16 v74, s20, v185
    v_dot2c_f32_bf16 v75, v185, v185
    v_dot2c_f32_bf16 v72, s20, v186
    v_dot2c_f32_bf16 v73, v186, v186
    v_dot2c_f32_bf16 v74, s20, v187
    v_dot2c_f32_bf16 v75, v187, v187
    v_dot2c_f32_bf16 v72, s20, v188
    v_dot2c_f32_bf16 v73, v188, v188
    v_dot2c_f32_bf16 v74, s20, v189
    v_dot2c_f32_bf16 v75, v189, v189
    v_dot2c_f32_bf16 v72, s20, v190
    v_dot2c_f32_bf16 v73, v190, v190
    v_dot2c_f32_bf16 v74, s20, v191
    v_dot2c_f32_bf16 v75, v191, v191
    s_waitcnt lgkmcnt(8)
    v_mfma_f32_32x32x16_bf16 v[40:55], v[96:99], v[192:195], v[40:55]
    ds_read_b64_tr_b16 v[116:117], v7 offset:18432
    ds_read_b64_tr_b16 v[118:119], v7 offset:18688
    v_add_u32 v13, 2, v9
    ds_write_b32 v0, v13
    s_waitcnt lgkmcnt(8)
    v_mfma_f32_32x32x16_bf16 v[56:71], v[100:103], v[192:195], v[56:71]
    ds_read_b64_tr_b16 v[120:121], v6 offset:52224
    ds_read_b64_tr_b16 v[122:123], v6 offset:52480
    s_waitcnt lgkmcnt(8)
    v_mfma_f32_32x32x16_bf16 v[40:55], v[104:107], v[196:199], v[40:55]
    ds_read_b64_tr_b16 v[124:125], v7 offset:19456
    ds_read_b64_tr_b16 v[126:127], v7 offset:19712
    s_waitcnt lgkmcnt(8)
    v_mfma_f32_32x32x16_bf16 v[56:71], v[108:111], v[196:199], v[56:71]
    s_waitcnt vmcnt(8)
    ds_read_b128 v[208:211], v78 offset:0
    ds_read_b128 v[212:215], v79 offset:0
    s_waitcnt lgkmcnt(8)
    v_mfma_f32_32x32x16_bf16 v[40:55], v[112:115], v[200:203], v[40:55]
    ds_read_b128 v[216:219], v80 offset:0
    ds_read_b128 v[220:223], v81 offset:0
    s_waitcnt lgkmcnt(8)
    v_mfma_f32_32x32x16_bf16 v[56:71], v[116:119], v[200:203], v[56:71]
    ds_read_b64_tr_b16 v[96:97], v6 offset:53248
    ds_read_b64_tr_b16 v[98:99], v6 offset:53504
    s_waitcnt lgkmcnt(8)
    v_mfma_f32_32x32x16_bf16 v[40:55], v[120:123], v[204:207], v[40:55]
    ds_read_b64_tr_b16 v[100:101], v7 offset:20480
    ds_read_b64_tr_b16 v[102:103], v7 offset:20736
    s_waitcnt lgkmcnt(8)
    v_mfma_f32_32x32x16_bf16 v[56:71], v[124:127], v[204:207], v[56:71]
    ds_read_b64_tr_b16 v[104:105], v6 offset:54272
    ds_read_b64_tr_b16 v[106:107], v6 offset:54528
    ds_read_b64_tr_b16 v[108:109], v7 offset:21504
    ds_read_b64_tr_b16 v[110:111], v7 offset:21760
    ds_read_b64_tr_b16 v[112:113], v6 offset:55296
    ds_read_b64_tr_b16 v[114:115], v6 offset:55552
    v_dot2c_f32_bf16 v72, s20, v192
    v_dot2c_f32_bf16 v73, v192, v192
    v_dot2c_f32_bf16 v74, s20, v193
    v_dot2c_f32_bf16 v75, v193, v193
    v_dot2c_f32_bf16 v72, s20, v194
    v_dot2c_f32_bf16 v73, v194, v194
    v_dot2c_f32_bf16 v74, s20, v195
    v_dot2c_f32_bf16 v75, v195, v195
    v_dot2c_f32_bf16 v72, s20, v196
    v_dot2c_f32_bf16 v73, v196, v196
    v_dot2c_f32_bf16 v74, s20, v197
    v_dot2c_f32_bf16 v75, v197, v197
    v_dot2c_f32_bf16 v72, s20, v198
    v_dot2c_f32_bf16 v73, v198, v198
    v_dot2c_f32_bf16 v74, s20, v199
    v_dot2c_f32_bf16 v75, v199, v199
    v_dot2c_f32_bf16 v72, s20, v200
    v_dot2c_f32_bf16 v73, v200, v200
    v_dot2c_f32_bf16 v74, s20, v201
    v_dot2c_f32_bf16 v75, v201, v201
    v_dot2c_f32_bf16 v72, s20, v202
    v_dot2c_f32_bf16 v73, v202, v202
    v_dot2c_f32_bf16 v74, s20, v203
    v_dot2c_f32_bf16 v75, v203, v203
    v_dot2c_f32_bf16 v72, s20, v204
    v_dot2c_f32_bf16 v73, v204, v204
    v_dot2c_f32_bf16 v74, s20, v205
    v_dot2c_f32_bf16 v75, v205, v205
    v_dot2c_f32_bf16 v72, s20, v206
    v_dot2c_f32_bf16 v73, v206, v206
    v_dot2c_f32_bf16 v74, s20, v207
    v_dot2c_f32_bf16 v75, v207, v207
    s_waitcnt lgkmcnt(8)
    v_mfma_f32_32x32x16_bf16 v[40:55], v[96:99], v[208:211], v[40:55]
    ds_read_b32 v1, v35 offset:0
    ds_read_b64_tr_b16 v[116:117], v7 offset:22528
    ds_read_b64_tr_b16 v[118:119], v7 offset:22784
    s_waitcnt lgkmcnt(9)
    v_mfma_f32_32x32x16_bf16 v[56:71], v[100:103], v[208:211], v[56:71]
    ds_read_b64_tr_b16 v[120:121], v6 offset:56320
    ds_read_b64_tr_b16 v[122:123], v6 offset:56576
    s_waitcnt lgkmcnt(9)
    v_mfma_f32_32x32x16_bf16 v[40:55], v[104:107], v[212:215], v[40:55]
    ds_read_b64_tr_b16 v[124:125], v7 offset:23552
    ds_read_b64_tr_b16 v[126:127], v7 offset:23808
    s_waitcnt lgkmcnt(9)
    v_mfma_f32_32x32x16_bf16 v[56:71], v[108:111], v[212:215], v[56:71]
    s_waitcnt vmcnt(4)
    ds_read_b128 v[224:227], v78 offset:16384
    ds_read_b128 v[228:231], v79 offset:16384
    s_waitcnt lgkmcnt(9)
    v_mfma_f32_32x32x16_bf16 v[40:55], v[112:115], v[216:219], v[40:55]
    s_waitcnt lgkmcnt(8)
    s_add_u32 s39, s7, 4
    v_cmp_gt_u32 s[30:31], s39, v1
    ds_read_b128 v[232:235], v80 offset:16384
    ds_read_b128 v[236:239], v81 offset:16384
    s_waitcnt lgkmcnt(8)
    v_mfma_f32_32x32x16_bf16 v[56:71], v[116:119], v[216:219], v[56:71]
    s_cmp_eq_u64 s[30:31], 0
    s_cbranch_scc1 L8
L7:
    s_add_u32 s38, s38, 1
    s_cmp_gt_u32 s38, 6400000
    s_cbranch_scc1 L8
    ds_read_b32 v1, v35 offset:0
    s_waitcnt lgkmcnt(0)
    v_cmp_gt_u32 vcc, s39, v1
    s_cbranch_vccnz L7
L8:
    ds_read_b64_tr_b16 v[96:97], v6 offset:57344
    ds_read_b64_tr_b16 v[98:99], v6 offset:57600
    s_waitcnt lgkmcnt(8)
    v_mfma_f32_32x32x16_bf16 v[40:55], v[120:123], v[220:223], v[40:55]
    ds_read_b64_tr_b16 v[100:101], v7 offset:24576
    ds_read_b64_tr_b16 v[102:103], v7 offset:24832
    s_waitcnt lgkmcnt(8)
    v_mfma_f32_32x32x16_bf16 v[56:71], v[124:127], v[220:223], v[56:71]
    ds_read_b64_tr_b16 v[104:105], v6 offset:58368
    ds_read_b64_tr_b16 v[106:107], v6 offset:58624
    ds_read_b64_tr_b16 v[108:109], v7 offset:25600
    ds_read_b64_tr_b16 v[110:111], v7 offset:25856
    ds_read_b64_tr_b16 v[112:113], v6 offset:59392
    ds_read_b64_tr_b16 v[114:115], v6 offset:59648
    v_dot2c_f32_bf16 v72, s20, v208
    v_dot2c_f32_bf16 v73, v208, v208
    v_dot2c_f32_bf16 v74, s20, v209
    v_dot2c_f32_bf16 v75, v209, v209
    v_dot2c_f32_bf16 v72, s20, v210
    v_dot2c_f32_bf16 v73, v210, v210
    v_dot2c_f32_bf16 v74, s20, v211
    v_dot2c_f32_bf16 v75, v211, v211
    v_dot2c_f32_bf16 v72, s20, v212
    v_dot2c_f32_bf16 v73, v212, v212
    v_dot2c_f32_bf16 v74, s20, v213
    v_dot2c_f32_bf16 v75, v213, v213
    v_dot2c_f32_bf16 v72, s20, v214
    v_dot2c_f32_bf16 v73, v214, v214
    v_dot2c_f32_bf16 v74, s20, v215
    v_dot2c_f32_bf16 v75, v215, v215
    v_dot2c_f32_bf16 v72, s20, v216
    v_dot2c_f32_bf16 v73, v216, v216
    v_dot2c_f32_bf16 v74, s20, v217
    v_dot2c_f32_bf16 v75, v217, v217
    v_dot2c_f32_bf16 v72, s20, v218
    v_dot2c_f32_bf16 v73, v218, v218
    v_dot2c_f32_bf16 v74, s20, v219
    v_dot2c_f32_bf16 v75, v219, v219
    v_dot2c_f32_bf16 v72, s20, v220
    v_dot2c_f32_bf16 v73, v220, v220
    v_dot2c_f32_bf16 v74, s20, v221
    v_dot2c_f32_bf16 v75, v221, v221
    v_dot2c_f32_bf16 v72, s20, v222
    v_dot2c_f32_bf16 v73, v222, v222
    v_dot2c_f32_bf16 v74, s20, v223
    v_dot2c_f32_bf16 v75, v223, v223
    s_waitcnt lgkmcnt(8)
    v_mfma_f32_32x32x16_bf16 v[40:55], v[96:99], v[224:227], v[40:55]
    ds_read_b64_tr_b16 v[116:117], v7 offset:26624
    ds_read_b64_tr_b16 v[118:119], v7 offset:26880
    s_waitcnt lgkmcnt(8)
    v_mfma_f32_32x32x16_bf16 v[56:71], v[100:103], v[224:227], v[56:71]
    ds_read_b64_tr_b16 v[120:121], v6 offset:60416
    ds_read_b64_tr_b16 v[122:123], v6 offset:60672
    s_waitcnt lgkmcnt(8)
    v_mfma_f32_32x32x16_bf16 v[40:55], v[104:107], v[228:231], v[40:55]
    ds_read_b64_tr_b16 v[124:125], v7 offset:27648
    ds_read_b64_tr_b16 v[126:127], v7 offset:27904
    s_waitcnt lgkmcnt(8)
    v_mfma_f32_32x32x16_bf16 v[56:71], v[108:111], v[228:231], v[56:71]
    s_waitcnt vmcnt(0)
    ds_read_b128 v[240:243], v78 offset:32768
    ds_read_b128 v[244:247], v79 offset:32768
    s_waitcnt lgkmcnt(8)
    v_mfma_f32_32x32x16_bf16 v[40:55], v[112:115], v[232:235], v[40:55]
    ds_read_b128 v[248:251], v80 offset:32768
    ds_read_b128 v[252:255], v81 offset:32768
    s_waitcnt lgkmcnt(8)
    v_mfma_f32_32x32x16_bf16 v[56:71], v[116:119], v[232:235], v[56:71]
    ds_read_b64_tr_b16 v[96:97], v6 offset:61440
    ds_read_b64_tr_b16 v[98:99], v6 offset:61696
    s_waitcnt lgkmcnt(8)
    v_mfma_f32_32x32x16_bf16 v[40:55], v[120:123], v[236:239], v[40:55]
    ds_read_b64_tr_b16 v[100:101], v7 offset:28672
    ds_read_b64_tr_b16 v[102:103], v7 offset:28928
    s_waitcnt lgkmcnt(8)
    v_mfma_f32_32x32x16_bf16 v[56:71], v[124:127], v[236:239], v[56:71]
    ds_read_b64_tr_b16 v[104:105], v6 offset:62464
    ds_read_b64_tr_b16 v[106:107], v6 offset:62720
    ds_read_b32 v1, v35 offset:0
    ds_read_b64_tr_b16 v[108:109], v7 offset:29696
    ds_read_b64_tr_b16 v[110:111], v7 offset:29952
    ds_read_b64_tr_b16 v[112:113], v6 offset:63488
    ds_read_b64_tr_b16 v[114:115], v6 offset:63744
    v_dot2c_f32_bf16 v72, s20, v224
    v_dot2c_f32_bf16 v73, v224, v224
    v_dot2c_f32_bf16 v74, s20, v225
    v_dot2c_f32_bf16 v75, v225, v225
    v_dot2c_f32_bf16 v72, s20, v226
    v_dot2c_f32_bf16 v73, v226, v226
    v_dot2c_f32_bf16 v74, s20, v227
    v_dot2c_f32_bf16 v75, v227, v227
    v_dot2c_f32_bf16 v72, s20, v228
    v_dot2c_f32_bf16 v73, v228, v228
    v_dot2c_f32_bf16 v74, s20, v229
    v_dot2c_f32_bf16 v75, v229, v229
    v_dot2c_f32_bf16 v72, s20, v230
    v_dot2c_f32_bf16 v73, v230, v230
    v_dot2c_f32_bf16 v74, s20, v231
    v_dot2c_f32_bf16 v75, v231, v231
    v_dot2c_f32_bf16 v72, s20, v232
    v_dot2c_f32_bf16 v73, v232, v232
    v_dot2c_f32_bf16 v74, s20, v233
    v_dot2c_f32_bf16 v75, v233, v233
    v_dot2c_f32_bf16 v72, s20, v234
    v_dot2c_f32_bf16 v73, v234, v234
    v_dot2c_f32_bf16 v74, s20, v235
    v_dot2c_f32_bf16 v75, v235, v235
    v_dot2c_f32_bf16 v72, s20, v236
    v_dot2c_f32_bf16 v73, v236, v236
    v_dot2c_f32_bf16 v74, s20, v237
    v_dot2c_f32_bf16 v75, v237, v237
    v_dot2c_f32_bf16 v72, s20, v238
    v_dot2c_f32_bf16 v73, v238, v238
    v_dot2c_f32_bf16 v74, s20, v239
    v_dot2c_f32_bf16 v75, v239, v239
    s_waitcnt lgkmcnt(9)
    v_mfma_f32_32x32x16_bf16 v[40:55], v[96:99], v[240:243], v[40:55]
    ds_read_b64_tr_b16 v[116:117], v7 offset:30720
    ds_read_b64_tr_b16 v[118:119], v7 offset:30976
    s_waitcnt lgkmcnt(9)
    v_mfma_f32_32x32x16_bf16 v[56:71], v[100:103], v[240:243], v[56:71]
    ds_read_b64_tr_b16 v[120:121], v6 offset:64512
    ds_read_b64_tr_b16 v[122:123], v6 offset:64768
    s_waitcnt lgkmcnt(9)
    v_mfma_f32_32x32x16_bf16 v[40:55], v[104:107], v[244:247], v[40:55]
    s_waitcnt lgkmcnt(8)
    s_add_u32 s39, s7, 5
    v_cmp_gt_u32 s[30:31], s39, v1
    ds_read_b64_tr_b16 v[124:125], v7 offset:31744
    ds_read_b64_tr_b16 v[126:127], v7 offset:32000
    v_add_u32 v13, 3, v9
    ds_write_b32 v0, v13
    s_waitcnt lgkmcnt(9)
    v_mfma_f32_32x32x16_bf16 v[56:71], v[108:111], v[244:247], v[56:71]
    s_cmp_eq_u64 s[30:31], 0
    s_cbranch_scc1 L10
L9:
    s_add_u32 s38, s38, 1
    s_cmp_gt_u32 s38, 6400000
    s_cbranch_scc1 L10
    ds_read_b32 v1, v35 offset:0
    s_waitcnt lgkmcnt(0)
    v_cmp_gt_u32 vcc, s39, v1
    s_cbranch_vccnz L9
L10:
    ds_read_b64 v[96:97], v22 offset:256
    ds_read_b64 v[100:101], v22 offset:512
    s_waitcnt lgkmcnt(9)
    v_mfma_f32_32x32x16_bf16 v[40:55], v[112:115], v[248:251], v[40:55]
    s_waitcnt lgkmcnt(7)
    v_mfma_f32_32x32x16_bf16 v[56:71], v[116:119], v[248:251], v[56:71]
    s_waitcnt lgkmcnt(5)
    v_mfma_f32_32x32x16_bf16 v[40:55], v[120:123], v[252:255], v[40:55]
    s_waitcnt lgkmcnt(3)
    v_mfma_f32_32x32x16_bf16 v[56:71], v[124:127], v[252:255], v[56:71]
    v_dot2c_f32_bf16 v72, s20, v240
    v_dot2c_f32_bf16 v73, v240, v240
    v_dot2c_f32_bf16 v74, s20, v241
    v_dot2c_f32_bf16 v75, v241, v241
    v_dot2c_f32_bf16 v72, s20, v242
    v_dot2c_f32_bf16 v73, v242, v242
    v_dot2c_f32_bf16 v74, s20, v243
    v_dot2c_f32_bf16 v75, v243, v243
    v_dot2c_f32_bf16 v72, s20, v244
    v_dot2c_f32_bf16 v73, v244, v244
    v_dot2c_f32_bf16 v74, s20, v245
    v_dot2c_f32_bf16 v75, v245, v245
    v_dot2c_f32_bf16 v72, s20, v246
    v_dot2c_f32_bf16 v73, v246, v246
    v_dot2c_f32_bf16 v74, s20, v247
    v_dot2c_f32_bf16 v75, v247, v247
    v_dot2c_f32_bf16 v72, s20, v248
    v_dot2c_f32_bf16 v73, v248, v248
    v_dot2c_f32_bf16 v74, s20, v249
    v_dot2c_f32_bf16 v75, v249, v249
    v_dot2c_f32_bf16 v72, s20, v250
    v_dot2c_f32_bf16 v73, v250, v250
    v_dot2c_f32_bf16 v74, s20, v251
    v_dot2c_f32_bf16 v75, v251, v251
    v_dot2c_f32_bf16 v72, s20, v252
    v_dot2c_f32_bf16 v73, v252, v252
    v_dot2c_f32_bf16 v74, s20, v253
    v_dot2c_f32_bf16 v75, v253, v253
    v_dot2c_f32_bf16 v72, s20, v254
    v_dot2c_f32_bf16 v73, v254, v254
    v_dot2c_f32_bf16 v74, s20, v255
    v_dot2c_f32_bf16 v75, v255, v255
    s_nop 1
    v_add_f32 v72, v72, v74
    v_add_f32 v73, v73, v75
    s_nop 1
    v_permlane32_swap_b32 v72, v73
    s_nop 1
    v_add_f32 v72, v72, v73
    v_mov_b32 v73, v72
    s_nop 1
    v_permlane32_swap_b32 v72, v73
    s_nop 1
    v_mul_f32 v72, 0xbb000000, v72
    v_mul_f32 v73, 0x3b000000, v73
    v_fma_f32 v73, -v72, v72, v73
    v_max_f32 v73, 0, v73
    v_add_f32 v73, 0x3727c5ac, v73
    v_rsq_f32 v10, v73
    v_sqrt_f32 v11, v73
    v_cvt_pk_bf16_f32 v16, v72, v72
    v_and_b32 v74, 0xffff0000, v16
    v_sub_f32 v74, v72, v74
    v_mov_b32 v75, 0
    v_cvt_pk_bf16_f32 v17, v74, v75
    v_cndmask_b32_e64 v16, 0, v16, s[62:63]
    v_cndmask_b32_e64 v17, 0, v17, s[62:63]
    v_mul_f32 v12, 0xbfb8aa3b, v10
    s_waitcnt lgkmcnt(1)
    v_mfma_f32_32x32x16_bf16 v[40:55], v[96:99], v[16:19], v[40:55]
    s_waitcnt lgkmcnt(0)
    v_mfma_f32_32x32x16_bf16 v[56:71], v[100:103], v[16:19], v[56:71]
    v_mov_b32 v13, 163496
    ds_read_b64 v[36:37], v13
    s_waitcnt lgkmcnt(0)
    v_readfirstlane_b32 s4, v36
    v_readfirstlane_b32 s5, v37
    s_branch L_c_go
L_c_loop:
    s_mov_b32 s41, 0
L11:
    buffer_load_dword v13, v20, s[8:11], s26 offen sc1
    s_add_u32 s41, s41, 1
    s_cmp_gt_u32 s41, 400000
    s_cbranch_scc1 L12
    s_waitcnt vmcnt(0)
    v_cmp_gt_u32 vcc, s57, v13
    s_cbranch_vccnz L11
L12:
    s_add_u32 s43, s55, 0
    buffer_load_dwordx4 v[128:131], v3, s[8:11], s43 offen offset:0 sc1
    buffer_load_dwordx4 v[132:135], v3, s[8:11], s43 offen offset:1024 sc1
    buffer_load_dwordx4 v[136:139], v3, s[8:11], s43 offen offset:2048 sc1
    buffer_load_dwordx4 v[140:143], v3, s[8:11], s43 offen offset:3072 sc1
    s_add_u32 s43, s55, 4096
    buffer_load_dwordx4 v[144:147], v3, s[8:11], s43 offen offset:0 sc1
    buffer_load_dwordx4 v[148:151], v3, s[8:11], s43 offen offset:1024 sc1
    buffer_load_dwordx4 v[72:75], v3, s[8:11], s56 offen offset:0 sc1
    buffer_load_dwordx4 v[76:79], v3, s[8:11], s56 offen offset:1024 sc1
    buffer_load_dwordx4 v[80:83], v3, s[8:11], s56 offen offset:2048 sc1
    buffer_load_dwordx4 v[84:87], v3, s[8:11], s56 offen offset:3072 sc1
    buffer_load_dwordx4 v[152:155], v3, s[8:11], s43 offen offset:2048 sc1
    buffer_load_dwordx4 v[156:159], v3, s[8:11], s43 offen offset:3072 sc1
    s_add_u32 s43, s55, 8192
    buffer_load_dwordx4 v[160:163], v3, s[8:11], s43 offen offset:0 sc1
    buffer_load_dwordx4 v[164:167], v3, s[8:11], s43 offen offset:1024 sc1
    ds_read_b32 v1, v35 offset:0
    s_waitcnt lgkmcnt(0)
    s_movk_i32 s39, 24
    v_cmp_gt_u32 s[30:31], s39, v1
    s_nop 0
    s_cmp_eq_u64 s[30:31], 0
    s_cbranch_scc1 L14
L13:
    s_add_u32 s38, s38, 1
    s_cmp_gt_u32 s38, 6400000
    s_cbranch_scc1 L14
    ds_read_b32 v1, v35 offset:0
    s_waitcnt lgkmcnt(0)
    v_cmp_gt_u32 vcc, s39, v1
    s_cbranch_vccnz L13
L14:
    ds_read_b64_tr_b16 v[96:97], v6 offset:32768
    ds_read_b64_tr_b16 v[98:99], v6 offset:33024
    ds_read_b64_tr_b16 v[100:101], v7 offset:0
    ds_read_b64_tr_b16 v[102:103], v7 offset:256
    ds_read_b64_tr_b16 v[104:105], v6 offset:33792
    ds_read_b64_tr_b16 v[106:107], v6 offset:34048
    ds_read_b64_tr_b16 v[108:109], v7 offset:1024
    ds_read_b64_tr_b16 v[110:111], v7 offset:1280
    ds_read_b64_tr_b16 v[112:113], v6 offset:34816
    ds_read_b64_tr_b16 v[114:115], v6 offset:35072
    ds_read_b64_tr_b16 v[116:117], v7 offset:2048
    ds_read_b64_tr_b16 v[118:119], v7 offset:2304
    s_waitcnt vmcnt(13)
    s_waitcnt lgkmcnt(10)
    v_mfma_f32_32x32x16_bf16 v[40:55], v[96:99], v[128:131], 0
    ds_read_b64_tr_b16 v[120:121], v6 offset:35840
    ds_read_b64_tr_b16 v[122:123], v6 offset:36096
    buffer_load_dwordx4 v[168:171], v3, s[8:11], s43 offen offset:2048 sc1
    s_waitcnt lgkmcnt(10)
    v_mfma_f32_32x32x16_bf16 v[56:71], v[100:103], v[128:131], 0
    ds_read_b64_tr_b16 v[124:125], v7 offset:3072
    ds_read_b64_tr_b16 v[126:127], v7 offset:3328
    s_waitcnt vmcnt(13)
    s_waitcnt lgkmcnt(10)
    v_mfma_f32_32x32x16_bf16 v[40:55], v[104:107], v[132:135], v[40:55]
    ds_read_b64_tr_b16 v[96:97], v6 offset:36864
    ds_read_b64_tr_b16 v[98:99], v6 offset:37120
    buffer_load_dwordx4 v[172:175], v3, s[8:11], s43 offen offset:3072 sc1
    s_waitcnt lgkmcnt(10)
    v_mfma_f32_32x32x16_bf16 v[56:71], v[108:111], v[132:135], v[56:71]
    ds_read_b64_tr_b16 v[100:101], v7 offset:4096
    ds_read_b64_tr_b16 v[102:103], v7 offset:4352
    s_waitcnt vmcnt(13)
    s_waitcnt lgkmcnt(10)
    v_mfma_f32_32x32x16_bf16 v[40:55], v[112:115], v[136:139], v[40:55]
    ds_read_b64_tr_b16 v[104:105], v6 offset:37888
    ds_read_b64_tr_b16 v[106:107], v6 offset:38144
    s_add_u32 s43, s55, 12288
    buffer_load_dwordx4 v[176:179], v3, s[8:11], s43 offen offset:0 sc1
    s_waitcnt lgkmcnt(10)
    v_mfma_f32_32x32x16_bf16 v[56:71], v[116:119], v[136:139], v[56:71]
    ds_read_b64_tr_b16 v[108:109], v7 offset:5120
    ds_read_b64_tr_b16 v[110:111], v7 offset:5376
    s_waitcnt vmcnt(13)
    s_waitcnt lgkmcnt(10)
    v_mfma_f32_32x32x16_bf16 v[40:55], v[120:123], v[140:143], v[40:55]
    ds_read_b64_tr_b16 v[112:113], v6 offset:38912
    ds_read_b64_tr_b16 v[114:115], v6 offset:39168
    buffer_load_dwordx4 v[180:183], v3, s[8:11], s43 offen offset:1024 sc1
    s_waitcnt lgkmcnt(10)
    v_mfma_f32_32x32x16_bf16 v[56:71], v[124:127], v[140:143], v[56:71]
    ds_read_b64_tr_b16 v[116:117], v7 offset:6144
    ds_read_b64_tr_b16 v[118:119], v7 offset:6400
    s_waitcnt vmcnt(13)
    s_waitcnt lgkmcnt(10)
    v_mfma_f32_32x32x16_bf16 v[40:55], v[96:99], v[144:147], v[40:55]
    ds_read_b64_tr_b16 v[120:121], v6 offset:39936
    ds_read_b64_tr_b16 v[122:123], v6 offset:40192
    buffer_load_dwordx4 v[184:187], v3, s[8:11], s43 offen offset:2048 sc1
    s_waitcnt lgkmcnt(10)
    v_mfma_f32_32x32x16_bf16 v[56:71], v[100:103], v[144:147], v[56:71]
    ds_read_b64_tr_b16 v[124:125], v7 offset:7168
    ds_read_b64_tr_b16 v[126:127], v7 offset:7424
    s_waitcnt vmcnt(13)
    s_waitcnt lgkmcnt(10)
    v_mfma_f32_32x32x16_bf16 v[40:55], v[104:107], v[148:151], v[40:55]
    ds_read_b64_tr_b16 v[96:97], v6 offset:40960
    ds_read_b64_tr_b16 v[98:99], v6 offset:41216
    buffer_load_dwordx4 v[188:191], v3, s[8:11], s43 offen offset:3072 sc1
    s_waitcnt lgkmcnt(10)
    v_mfma_f32_32x32x16_bf16 v[56:71], v[108:111], v[148:151], v[56:71]
    ds_read_b64_tr_b16 v[100:101], v7 offset:8192
    ds_read_b64_tr_b16 v[102:103], v7 offset:8448
    s_waitcnt vmcnt(9)
    s_waitcnt lgkmcnt(10)
    v_mfma_f32_32x32x16_bf16 v[40:55], v[112:115], v[152:155], v[40:55]
    ds_read_b64_tr_b16 v[104:105], v6 offset:41984
    ds_read_b64_tr_b16 v[106:107], v6 offset:42240
    s_add_u32 s43, s55, 16384
    buffer_load_dwordx4 v[192:195], v3, s[8:11], s43 offen offset:0 sc1
    s_waitcnt lgkmcnt(10)
    v_mfma_f32_32x32x16_bf16 v[56:71], v[116:119], v[152:155], v[56:71]
    ds_read_b64_tr_b16 v[108:109], v7 offset:9216
    ds_read_b64_tr_b16 v[110:111], v7 offset:9472
    s_waitcnt vmcnt(9)
    s_waitcnt lgkmcnt(10)
    v_mfma_f32_32x32x16_bf16 v[40:55], v[120:123], v[156:159], v[40:55]
    ds_read_b64_tr_b16 v[112:113], v6 offset:43008
    ds_read_b64_tr_b16 v[114:115], v6 offset:43264
    buffer_load_dwordx4 v[196:199], v3, s[8:11], s43 offen offset:1024 sc1
    s_waitcnt lgkmcnt(10)
    v_mfma_f32_32x32x16_bf16 v[56:71], v[124:127], v[156:159], v[56:71]
    ds_read_b64_tr_b16 v[116:117], v7 offset:10240
    ds_read_b64_tr_b16 v[118:119], v7 offset:10496
    v_add_f32 v72, v72, v80
    v_add_f32 v73, v73, v81
    v_add_f32 v74, v74, v82
    s_waitcnt vmcnt(9)
    s_waitcnt lgkmcnt(10)
    v_mfma_f32_32x32x16_bf16 v[40:55], v[96:99], v[160:163], v[40:55]
    ds_read_b64_tr_b16 v[120:121], v6 offset:44032
    ds_read_b64_tr_b16 v[122:123], v6 offset:44288
    buffer_load_dwordx4 v[200:203], v3, s[8:11], s43 offen offset:2048 sc1
    s_waitcnt lgkmcnt(10)
    v_mfma_f32_32x32x16_bf16 v[56:71], v[100:103], v[160:163], v[56:71]
    ds_read_b64_tr_b16 v[124:125], v7 offset:11264
    ds_read_b64_tr_b16 v[126:127], v7 offset:11520
    v_add_f32 v75, v75, v83
    v_add_f32 v76, v76, v84
    v_add_f32 v77, v77, v85
    s_waitcnt vmcnt(9)
    s_waitcnt lgkmcnt(10)
    v_mfma_f32_32x32x16_bf16 v[40:55], v[104:107], v[164:167], v[40:55]
    ds_read_b64_tr_b16 v[96:97], v6 offset:45056
    ds_read_b64_tr_b16 v[98:99], v6 offset:45312
    buffer_load_dwordx4 v[204:207], v3, s[8:11], s43 offen offset:3072 sc1
    s_waitcnt lgkmcnt(10)
    v_mfma_f32_32x32x16_bf16 v[56:71], v[108:111], v[164:167], v[56:71]
    ds_read_b64_tr_b16 v[100:101], v7 offset:12288
    ds_read_b64_tr_b16 v[102:103], v7 offset:12544
    v_add_f32 v78, v78, v86
    v_add_f32 v79, v79, v87
    v_add_f32 v72, v72, v76
    s_waitcnt vmcnt(9)
    s_waitcnt lgkmcnt(10)
    v_mfma_f32_32x32x16_bf16 v[40:55], v[112:115], v[168:171], v[40:55]
    ds_read_b64_tr_b16 v[104:105], v6 offset:46080
    ds_read_b64_tr_b16 v[106:107], v6 offset:46336
    s_add_u32 s43, s55, 20480
    buffer_load_dwordx4 v[208:211], v3, s[8:11], s43 offen offset:0 sc1
    s_waitcnt lgkmcnt(10)
    v_mfma_f32_32x32x16_bf16 v[56:71], v[116:119], v[168:171], v[56:71]
    ds_read_b64_tr_b16 v[108:109], v7 offset:13312
    ds_read_b64_tr_b16 v[110:111], v7 offset:13568
    v_add_f32 v73, v73, v77
    v_add_f32 v74, v74, v78
    v_add_f32 v75, v75, v79
    s_waitcnt vmcnt(9)
    s_waitcnt lgkmcnt(10)
    v_mfma_f32_32x32x16_bf16 v[40:55], v[120:123], v[172:175], v[40:55]
    ds_read_b64_tr_b16 v[112:113], v6 offset:47104
    ds_read_b64_tr_b16 v[114:115], v6 offset:47360
    buffer_load_dwordx4 v[212:215], v3, s[8:11], s43 offen offset:1024 sc1
    s_waitcnt lgkmcnt(10)
    v_mfma_f32_32x32x16_bf16 v[56:71], v[124:127], v[172:175], v[56:71]
    ds_read_b64_tr_b16 v[116:117], v7 offset:14336
    ds_read_b64_tr_b16 v[118:119], v7 offset:14592
    v_add_f32 v72, v72, v74
    v_add_f32 v73, v73, v75
    v_add_f32 v72, v72, v73
    s_waitcnt vmcnt(9)
    s_waitcnt lgkmcnt(10)
    v_mfma_f32_32x32x16_bf16 v[40:55], v[96:99], v[176:179], v[40:55]
    ds_read_b64_tr_b16 v[120:121], v6 offset:48128
    ds_read_b64_tr_b16 v[122:123], v6 offset:48384
    buffer_load_dwordx4 v[216:219], v3, s[8:11], s43 offen offset:2048 sc1
    s_waitcnt lgkmcnt(10)
    v_mfma_f32_32x32x16_bf16 v[56:71], v[100:103], v[176:179], v[56:71]
    ds_read_b64_tr_b16 v[124:125], v7 offset:15360
    ds_read_b64_tr_b16 v[126:127], v7 offset:15616
    v_mov_b32 v73, v72
    s_nop 1
    v_permlane32_swap_b32 v72, v73
    s_nop 1
    s_waitcnt vmcnt(9)
    s_waitcnt lgkmcnt(10)
    v_mfma_f32_32x32x16_bf16 v[40:55], v[104:107], v[180:183], v[40:55]
    ds_read_b64_tr_b16 v[96:97], v6 offset:49152
    ds_read_b64_tr_b16 v[98:99], v6 offset:49408
    buffer_load_dwordx4 v[220:223], v3, s[8:11], s43 offen offset:3072 sc1
    s_waitcnt lgkmcnt(10)
    v_mfma_f32_32x32x16_bf16 v[56:71], v[108:111], v[180:183], v[56:71]
    ds_read_b64_tr_b16 v[100:101], v7 offset:16384
    ds_read_b64_tr_b16 v[102:103], v7 offset:16640
    v_mul_f32 v72, 0xbb000000, v72
    v_mul_f32 v73, 0x3b000000, v73
    v_fma_f32 v73, -v72, v72, v73
    s_waitcnt vmcnt(9)
    s_waitcnt lgkmcnt(10)
    v_mfma_f32_32x32x16_bf16 v[40:55], v[112:115], v[184:187], v[40:55]
    ds_read_b64_tr_b16 v[104:105], v6 offset:50176
    ds_read_b64_tr_b16 v[106:107], v6 offset:50432
    s_add_u32 s43, s55, 24576
    buffer_load_dwordx4 v[224:227], v3, s[8:11], s43 offen offset:0 sc1
    s_waitcnt lgkmcnt(10)
    v_mfma_f32_32x32x16_bf16 v[56:71], v[116:119], v[184:187], v[56:71]
    ds_read_b64_tr_b16 v[108:109], v7 offset:17408
    ds_read_b64_tr_b16 v[110:111], v7 offset:17664
    v_max_f32 v73, 0, v73
    v_add_f32 v73, 0x3727c5ac, v73
    v_rsq_f32 v10, v73
    s_waitcnt vmcnt(9)
    s_waitcnt lgkmcnt(10)
    v_mfma_f32_32x32x16_bf16 v[40:55], v[120:123], v[188:191], v[40:55]
    ds_read_b64_tr_b16 v[112:113], v6 offset:51200
    ds_read_b64_tr_b16 v[114:115], v6 offset:51456
    buffer_load_dwordx4 v[228:231], v3, s[8:11], s43 offen offset:1024 sc1
    s_waitcnt lgkmcnt(10)
    v_mfma_f32_32x32x16_bf16 v[56:71], v[124:127], v[188:191], v[56:71]
    ds_read_b64_tr_b16 v[116:117], v7 offset:18432
    ds_read_b64_tr_b16 v[118:119], v7 offset:18688
    v_sqrt_f32 v11, v73
    v_cvt_pk_bf16_f32 v16, v72, v72
    v_and_b32 v74, 0xffff0000, v16
    s_waitcnt vmcnt(9)
    s_waitcnt lgkmcnt(10)
    v_mfma_f32_32x32x16_bf16 v[40:55], v[96:99], v[192:195], v[40:55]
    ds_read_b64_tr_b16 v[120:121], v6 offset:52224
    ds_read_b64_tr_b16 v[122:123], v6 offset:52480
    buffer_load_dwordx4 v[232:235], v3, s[8:11], s43 offen offset:2048 sc1
    s_waitcnt lgkmcnt(10)
    v_mfma_f32_32x32x16_bf16 v[56:71], v[100:103], v[192:195], v[56:71]
    ds_read_b64_tr_b16 v[124:125], v7 offset:19456
    ds_read_b64_tr_b16 v[126:127], v7 offset:19712
    v_sub_f32 v74, v72, v74
    v_mov_b32 v75, 0
    v_cvt_pk_bf16_f32 v17, v74, v75
    s_waitcnt vmcnt(9)
    s_waitcnt lgkmcnt(10)
    v_mfma_f32_32x32x16_bf16 v[40:55], v[104:107], v[196:199], v[40:55]
    ds_read_b64_tr_b16 v[96:97], v6 offset:53248
    ds_read_b64_tr_b16 v[98:99], v6 offset:53504
    buffer_load_dwordx4 v[236:239], v3, s[8:11], s43 offen offset:3072 sc1
    s_waitcnt lgkmcnt(10)
    v_mfma_f32_32x32x16_bf16 v[56:71], v[108:111], v[196:199], v[56:71]
    ds_read_b64_tr_b16 v[100:101], v7 offset:20480
    ds_read_b64_tr_b16 v[102:103], v7 offset:20736
    v_cndmask_b32_e64 v16, 0, v16, s[62:63]
    v_cndmask_b32_e64 v17, 0, v17, s[62:63]
    v_mul_f32 v12, 0xbfb8aa3b, v10
    s_waitcnt vmcnt(9)
    s_waitcnt lgkmcnt(10)
    v_mfma_f32_32x32x16_bf16 v[40:55], v[112:115], v[200:203], v[40:55]
    ds_read_b64_tr_b16 v[104:105], v6 offset:54272
    ds_read_b64_tr_b16 v[106:107], v6 offset:54528
    s_add_u32 s43, s55, 28672
    buffer_load_dwordx4 v[240:243], v3, s[8:11], s43 offen offset:0 sc1
    s_waitcnt lgkmcnt(10)
    v_mfma_f32_32x32x16_bf16 v[56:71], v[116:119], v[200:203], v[56:71]
    ds_read_b64_tr_b16 v[108:109], v7 offset:21504
    ds_read_b64_tr_b16 v[110:111], v7 offset:21760
    s_waitcnt vmcnt(9)
    s_waitcnt lgkmcnt(10)
    v_mfma_f32_32x32x16_bf16 v[40:55], v[120:123], v[204:207], v[40:55]
    ds_read_b64_tr_b16 v[112:113], v6 offset:55296
    ds_read_b64_tr_b16 v[114:115], v6 offset:55552
    buffer_load_dwordx4 v[244:247], v3, s[8:11], s43 offen offset:1024 sc1
    s_waitcnt lgkmcnt(10)
    v_mfma_f32_32x32x16_bf16 v[56:71], v[124:127], v[204:207], v[56:71]
    ds_read_b64_tr_b16 v[116:117], v7 offset:22528
    ds_read_b64_tr_b16 v[118:119], v7 offset:22784
    v_add_u32 v13, 2, v9
    ds_write_b32 v0, v13
    s_waitcnt vmcnt(9)
    s_waitcnt lgkmcnt(11)
    v_mfma_f32_32x32x16_bf16 v[40:55], v[96:99], v[208:211], v[40:55]
    ds_read_b64_tr_b16 v[120:121], v6 offset:56320
    ds_read_b64_tr_b16 v[122:123], v6 offset:56576
    buffer_load_dwordx4 v[248:251], v3, s[8:11], s43 offen offset:2048 sc1
    s_waitcnt lgkmcnt(11)
    v_mfma_f32_32x32x16_bf16 v[56:71], v[100:103], v[208:211], v[56:71]
    ds_read_b64_tr_b16 v[124:125], v7 offset:23552
    ds_read_b64_tr_b16 v[126:127], v7 offset:23808
    s_waitcnt vmcnt(9)
    s_waitcnt lgkmcnt(11)
    v_mfma_f32_32x32x16_bf16 v[40:55], v[104:107], v[212:215], v[40:55]
    ds_read_b64_tr_b16 v[96:97], v6 offset:57344
    ds_read_b64_tr_b16 v[98:99], v6 offset:57600
    buffer_load_dwordx4 v[252:255], v3, s[8:11], s43 offen offset:3072 sc1
    s_waitcnt lgkmcnt(11)
    v_mfma_f32_32x32x16_bf16 v[56:71], v[108:111], v[212:215], v[56:71]
    ds_read_b64_tr_b16 v[100:101], v7 offset:24576
    ds_read_b64_tr_b16 v[102:103], v7 offset:24832
    s_waitcnt vmcnt(9)
    s_waitcnt lgkmcnt(11)
    v_mfma_f32_32x32x16_bf16 v[40:55], v[112:115], v[216:219], v[40:55]
    ds_read_b64_tr_b16 v[104:105], v6 offset:58368
    ds_read_b64_tr_b16 v[106:107], v6 offset:58624
    s_waitcnt lgkmcnt(11)
    v_mfma_f32_32x32x16_bf16 v[56:71], v[116:119], v[216:219], v[56:71]
    ds_read_b64_tr_b16 v[108:109], v7 offset:25600
    ds_read_b64_tr_b16 v[110:111], v7 offset:25856
    s_waitcnt vmcnt(8)
    s_waitcnt lgkmcnt(10)
    v_mfma_f32_32x32x16_bf16 v[40:55], v[120:123], v[220:223], v[40:55]
    ds_read_b64_tr_b16 v[112:113], v6 offset:59392
    ds_read_b64_tr_b16 v[114:115], v6 offset:59648
    s_waitcnt lgkmcnt(10)
    v_mfma_f32_32x32x16_bf16 v[56:71], v[124:127], v[220:223], v[56:71]
    ds_read_b64_tr_b16 v[116:117], v7 offset:26624
    ds_read_b64_tr_b16 v[118:119], v7 offset:26880
    s_waitcnt vmcnt(7)
    s_waitcnt lgkmcnt(10)
    v_mfma_f32_32x32x16_bf16 v[40:55], v[96:99], v[224:227], v[40:55]
    ds_read_b64_tr_b16 v[120:121], v6 offset:60416
    ds_read_b64_tr_b16 v[122:123], v6 offset:60672
    s_waitcnt lgkmcnt(10)
    v_mfma_f32_32x32x16_bf16 v[56:71], v[100:103], v[224:227], v[56:71]
    ds_read_b64_tr_b16 v[124:125], v7 offset:27648
    ds_read_b64_tr_b16 v[126:127], v7 offset:27904
    s_waitcnt vmcnt(6)
    s_waitcnt lgkmcnt(10)
    v_mfma_f32_32x32x16_bf16 v[40:55], v[104:107], v[228:231], v[40:55]
    ds_read_b64_tr_b16 v[96:97], v6 offset:61440
    ds_read_b64_tr_b16 v[98:99], v6 offset:61696
    s_waitcnt lgkmcnt(10)
    v_mfma_f32_32x32x16_bf16 v[56:71], v[108:111], v[228:231], v[56:71]
    ds_read_b64_tr_b16 v[100:101], v7 offset:28672
    ds_read_b64_tr_b16 v[102:103], v7 offset:28928
    s_waitcnt vmcnt(5)
    s_waitcnt lgkmcnt(10)
    v_mfma_f32_32x32x16_bf16 v[40:55], v[112:115], v[232:235], v[40:55]
    ds_read_b64_tr_b16 v[104:105], v6 offset:62464
    ds_read_b64_tr_b16 v[106:107], v6 offset:62720
    s_waitcnt lgkmcnt(10)
    v_mfma_f32_32x32x16_bf16 v[56:71], v[116:119], v[232:235], v[56:71]
    ds_read_b64_tr_b16 v[108:109], v7 offset:29696
    ds_read_b64_tr_b16 v[110:111], v7 offset:29952
    s_waitcnt vmcnt(4)
    s_waitcnt lgkmcnt(10)
    v_mfma_f32_32x32x16_bf16 v[40:55], v[120:123], v[236:239], v[40:55]
    ds_read_b64_tr_b16 v[112:113], v6 offset:63488
    ds_read_b64_tr_b16 v[114:115], v6 offset:63744
    s_waitcnt lgkmcnt(10)
    v_mfma_f32_32x32x16_bf16 v[56:71], v[124:127], v[236:239], v[56:71]
    ds_read_b64_tr_b16 v[116:117], v7 offset:30720
    ds_read_b64_tr_b16 v[118:119], v7 offset:30976
    s_waitcnt vmcnt(3)
    s_waitcnt lgkmcnt(10)
    v_mfma_f32_32x32x16_bf16 v[40:55], v[96:99], v[240:243], v[40:55]
    ds_read_b64_tr_b16 v[120:121], v6 offset:64512
    ds_read_b64_tr_b16 v[122:123], v6 offset:64768
    s_waitcnt lgkmcnt(10)
    v_mfma_f32_32x32x16_bf16 v[56:71], v[100:103], v[240:243], v[56:71]
    ds_read_b64_tr_b16 v[124:125], v7 offset:31744
    ds_read_b64_tr_b16 v[126:127], v7 offset:32000
    v_add_u32 v13, 3, v9
    ds_write_b32 v0, v13
    s_waitcnt vmcnt(2)
    s_waitcnt lgkmcnt(11)
    v_mfma_f32_32x32x16_bf16 v[40:55], v[104:107], v[244:247], v[40:55]
    ds_read_b64 v[96:97], v22 offset:256
    ds_read_b64 v[100:101], v22 offset:512
    s_waitcnt lgkmcnt(11)
    v_mfma_f32_32x32x16_bf16 v[56:71], v[108:111], v[244:247], v[56:71]
    s_waitcnt vmcnt(1)
    s_waitcnt lgkmcnt(9)
    v_mfma_f32_32x32x16_bf16 v[40:55], v[112:115], v[248:251], v[40:55]
    s_waitcnt lgkmcnt(7)
    v_mfma_f32_32x32x16_bf16 v[56:71], v[116:119], v[248:251], v[56:71]
    s_waitcnt vmcnt(0)
    s_waitcnt lgkmcnt(5)
    v_mfma_f32_32x32x16_bf16 v[40:55], v[120:123], v[252:255], v[40:55]
    s_waitcnt lgkmcnt(3)
    v_mfma_f32_32x32x16_bf16 v[56:71], v[124:127], v[252:255], v[56:71]
    s_waitcnt lgkmcnt(1)
    v_mfma_f32_32x32x16_bf16 v[40:55], v[96:99], v[16:19], v[40:55]
    s_waitcnt lgkmcnt(0)
    v_mfma_f32_32x32x16_bf16 v[56:71], v[100:103], v[16:19], v[56:71]
L_c_go:
    ds_read_b32 v1, v35 offset:0
    s_lshl_b32 s58, s27, 4
    s_add_u32 s58, s58, s17
    s_mul_i32 s58, s58, 7168
    s_add_u32 s58, s58, 8390656
    s_add_u32 s40, s25, 118784
    v_add_u32 v23, s40, v3
    v_lshlrev_b32 v88, 3, v2
    v_add_u32 v88, 4096, v88
    v_mov_b32 v90, s4
    v_mov_b32 v91, s5
    v_mul_f32 v40, v10, v40
    v_mul_f32 v41, v10, v41
    v_mul_f32 v42, v10, v42
    v_mul_f32 v43, v10, v43
    v_mul_f32 v44, v10, v44
    v_mul_f32 v45, v10, v45
    v_mul_f32 v46, v10, v46
    v_mul_f32 v47, v10, v47
    v_cvt_pk_bf16_f32 v40, v40, v41
    v_cvt_pk_bf16_f32 v41, v42, v43
    v_cvt_pk_bf16_f32 v42, v44, v45
    v_cvt_pk_bf16_f32 v43, v46, v47
    buffer_store_dwordx4 v[40:43], v3, s[8:11], s58 offen offset:0 sc1
    v_bitop3_b32 v90, v90, v40, v41 bitop3:0x96
    v_bitop3_b32 v90, v90, v42, v43 bitop3:0x96
    s_waitcnt lgkmcnt(0)
    s_add_u32 s39, s7, 6
    v_cmp_gt_u32 s[30:31], s39, v1
    s_nop 0
    s_cmp_eq_u64 s[30:31], 0
    s_cbranch_scc1 L16
    v_mul_f32 v48, v10, v48
    v_mul_f32 v49, v10, v49
    v_mul_f32 v50, v10, v50
    v_mul_f32 v51, v10, v51
    v_mul_f32 v52, v10, v52
    v_mul_f32 v53, v10, v53
    v_mul_f32 v54, v10, v54
    v_mul_f32 v55, v10, v55
    v_cvt_pk_bf16_f32 v44, v48, v49
    v_cvt_pk_bf16_f32 v45, v50, v51
    v_cvt_pk_bf16_f32 v46, v52, v53
    v_cvt_pk_bf16_f32 v47, v54, v55
    buffer_store_dwordx4 v[44:47], v3, s[8:11], s58 offen offset:1024 sc1
    v_bitop3_b32 v90, v90, v44, v45 bitop3:0x96
    v_bitop3_b32 v90, v90, v46, v47 bitop3:0x96
    v_mul_f32 v56, v10, v56
    v_mul_f32 v57, v10, v57
    v_mul_f32 v58, v10, v58
    v_mul_f32 v59, v10, v59
    v_mul_f32 v60, v10, v60
    v_mul_f32 v61, v10, v61
    v_mul_f32 v62, v10, v62
    v_mul_f32 v63, v10, v63
    v_cvt_pk_bf16_f32 v56, v56, v57
    v_cvt_pk_bf16_f32 v57, v58, v59
    v_cvt_pk_bf16_f32 v58, v60, v61
    v_cvt_pk_bf16_f32 v59, v62, v63
    buffer_store_dwordx4 v[56:59], v3, s[8:11], s58 offen offset:2048 sc1
    v_bitop3_b32 v90, v90, v56, v57 bitop3:0x96
    v_bitop3_b32 v90, v90, v58, v59 bitop3:0x96
    v_mul_f32 v64, v10, v64
    v_mul_f32 v65, v10, v65
    v_mul_f32 v66, v10, v66
    v_mul_f32 v67, v10, v67
    v_mul_f32 v68, v10, v68
    v_mul_f32 v69, v10, v69
    v_mul_f32 v70, v10, v70
    v_mul_f32 v71, v10, v71
    v_cvt_pk_bf16_f32 v60, v64, v65
    v_cvt_pk_bf16_f32 v61, v66, v67
    v_cvt_pk_bf16_f32 v62, v68, v69
    v_cvt_pk_bf16_f32 v63, v70, v71
    buffer_store_dwordx4 v[60:63], v3, s[8:11], s58 offen offset:3072 sc1
    v_bitop3_b32 v90, v90, v60, v61 bitop3:0x96
    v_bitop3_b32 v90, v90, v62, v63 bitop3:0x96
    buffer_store_dwordx2 v[90:91], v88, s[8:11], s58 offen sc1
    s_cmp_eq_u64 s[30:31], 0
    s_cbranch_scc1 L18
L17:
    s_add_u32 s38, s38, 1
    s_cmp_gt_u32 s38, 6400000
    s_cbranch_scc1 L18
    ds_read_b32 v1, v35 offset:0
    s_waitcnt lgkmcnt(0)
    v_cmp_gt_u32 vcc, s39, v1
    s_cbranch_vccnz L17
L18:
    s_mov_b64 s[30:31], -1
L16:
    s_lshl_b32 s36, s16, 11
    s_lshl_b32 s41, s17, 7
    s_add_u32 s36, s36, s41
    s_lshl_b32 s41, s6, 2
    s_add_u32 s36, s36, s41
    s_add_u32 s36, s36, 1720320
    ds_read_b64_tr_b16 v[104:105], v6 offset:19456
    ds_read_b64_tr_b16 v[106:107], v6 offset:19712
    ds_read_b64_tr_b16 v[108:109], v6 offset:20480
    ds_read_b64_tr_b16 v[110:111], v6 offset:20736
    ds_read_b64_tr_b16 v[112:113], v6 offset:21504
    ds_read_b64_tr_b16 v[114:115], v6 offset:21760
    ds_read_b64_tr_b16 v[116:117], v6 offset:22528
    ds_read_b64_tr_b16 v[118:119], v6 offset:22784
    ds_read_b64_tr_b16 v[120:121], v6 offset:2048
    ds_read_b64_tr_b16 v[122:123], v6 offset:2304
    s_cmp_lg_u64 s[30:31], 0
    s_cbranch_scc1 L20
    v_mul_f32 v48, v10, v48
    v_mul_f32 v49, v10, v49
    v_mul_f32 v50, v10, v50
    v_mul_f32 v51, v10, v51
    v_mul_f32 v52, v10, v52
    v_mul_f32 v53, v10, v53
    v_mul_f32 v54, v10, v54
    v_mul_f32 v55, v10, v55
    v_cvt_pk_bf16_f32 v44, v48, v49
    v_cvt_pk_bf16_f32 v45, v50, v51
    v_cvt_pk_bf16_f32 v46, v52, v53
    v_cvt_pk_bf16_f32 v47, v54, v55
    buffer_store_dwordx4 v[44:47], v3, s[8:11], s58 offen offset:1024 sc1
    v_bitop3_b32 v90, v90, v44, v45 bitop3:0x96
    v_bitop3_b32 v90, v90, v46, v47 bitop3:0x96
    v_mul_f32 v56, v10, v56
    v_mul_f32 v57, v10, v57
    v_mul_f32 v58, v10, v58
    v_mul_f32 v59, v10, v59
    v_mul_f32 v60, v10, v60
    v_mul_f32 v61, v10, v61
    v_mul_f32 v62, v10, v62
    v_mul_f32 v63, v10, v63
    v_cvt_pk_bf16_f32 v56, v56, v57
    v_cvt_pk_bf16_f32 v57, v58, v59
    v_cvt_pk_bf16_f32 v58, v60, v61
    v_cvt_pk_bf16_f32 v59, v62, v63
    buffer_store_dwordx4 v[56:59], v3, s[8:11], s58 offen offset:2048 sc1
    v_bitop3_b32 v90, v90, v56, v57 bitop3:0x96
    v_bitop3_b32 v90, v90, v58, v59 bitop3:0x96
    v_mul_f32 v64, v10, v64
    v_mul_f32 v65, v10, v65
    v_mul_f32 v66, v10, v66
    v_mul_f32 v67, v10, v67
    v_mul_f32 v68, v10, v68
    v_mul_f32 v69, v10, v69
    v_mul_f32 v70, v10, v70
    v_mul_f32 v71, v10, v71
    v_cvt_pk_bf16_f32 v60, v64, v65
    v_cvt_pk_bf16_f32 v61, v66, v67
    v_cvt_pk_bf16_f32 v62, v68, v69
    v_cvt_pk_bf16_f32 v63, v70, v71
    buffer_store_dwordx4 v[60:63], v3, s[8:11], s58 offen offset:3072 sc1
    v_bitop3_b32 v90, v90, v60, v61 bitop3:0x96
    v_bitop3_b32 v90, v90, v62, v63 bitop3:0x96
    buffer_store_dwordx2 v[90:91], v88, s[8:11], s58 offen sc1
L20:
    s_waitcnt lgkmcnt(8)
    v_mfma_f32_32x32x16_bf16 v[72:87], v[104:107], v[204:207], 0
    ds_read_b64_tr_b16 v[124:125], v6 offset:3072
    ds_read_b64_tr_b16 v[126:127], v6 offset:3328
    ds_write_b128 v23, v[40:43] offset:0
    ds_write_b128 v23, v[56:59] offset:12288
    ds_write_b128 v23, v[44:47] offset:24576
    ds_write_b128 v23, v[60:63] offset:36864
    s_waitcnt lgkmcnt(12)
    v_mfma_f32_32x32x16_bf16 v[72:87], v[108:111], v[208:211], v[72:87]
    ds_read_b64_tr_b16 v[96:97], v6 offset:4096
    ds_read_b64_tr_b16 v[98:99], v6 offset:4352
    v_add_u32 v37, 159744, v3
    v_mov_b32 v92, v16
    v_mov_b32 v93, v17
    v_mov_b32 v94, v16
    s_waitcnt lgkmcnt(12)
    v_mfma_f32_32x32x16_bf16 v[72:87], v[112:115], v[212:215], v[72:87]
    ds_read_b64_tr_b16 v[100:101], v6 offset:5120
    ds_read_b64_tr_b16 v[102:103], v6 offset:5376
    v_mov_b32 v95, v17
    v_permlane32_swap_b32 v92, v94
    s_nop 0
    v_permlane32_swap_b32 v93, v95
    s_nop 0
    v_mov_b32 v94, v92
    s_waitcnt lgkmcnt(12)
    v_mfma_f32_32x32x16_bf16 v[72:87], v[116:119], v[216:219], v[72:87]
    ds_read_b64_tr_b16 v[104:105], v6 offset:6144
    ds_read_b64_tr_b16 v[106:107], v6 offset:6400
    v_mov_b32 v95, v93
    v_mov_b32 v36, 163488
    ds_read_b32 v36, v36
    v_mul_f32 v12, 0x3eb8aa3b, v10
    s_waitcnt lgkmcnt(13)
    v_mfma_f32_32x32x16_bf16 v[72:87], v[120:123], v[136:139], v[72:87]
    ds_read_b64_tr_b16 v[108:109], v6 offset:7168
    ds_read_b64_tr_b16 v[110:111], v6 offset:7424
    v_and_b32 v48, 31, v2
    v_lshrrev_b32 v49, 5, v2
    v_and_b32 v65, 0x13, v48
    v_bfe_u32 v50, v48, 2, 1
    s_waitcnt lgkmcnt(13)
    v_mfma_f32_32x32x16_bf16 v[72:87], v[124:127], v[140:143], v[72:87]
    ds_read_b64_tr_b16 v[112:113], v6 offset:9216
    ds_read_b64_tr_b16 v[114:115], v6 offset:9472
    v_lshl_add_u32 v65, v50, 3, v65
    v_bfe_u32 v50, v48, 3, 1
    v_lshl_add_u32 v65, v50, 2, v65
    v_lshlrev_b32 v65, 4, v65
    s_waitcnt lgkmcnt(9)
    v_mfma_f32_32x32x16_bf16 v[72:87], v[96:99], v[144:147], v[72:87]
    ds_read_b64_tr_b16 v[116:117], v6 offset:10240
    ds_read_b64_tr_b16 v[118:119], v6 offset:10496
    v_lshl_add_u32 v65, v49, 9, v65
    s_add_u32 s41, s25, 110592
    v_add_u32 v65, s41, v65
    s_waitcnt lgkmcnt(9)
    v_mfma_f32_32x32x16_bf16 v[72:87], v[100:103], v[148:151], v[72:87]
    ds_read_b64_tr_b16 v[120:121], v6 offset:0
    ds_read_b64_tr_b16 v[122:123], v6 offset:256
    s_waitcnt lgkmcnt(9)
    v_mfma_f32_32x32x16_bf16 v[72:87], v[104:107], v[152:155], v[72:87]
    ds_read_b64_tr_b16 v[124:125], v6 offset:1024
    ds_read_b64_tr_b16 v[126:127], v6 offset:1280
    s_waitcnt lgkmcnt(8)
    v_mfma_f32_32x32x16_bf16 v[72:87], v[108:111], v[156:159], v[72:87]
    ds_read_b64_tr_b16 v[96:97], v6 offset:8192
    ds_read_b64_tr_b16 v[98:99], v6 offset:8448
    s_waitcnt lgkmcnt(8)
    v_mfma_f32_32x32x16_bf16 v[72:87], v[112:115], v[164:167], v[72:87]
    ds_read_b64_tr_b16 v[100:101], v6 offset:11264
    ds_read_b64_tr_b16 v[102:103], v6 offset:11520
    s_waitcnt lgkmcnt(8)
    v_mfma_f32_32x32x16_bf16 v[72:87], v[116:119], v[168:171], v[72:87]
    ds_read_b64_tr_b16 v[104:105], v6 offset:12288
    ds_read_b64_tr_b16 v[106:107], v6 offset:12544
    v_add_u32 v13, 4, v9
    ds_write_b32 v0, v13
    s_waitcnt lgkmcnt(9)
    v_mfma_f32_32x32x16_bf16 v[72:87], v[120:123], v[128:131], v[72:87]
    ds_read_b64_tr_b16 v[108:109], v6 offset:13312
    ds_read_b64_tr_b16 v[110:111], v6 offset:13568
    ds_read_b128 v[168:171], v65 offset:8192
    ds_read_b128 v[164:167], v65 offset:32768
    v_bfe_u32 v50, v2, 2, 2
    v_lshl_add_u32 v50, v49, 3, v50
    s_waitcnt lgkmcnt(11)
    v_mfma_f32_32x32x16_bf16 v[72:87], v[124:127], v[132:135], v[72:87]
    ds_read_b64_tr_b16 v[112:113], v6 offset:14336
    ds_read_b64_tr_b16 v[114:115], v6 offset:14592
    v_lshlrev_b32 v50, 4, v50
    v_and_b32 v51, 1, v2
    v_lshl_add_u32 v50, v51, 9, v50
    v_bfe_u32 v51, v2, 1, 1
    s_waitcnt lgkmcnt(11)
    v_mfma_f32_32x32x16_bf16 v[72:87], v[96:99], v[160:163], v[72:87]
    ds_read_b64_tr_b16 v[116:117], v6 offset:15360
    ds_read_b64_tr_b16 v[118:119], v6 offset:15616
    v_lshl_add_u32 v50, v51, 3, v50
    s_add_u32 s41, s25, 122880
    v_add_u32 v50, s41, v50
    v_bfe_u32 v51, v2, 4, 1
    v_xor_b32 v52, 1, v51
    s_waitcnt lgkmcnt(11)
    v_mfma_f32_32x32x16_bf16 v[72:87], v[100:103], v[172:175], v[72:87]
    ds_read_b64_tr_b16 v[120:121], v6 offset:16384
    ds_read_b64_tr_b16 v[122:123], v6 offset:16640
    v_mul_u32_u24 v66, 24576, v52
    v_mul_u32_u24 v56, v50, v52
    v_mul_u32_u24 v50, 163072, v51
    v_add_u32 v56, v56, v50
    s_waitcnt lgkmcnt(11)
    v_mfma_f32_32x32x16_bf16 v[72:87], v[104:107], v[176:179], v[72:87]
    ds_read_b64_tr_b16 v[124:125], v6 offset:17408
    ds_read_b64_tr_b16 v[126:127], v6 offset:17664
    v_lshlrev_b32 v52, 10, v52
    v_add_u32 v57, v52, v56
    v_add_u32 v58, v52, v57
    v_add_u32 v59, v52, v58
    s_waitcnt lgkmcnt(10)
    v_mfma_f32_32x32x16_bf16 v[72:87], v[108:111], v[180:183], v[72:87]
    ds_read_b64_tr_b16 v[96:97], v6 offset:18432
    ds_read_b64_tr_b16 v[98:99], v6 offset:18688
    v_add_u32 v60, v52, v59
    v_add_u32 v61, v52, v60
    v_add_u32 v62, v52, v61
    v_add_u32 v63, v52, v62
    s_waitcnt lgkmcnt(8)
    v_mfma_f32_32x32x16_bf16 v[72:87], v[112:115], v[184:187], v[72:87]
    ds_read_b64_tr_b16 v[100:101], v6 offset:23552
    ds_read_b64_tr_b16 v[102:103], v6 offset:23808
    v_add_u32 v64, v52, v63
    s_cmp_ge_u32 s27, 8
    s_cbranch_scc1 L19
    s_sub_i32 s42, 8, s27
    v_lshlrev_b32 v51, 3, v51
    s_cmp_gt_i32 s42, 0
    s_cselect_b32 s41, -1, 0
    v_and_b32 v50, s41, v51
    v_add_u32 v56, v50, v56
    s_cmp_gt_i32 s42, 1
    s_cselect_b32 s41, -1, 0
    v_and_b32 v50, s41, v51
    v_add_u32 v57, v50, v57
    s_cmp_gt_i32 s42, 2
    s_cselect_b32 s41, -1, 0
    v_and_b32 v50, s41, v51
    v_add_u32 v58, v50, v58
    s_cmp_gt_i32 s42, 3
    s_cselect_b32 s41, -1, 0
    v_and_b32 v50, s41, v51
    v_add_u32 v59, v50, v59
    s_cmp_gt_i32 s42, 4
    s_cselect_b32 s41, -1, 0
    v_and_b32 v50, s41, v51
    v_add_u32 v60, v50, v60
    s_cmp_gt_i32 s42, 5
    s_cselect_b32 s41, -1, 0
    v_and_b32 v50, s41, v51
    v_add_u32 v61, v50, v61
    s_cmp_gt_i32 s42, 6
    s_cselect_b32 s41, -1, 0
    v_and_b32 v50, s41, v51
    v_add_u32 v62, v50, v62
    s_cmp_gt_i32 s42, 7
    s_cselect_b32 s41, -1, 0
    v_and_b32 v50, s41, v51
    v_add_u32 v63, v50, v63
L19:
    v_mov_b32 v48, 0xffff
    v_mov_b32 v49, 0xffff0000
    s_waitcnt lgkmcnt(8)
    v_mfma_f32_32x32x16_bf16 v[72:87], v[116:119], v[188:191], v[72:87]
    ds_read_b64_tr_b16 v[104:105], v6 offset:24576
    ds_read_b64_tr_b16 v[106:107], v6 offset:24832
    v_cndmask_b32_e64 v50, v48, 0, s[64:65]
    v_cndmask_b32_e64 v51, v49, 0, s[66:67]
    v_or_b32 v40, v50, v51
    v_cndmask_b32_e64 v50, v48, 0, s[68:69]
    s_waitcnt lgkmcnt(8)
    v_mfma_f32_32x32x16_bf16 v[72:87], v[120:123], v[192:195], v[72:87]
    ds_read_b64_tr_b16 v[108:109], v6 offset:25600
    ds_read_b64_tr_b16 v[110:111], v6 offset:25856
    v_cndmask_b32_e64 v51, v49, 0, s[70:71]
    v_or_b32 v41, v50, v51
    v_cndmask_b32_e64 v50, v48, 0, s[72:73]
    v_cndmask_b32_e64 v51, v49, 0, s[74:75]
    s_waitcnt lgkmcnt(8)
    v_mfma_f32_32x32x16_bf16 v[72:87], v[124:127], v[196:199], v[72:87]
    ds_read_b64_tr_b16 v[112:113], v6 offset:26624
    ds_read_b64_tr_b16 v[114:115], v6 offset:26880
    v_or_b32 v42, v50, v51
    v_cndmask_b32_e64 v50, v48, 0, s[76:77]
    v_cndmask_b32_e64 v51, v49, 0, s[78:79]
    v_or_b32 v43, v50, v51
    s_waitcnt lgkmcnt(8)
    v_mfma_f32_32x32x16_bf16 v[72:87], v[96:99], v[200:203], v[72:87]
    ds_read_b32 v1, v35 offset:0
    ds_read_b64_tr_b16 v[116:117], v6 offset:27648
    ds_read_b64_tr_b16 v[118:119], v6 offset:27904
    v_cndmask_b32_e64 v50, v48, 0, s[80:81]
    v_cndmask_b32_e64 v51, v49, 0, s[82:83]
    v_or_b32 v44, v50, v51
    v_cndmask_b32_e64 v50, v48, 0, s[84:85]
    s_waitcnt lgkmcnt(9)
    v_mfma_f32_32x32x16_bf16 v[72:87], v[100:103], v[220:223], v[72:87]
    ds_read_b64_tr_b16 v[120:121], v6 offset:28672
    ds_read_b64_tr_b16 v[122:123], v6 offset:28928
    v_cndmask_b32_e64 v51, v49, 0, s[86:87]
    v_or_b32 v45, v50, v51
    v_cndmask_b32_e64 v50, v48, 0, s[88:89]
    v_cndmask_b32_e64 v51, v49, 0, s[90:91]
    s_waitcnt lgkmcnt(9)
    v_mfma_f32_32x32x16_bf16 v[72:87], v[104:107], v[224:227], v[72:87]
    ds_read_b64_tr_b16 v[124:125], v6 offset:29696
    ds_read_b64_tr_b16 v[126:127], v6 offset:29952
    v_or_b32 v46, v50, v51
    v_cndmask_b32_e64 v50, v48, 0, s[92:93]
    v_cndmask_b32_e64 v51, v49, 0, s[94:95]
    v_or_b32 v47, v50, v51
    s_waitcnt lgkmcnt(9)
    v_mfma_f32_32x32x16_bf16 v[72:87], v[108:111], v[228:231], v[72:87]
    ds_read_b64_tr_b16 v[96:97], v6 offset:30720
    ds_read_b64_tr_b16 v[98:99], v6 offset:30976
    v_mov_b32 v67, 0xf149f2ca
    v_mov_b32 v68, 0x53800000
    v_mov_b32 v69, 0x2b800000
    s_waitcnt lgkmcnt(9)
    v_mfma_f32_32x32x16_bf16 v[72:87], v[112:115], v[232:235], v[72:87]
    s_waitcnt lgkmcnt(8)
    s_add_u32 s39, s7, 7
    v_cmp_gt_u32 s[30:31], s39, v1
    ds_read_b64_tr_b16 v[100:101], v6 offset:31744
    ds_read_b64_tr_b16 v[102:103], v6 offset:32000
    v_add_u32 v13, 5, v9
    ds_write_b32 v0, v13
    s_waitcnt lgkmcnt(9)
    v_mfma_f32_32x32x16_bf16 v[72:87], v[116:119], v[236:239], v[72:87]
    s_cmp_eq_u64 s[30:31], 0
    s_cbranch_scc1 L22
L21:
    s_add_u32 s38, s38, 1
    s_cmp_gt_u32 s38, 6400000
    s_cbranch_scc1 L22
    ds_read_b32 v1, v35 offset:0
    s_waitcnt lgkmcnt(0)
    v_cmp_gt_u32 vcc, s39, v1
    s_cbranch_vccnz L21
L22:
    ds_read_b128 v[104:107], v37 offset:0
    s_waitcnt lgkmcnt(8)
    v_mfma_f32_32x32x16_bf16 v[72:87], v[120:123], v[240:243], v[72:87]
    s_waitcnt lgkmcnt(6)
    v_mfma_f32_32x32x16_bf16 v[72:87], v[124:127], v[244:247], v[72:87]
    s_waitcnt lgkmcnt(4)
    v_mfma_f32_32x32x16_bf16 v[72:87], v[96:99], v[248:251], v[72:87]
    s_waitcnt lgkmcnt(2)
    v_mfma_f32_32x32x16_bf16 v[72:87], v[100:103], v[252:255], v[72:87]
    s_waitcnt lgkmcnt(0)
    v_mfma_f32_32x32x16_bf16 v[72:87], v[104:107], v[92:95], v[72:87]
    s_waitcnt lgkmcnt(0)
    v_readfirstlane_b32 s21, v36
    s_nop 0
    s_mul_i32 s34, s21, 134217728
    s_add_u32 s34, s34, s35
    s_sub_u32 s37, s58, 2048
    s_add_u32 s37, s37, s34
    s_mul_i32 s60, s48, 114688
    s_mul_i32 s40, s51, 57344
    s_add_u32 s60, s60, s40
    s_add_u32 s60, s60, 8388608
    s_add_u32 s60, s60, s34
    v_mul_f32 v72, v12, v72
    v_mul_f32 v73, v12, v73
    v_mul_f32 v74, v12, v74
    v_mul_f32 v75, v12, v75
    v_mul_f32 v76, v12, v76
    v_mul_f32 v77, v12, v77
    v_mul_f32 v78, v12, v78
    v_mul_f32 v79, v12, v79
    v_mul_f32 v80, v12, v80
    v_mul_f32 v81, v12, v81
    v_mul_f32 v82, v12, v82
    v_mul_f32 v83, v12, v83
    v_mul_f32 v84, v12, v84
    v_mul_f32 v85, v12, v85
    v_mul_f32 v86, v12, v86
    v_mul_f32 v87, v12, v87
    v_cvt_pk_bf16_f32 v128, v72, v73
    v_cvt_pk_bf16_f32 v129, v74, v75
    v_cvt_pk_bf16_f32 v130, v76, v77
    v_cvt_pk_bf16_f32 v131, v78, v79
    v_cvt_pk_bf16_f32 v132, v80, v81
    v_cvt_pk_bf16_f32 v133, v82, v83
    v_cvt_pk_bf16_f32 v134, v84, v85
    v_cvt_pk_bf16_f32 v135, v86, v87
    ds_read_b64_tr_b16 v[104:105], v64 offset:0
    ds_read_b64_tr_b16 v[106:107], v64 offset:64
    ds_read_b64_tr_b16 v[108:109], v64 offset:256
    ds_read_b64_tr_b16 v[110:111], v64 offset:320
    v_add_u32 v64, v66, v64
    ds_read_b64_tr_b16 v[112:113], v64 offset:0
    ds_read_b64_tr_b16 v[114:115], v64 offset:64
    ds_read_b64_tr_b16 v[116:117], v64 offset:256
    ds_read_b64_tr_b16 v[118:119], v64 offset:320
    v_mfma_f32_32x32x16_bf16 v[172:187], v[168:171], v[128:131], 0
    v_mfma_f32_32x32x16_bf16 v[188:203], v[164:167], v[132:135], 0
    s_cmp_lg_u32 s22, 0
    s_cbranch_scc1 L23
    s_lshl_b32 s40, s48, 15
    s_lshl_b32 s41, s49, 6
    s_add_u32 s40, s40, s41
    buffer_load_dwordx4 v[24:27], v8, s[44:47], s40 offen
    buffer_load_dwordx4 v[28:31], v8, s[44:47], s40 offen offset:32
L23:
    s_nop 8
    v_max3_f32 v252, v172, v173, v174
    v_max3_f32 v253, v175, v176, v177
    v_max3_f32 v252, v252, v178, v179
    v_max3_f32 v253, v253, v180, v181
    v_max3_f32 v252, v252, v182, v183
    v_max3_f32 v253, v253, v184, v185
    v_max3_f32 v252, v252, v186, v187
    v_max_f32 v252, v252, v253
    v_mov_b32 v253, v252
    s_nop 1
    v_permlane32_swap_b32 v252, v253
    s_nop 1
    v_max_f32 v252, v252, v253
    v_sub_f32 v220, 0, v252
    v_sub_f32 v221, 0, v252
    v_sub_f32 v222, 0, v252
    v_sub_f32 v223, 0, v252
    v_sub_f32 v224, 0, v252
    v_sub_f32 v225, 0, v252
    v_sub_f32 v226, 0, v252
    v_sub_f32 v227, 0, v252
    v_sub_f32 v228, 0, v252
    v_sub_f32 v229, 0, v252
    v_sub_f32 v230, 0, v252
    v_sub_f32 v231, 0, v252
    v_sub_f32 v232, 0, v252
    v_sub_f32 v233, 0, v252
    v_sub_f32 v234, 0, v252
    v_sub_f32 v235, 0, v252
    s_nop 1
    v_mfma_f32_32x32x16_bf16 v[172:187], v[168:171], v[128:131], v[220:235]
    v_max3_f32 v252, v188, v189, v190
    v_max3_f32 v253, v191, v192, v193
    v_max3_f32 v252, v252, v194, v195
    v_max3_f32 v253, v253, v196, v197
    v_max3_f32 v252, v252, v198, v199
    v_max3_f32 v253, v253, v200, v201
    v_max3_f32 v252, v252, v202, v203
    v_max_f32 v252, v252, v253
    v_mov_b32 v253, v252
    s_nop 1
    v_permlane32_swap_b32 v252, v253
    s_nop 1
    v_max_f32 v252, v252, v253
    v_sub_f32 v236, 0, v252
    v_sub_f32 v237, 0, v252
    v_sub_f32 v238, 0, v252
    v_sub_f32 v239, 0, v252
    v_sub_f32 v240, 0, v252
    v_sub_f32 v241, 0, v252
    v_sub_f32 v242, 0, v252
    v_sub_f32 v243, 0, v252
    v_sub_f32 v244, 0, v252
    v_sub_f32 v245, 0, v252
    v_sub_f32 v246, 0, v252
    v_sub_f32 v247, 0, v252
    v_sub_f32 v248, 0, v252
    v_sub_f32 v249, 0, v252
    v_sub_f32 v250, 0, v252
    v_sub_f32 v251, 0, v252
    s_nop 1
    v_mfma_f32_32x32x16_bf16 v[188:203], v[164:167], v[132:135], v[236:251]
    v_exp_f32 v172, v172
    v_exp_f32 v173, v173
    v_exp_f32 v174, v174
    v_exp_f32 v175, v175
    v_exp_f32 v176, v176
    v_exp_f32 v177, v177
    v_exp_f32 v178, v178
    v_exp_f32 v179, v179
    v_exp_f32 v180, v180
    v_exp_f32 v181, v181
    v_exp_f32 v182, v182
    v_exp_f32 v183, v183
    v_exp_f32 v184, v184
    v_exp_f32 v185, v185
    v_exp_f32 v186, v186
    v_exp_f32 v187, v187
    v_cvt_pk_bf16_f32 v120, v172, v173
    v_cvt_pk_bf16_f32 v121, v174, v175
    v_cvt_pk_bf16_f32 v122, v176, v177
    v_cvt_pk_bf16_f32 v123, v178, v179
    v_cvt_pk_bf16_f32 v124, v180, v181
    v_cvt_pk_bf16_f32 v125, v182, v183
    v_cvt_pk_bf16_f32 v126, v184, v185
    v_cvt_pk_bf16_f32 v127, v186, v187
    v_bfi_b32 v120, v40, 0, v120
    v_bfi_b32 v121, v41, 0, v121
    v_bfi_b32 v122, v42, 0, v122
    v_bfi_b32 v123, v43, 0, v123
    v_bfi_b32 v124, v44, 0, v124
    v_bfi_b32 v125, v45, 0, v125
    v_bfi_b32 v126, v46, 0, v126
    v_bfi_b32 v127, v47, 0, v127
    s_waitcnt lgkmcnt(0)
    v_mfma_f32_32x32x16_bf16 v[72:87], v[104:107], v[120:123], 0
    v_mfma_f32_32x32x16_bf16 v[72:87], v[108:111], v[124:127], v[72:87]
    ds_read_b32 v1, v35 offset:16
    v_exp_f32 v188, v188
    v_exp_f32 v189, v189
    v_exp_f32 v190, v190
    v_exp_f32 v191, v191
    v_exp_f32 v192, v192
    v_exp_f32 v193, v193
    v_exp_f32 v194, v194
    v_exp_f32 v195, v195
    v_exp_f32 v196, v196
    v_exp_f32 v197, v197
    v_exp_f32 v198, v198
    v_exp_f32 v199, v199
    v_exp_f32 v200, v200
    v_exp_f32 v201, v201
    v_exp_f32 v202, v202
    v_exp_f32 v203, v203
    v_cvt_pk_bf16_f32 v48, v188, v189
    v_cvt_pk_bf16_f32 v49, v190, v191
    v_cvt_pk_bf16_f32 v50, v192, v193
    v_cvt_pk_bf16_f32 v51, v194, v195
    v_cvt_pk_bf16_f32 v52, v196, v197
    v_cvt_pk_bf16_f32 v53, v198, v199
    v_cvt_pk_bf16_f32 v54, v200, v201
    v_cvt_pk_bf16_f32 v55, v202, v203
    v_bfi_b32 v48, v40, 0, v48
    v_bfi_b32 v49, v41, 0, v49
    v_bfi_b32 v50, v42, 0, v50
    v_bfi_b32 v51, v43, 0, v51
    v_bfi_b32 v52, v44, 0, v52
    v_bfi_b32 v53, v45, 0, v53
    v_bfi_b32 v54, v46, 0, v54
    v_bfi_b32 v55, v47, 0, v55
    s_waitcnt lgkmcnt(0)
    s_add_u32 s39, s7, 5
    v_cmp_gt_u32 s[30:31], s39, v1
    v_mfma_f32_32x32x16_bf16 v[88:103], v[112:115], v[48:51], 0
    s_cmp_eq_u64 s[30:31], 0
    s_cbranch_scc1 L25
L24:
    s_add_u32 s38, s38, 1
    s_cmp_gt_u32 s38, 6400000
    s_cbranch_scc1 L25
    ds_read_b32 v1, v35 offset:16
    s_waitcnt lgkmcnt(0)
    v_cmp_gt_u32 vcc, s39, v1
    s_cbranch_vccnz L24
L25:
    ds_read_b32 v1, v35 offset:0
    ds_read_b128 v[164:167], v65 offset:7168
    ds_read_b128 v[160:163], v65 offset:6144
    ds_read_b128 v[156:159], v65 offset:5120
    v_mfma_f32_32x32x16_bf16 v[88:103], v[116:119], v[52:55], v[88:103]
    s_waitcnt lgkmcnt(3)
    s_add_u32 s39, s7, 8
    v_cmp_gt_u32 s[30:31], s39, v1
    s_nop 0
    s_cmp_eq_u64 s[30:31], 0
    s_cbranch_scc1 L27
L26:
    s_add_u32 s38, s38, 1
    s_cmp_gt_u32 s38, 6400000
    s_cbranch_scc1 L27
    ds_read_b32 v1, v35 offset:0
    ds_read_b128 v[164:167], v65 offset:7168
    ds_read_b128 v[160:163], v65 offset:6144
    ds_read_b128 v[156:159], v65 offset:5120
    s_waitcnt lgkmcnt(0)
    v_cmp_gt_u32 vcc, s39, v1
    s_cbranch_vccnz L26
L27:
    ds_read_b128 v[152:155], v65 offset:4096
    ds_read_b128 v[148:151], v65 offset:3072
    ds_read_b128 v[144:147], v65 offset:2048
    ds_read_b128 v[140:143], v65 offset:1024
    ds_read_b128 v[136:139], v65 offset:0
    s_waitcnt lgkmcnt(7)
    v_mfma_f32_32x32x16_bf16 v[172:187], v[164:167], v[128:131], v[220:235]
    s_waitcnt lgkmcnt(6)
    v_mfma_f32_32x32x16_bf16 v[188:203], v[160:163], v[128:131], v[220:235]
    ds_read_b128 v[164:167], v65 offset:31744
    ds_read_b128 v[160:163], v65 offset:30720
    s_nop 7
    v_exp_f32 v172, v172
    v_exp_f32 v173, v173
    v_exp_f32 v174, v174
    v_exp_f32 v175, v175
    ds_read_b64_tr_b16 v[104:105], v63 offset:0
    ds_read_b64_tr_b16 v[106:107], v63 offset:64
    ds_read_b64_tr_b16 v[108:109], v63 offset:256
    ds_read_b64_tr_b16 v[110:111], v63 offset:320
    v_add_u32 v63, v66, v63
    v_exp_f32 v176, v176
    v_exp_f32 v177, v177
    v_exp_f32 v178, v178
    v_exp_f32 v179, v179
    v_exp_f32 v180, v180
    v_exp_f32 v181, v181
    s_waitcnt lgkmcnt(6)
    v_mfma_f32_32x32x16_bf16 v[204:219], v[156:159], v[128:131], v[220:235]
    ds_read_b128 v[156:159], v65 offset:29696
    v_exp_f32 v182, v182
    v_exp_f32 v183, v183
    v_exp_f32 v184, v184
    v_exp_f32 v185, v185
    v_exp_f32 v186, v186
    v_exp_f32 v187, v187
    v_cvt_pk_bf16_f32 v120, v172, v173
    v_cvt_pk_bf16_f32 v121, v174, v175
    v_cvt_pk_bf16_f32 v122, v176, v177
    v_cvt_pk_bf16_f32 v123, v178, v179
    v_cvt_pk_bf16_f32 v124, v180, v181
    v_cvt_pk_bf16_f32 v125, v182, v183
    v_cvt_pk_bf16_f32 v126, v184, v185
    v_cvt_pk_bf16_f32 v127, v186, v187
    s_waitcnt lgkmcnt(1)
    v_mfma_f32_32x32x16_bf16 v[72:87], v[104:107], v[120:123], v[72:87]
    v_exp_f32 v188, v188
    v_exp_f32 v189, v189
    v_exp_f32 v190, v190
    v_exp_f32 v191, v191
    ds_read_b64_tr_b16 v[112:113], v62 offset:0
    ds_read_b64_tr_b16 v[114:115], v62 offset:64
    ds_read_b64_tr_b16 v[116:117], v62 offset:256
    ds_read_b64_tr_b16 v[118:119], v62 offset:320
    v_add_u32 v62, v66, v62
    v_mfma_f32_32x32x16_bf16 v[72:87], v[108:111], v[124:127], v[72:87]
    v_exp_f32 v192, v192
    v_exp_f32 v193, v193
    v_exp_f32 v194, v194
    v_exp_f32 v195, v195
    v_exp_f32 v196, v196
    v_exp_f32 v197, v197
    v_mfma_f32_32x32x16_bf16 v[172:187], v[152:155], v[128:131], v[220:235]
    ds_read_b128 v[152:155], v65 offset:28672
    v_exp_f32 v198, v198
    v_exp_f32 v199, v199
    v_exp_f32 v200, v200
    v_exp_f32 v201, v201
    v_exp_f32 v202, v202
    v_exp_f32 v203, v203
    v_cvt_pk_bf16_f32 v48, v188, v189
    v_cvt_pk_bf16_f32 v49, v190, v191
    v_cvt_pk_bf16_f32 v50, v192, v193
    v_cvt_pk_bf16_f32 v51, v194, v195
    v_cvt_pk_bf16_f32 v52, v196, v197
    v_cvt_pk_bf16_f32 v53, v198, v199
    v_cvt_pk_bf16_f32 v54, v200, v201
    v_cvt_pk_bf16_f32 v55, v202, v203
    s_waitcnt lgkmcnt(1)
    v_mfma_f32_32x32x16_bf16 v[72:87], v[112:115], v[48:51], v[72:87]
    v_exp_f32 v204, v204
    v_exp_f32 v205, v205
    v_exp_f32 v206, v206
    v_exp_f32 v207, v207
    ds_read_b64_tr_b16 v[104:105], v61 offset:0
    ds_read_b64_tr_b16 v[106:107], v61 offset:64
    ds_read_b64_tr_b16 v[108:109], v61 offset:256
    ds_read_b64_tr_b16 v[110:111], v61 offset:320
    v_add_u32 v61, v66, v61
    v_mfma_f32_32x32x16_bf16 v[72:87], v[116:119], v[52:55], v[72:87]
    v_exp_f32 v208, v208
    v_exp_f32 v209, v209
    v_exp_f32 v210, v210
    v_exp_f32 v211, v211
    v_exp_f32 v212, v212
    v_exp_f32 v213, v213
    v_mfma_f32_32x32x16_bf16 v[188:203], v[148:151], v[128:131], v[220:235]
    ds_read_b128 v[148:151], v65 offset:27648
    v_exp_f32 v214, v214
    v_exp_f32 v215, v215
    v_exp_f32 v216, v216
    v_exp_f32 v217, v217
    v_exp_f32 v218, v218
    v_exp_f32 v219, v219
    v_cvt_pk_bf16_f32 v120, v204, v205
    v_cvt_pk_bf16_f32 v121, v206, v207
    v_cvt_pk_bf16_f32 v122, v208, v209
    v_cvt_pk_bf16_f32 v123, v210, v211
    v_cvt_pk_bf16_f32 v124, v212, v213
    v_cvt_pk_bf16_f32 v125, v214, v215
    v_cvt_pk_bf16_f32 v126, v216, v217
    v_cvt_pk_bf16_f32 v127, v218, v219
    s_waitcnt lgkmcnt(1)
    v_mfma_f32_32x32x16_bf16 v[72:87], v[104:107], v[120:123], v[72:87]
    v_exp_f32 v172, v172
    v_exp_f32 v173, v173
    v_exp_f32 v174, v174
    v_exp_f32 v175, v175
    ds_read_b64_tr_b16 v[112:113], v60 offset:0
    ds_read_b64_tr_b16 v[114:115], v60 offset:64
    ds_read_b64_tr_b16 v[116:117], v60 offset:256
    ds_read_b64_tr_b16 v[118:119], v60 offset:320
    v_add_u32 v60, v66, v60
    v_mfma_f32_32x32x16_bf16 v[72:87], v[108:111], v[124:127], v[72:87]
    v_exp_f32 v176, v176
    v_exp_f32 v177, v177
    v_exp_f32 v178, v178
    v_exp_f32 v179, v179
    v_exp_f32 v180, v180
    v_exp_f32 v181, v181
    v_mfma_f32_32x32x16_bf16 v[204:219], v[144:147], v[128:131], v[220:235]
    ds_read_b128 v[144:147], v65 offset:26624
    v_exp_f32 v182, v182
    v_exp_f32 v183, v183
    v_exp_f32 v184, v184
    v_exp_f32 v185, v185
    v_exp_f32 v186, v186
    v_exp_f32 v187, v187
    v_cvt_pk_bf16_f32 v48, v172, v173
    v_cvt_pk_bf16_f32 v49, v174, v175
    v_cvt_pk_bf16_f32 v50, v176, v177
    v_cvt_pk_bf16_f32 v51, v178, v179
    v_cvt_pk_bf16_f32 v52, v180, v181
    v_cvt_pk_bf16_f32 v53, v182, v183
    v_cvt_pk_bf16_f32 v54, v184, v185
    v_cvt_pk_bf16_f32 v55, v186, v187
    s_waitcnt lgkmcnt(1)
    v_mfma_f32_32x32x16_bf16 v[72:87], v[112:115], v[48:51], v[72:87]
    v_exp_f32 v188, v188
    v_exp_f32 v189, v189
    v_exp_f32 v190, v190
    v_exp_f32 v191, v191
    ds_read_b64_tr_b16 v[104:105], v59 offset:0
    ds_read_b64_tr_b16 v[106:107], v59 offset:64
    ds_read_b64_tr_b16 v[108:109], v59 offset:256
    ds_read_b64_tr_b16 v[110:111], v59 offset:320
    v_add_u32 v59, v66, v59
    v_mfma_f32_32x32x16_bf16 v[72:87], v[116:119], v[52:55], v[72:87]
    v_exp_f32 v192, v192
    v_exp_f32 v193, v193
    v_exp_f32 v194, v194
    v_exp_f32 v195, v195
    v_exp_f32 v196, v196
    v_exp_f32 v197, v197
    v_mfma_f32_32x32x16_bf16 v[172:187], v[140:143], v[128:131], v[220:235]
    ds_read_b128 v[140:143], v65 offset:25600
    v_exp_f32 v198, v198
    v_exp_f32 v199, v199
    v_exp_f32 v200, v200
    v_exp_f32 v201, v201
    v_exp_f32 v202, v202
    v_exp_f32 v203, v203
    v_cvt_pk_bf16_f32 v120, v188, v189
    v_cvt_pk_bf16_f32 v121, v190, v191
    v_cvt_pk_bf16_f32 v122, v192, v193
    v_cvt_pk_bf16_f32 v123, v194, v195
    v_cvt_pk_bf16_f32 v124, v196, v197
    v_cvt_pk_bf16_f32 v125, v198, v199
    v_cvt_pk_bf16_f32 v126, v200, v201
    v_cvt_pk_bf16_f32 v127, v202, v203
    s_waitcnt lgkmcnt(1)
    v_mfma_f32_32x32x16_bf16 v[72:87], v[104:107], v[120:123], v[72:87]
    v_exp_f32 v204, v204
    v_exp_f32 v205, v205
    v_exp_f32 v206, v206
    v_exp_f32 v207, v207
    ds_read_b64_tr_b16 v[112:113], v58 offset:0
    ds_read_b64_tr_b16 v[114:115], v58 offset:64
    ds_read_b64_tr_b16 v[116:117], v58 offset:256
    ds_read_b64_tr_b16 v[118:119], v58 offset:320
    v_add_u32 v58, v66, v58
    v_mfma_f32_32x32x16_bf16 v[72:87], v[108:111], v[124:127], v[72:87]
    v_exp_f32 v208, v208
    v_exp_f32 v209, v209
    v_exp_f32 v210, v210
    v_exp_f32 v211, v211
    v_exp_f32 v212, v212
    v_exp_f32 v213, v213
    v_mfma_f32_32x32x16_bf16 v[188:203], v[136:139], v[128:131], v[220:235]
    ds_read_b128 v[136:139], v65 offset:24576
    v_exp_f32 v214, v214
    v_exp_f32 v215, v215
    v_exp_f32 v216, v216
    v_exp_f32 v217, v217
    v_exp_f32 v218, v218
    v_exp_f32 v219, v219
    v_cvt_pk_bf16_f32 v48, v204, v205
    v_cvt_pk_bf16_f32 v49, v206, v207
    v_cvt_pk_bf16_f32 v50, v208, v209
    v_cvt_pk_bf16_f32 v51, v210, v211
    v_cvt_pk_bf16_f32 v52, v212, v213
    v_cvt_pk_bf16_f32 v53, v214, v215
    v_cvt_pk_bf16_f32 v54, v216, v217
    v_cvt_pk_bf16_f32 v55, v218, v219
    s_waitcnt lgkmcnt(1)
    v_mfma_f32_32x32x16_bf16 v[72:87], v[112:115], v[48:51], v[72:87]
    v_exp_f32 v172, v172
    v_exp_f32 v173, v173
    v_exp_f32 v174, v174
    v_exp_f32 v175, v175
    ds_read_b64_tr_b16 v[104:105], v57 offset:0
    ds_read_b64_tr_b16 v[106:107], v57 offset:64
    ds_read_b64_tr_b16 v[108:109], v57 offset:256
    ds_read_b64_tr_b16 v[110:111], v57 offset:320
    v_add_u32 v57, v66, v57
    v_mfma_f32_32x32x16_bf16 v[72:87], v[116:119], v[52:55], v[72:87]
    v_exp_f32 v176, v176
    v_exp_f32 v177, v177
    v_exp_f32 v178, v178
    v_exp_f32 v179, v179
    v_exp_f32 v180, v180
    v_exp_f32 v181, v181
    v_mfma_f32_32x32x16_bf16 v[204:219], v[164:167], v[132:135], v[236:251]
    v_exp_f32 v182, v182
    v_exp_f32 v183, v183
    v_exp_f32 v184, v184
    v_exp_f32 v185, v185
    v_exp_f32 v186, v186
    v_exp_f32 v187, v187
    v_cvt_pk_bf16_f32 v120, v172, v173
    v_cvt_pk_bf16_f32 v121, v174, v175
    v_cvt_pk_bf16_f32 v122, v176, v177
    v_cvt_pk_bf16_f32 v123, v178, v179
    v_cvt_pk_bf16_f32 v124, v180, v181
    v_cvt_pk_bf16_f32 v125, v182, v183
    v_cvt_pk_bf16_f32 v126, v184, v185
    v_cvt_pk_bf16_f32 v127, v186, v187
    s_waitcnt lgkmcnt(0)
    v_mfma_f32_32x32x16_bf16 v[72:87], v[104:107], v[120:123], v[72:87]
    v_exp_f32 v188, v188
    v_exp_f32 v189, v189
    v_exp_f32 v190, v190
    v_exp_f32 v191, v191
    ds_read_b64_tr_b16 v[112:113], v56 offset:0
    ds_read_b64_tr_b16 v[114:115], v56 offset:64
    ds_read_b64_tr_b16 v[116:117], v56 offset:256
    ds_read_b64_tr_b16 v[118:119], v56 offset:320
    v_add_u32 v56, v66, v56
    v_mfma_f32_32x32x16_bf16 v[72:87], v[108:111], v[124:127], v[72:87]
    v_exp_f32 v192, v192
    v_exp_f32 v193, v193
    v_exp_f32 v194, v194
    v_exp_f32 v195, v195
    v_exp_f32 v196, v196
    v_exp_f32 v197, v197
    v_mfma_f32_32x32x16_bf16 v[172:187], v[160:163], v[132:135], v[236:251]
    v_exp_f32 v198, v198
    v_exp_f32 v199, v199
    v_exp_f32 v200, v200
    v_exp_f32 v201, v201
    v_exp_f32 v202, v202
    v_exp_f32 v203, v203
    v_cvt_pk_bf16_f32 v48, v188, v189
    v_cvt_pk_bf16_f32 v49, v190, v191
    v_cvt_pk_bf16_f32 v50, v192, v193
    v_cvt_pk_bf16_f32 v51, v194, v195
    v_cvt_pk_bf16_f32 v52, v196, v197
    v_cvt_pk_bf16_f32 v53, v198, v199
    v_cvt_pk_bf16_f32 v54, v200, v201
    v_cvt_pk_bf16_f32 v55, v202, v203
    v_and_b32 v48, v40, v48
    v_and_b32 v49, v41, v49
    v_and_b32 v50, v42, v50
    v_and_b32 v51, v43, v51
    v_and_b32 v52, v44, v52
    v_and_b32 v53, v45, v53
    v_and_b32 v54, v46, v54
    v_and_b32 v55, v47, v55
    s_waitcnt lgkmcnt(0)
    v_mfma_f32_32x32x16_bf16 v[72:87], v[112:115], v[48:51], v[72:87]
    v_exp_f32 v204, v204
    v_exp_f32 v205, v205
    v_exp_f32 v206, v206
    v_exp_f32 v207, v207
    ds_read_b64_tr_b16 v[104:105], v63 offset:0
    ds_read_b64_tr_b16 v[106:107], v63 offset:64
    ds_read_b64_tr_b16 v[108:109], v63 offset:256
    ds_read_b64_tr_b16 v[110:111], v63 offset:320
    v_mfma_f32_32x32x16_bf16 v[72:87], v[116:119], v[52:55], v[72:87]
    v_exp_f32 v208, v208
    v_exp_f32 v209, v209
    v_exp_f32 v210, v210
    v_exp_f32 v211, v211
    v_exp_f32 v212, v212
    v_exp_f32 v213, v213
    v_mfma_f32_32x32x16_bf16 v[188:203], v[156:159], v[132:135], v[236:251]
    v_exp_f32 v214, v214
    v_exp_f32 v215, v215
    v_exp_f32 v216, v216
    v_exp_f32 v217, v217
    v_exp_f32 v218, v218
    v_exp_f32 v219, v219
    v_rcp_f32 v254, v80
    v_med3_f32 v252, v80, v69, v68
    v_cmp_neq_f32 vcc, v80, v252
    v_mul_f32 v72, v254, v72
    v_mul_f32 v73, v254, v73
    v_mul_f32 v74, v254, v74
    v_mul_f32 v75, v254, v75
    v_mul_f32 v76, v254, v76
    v_mul_f32 v77, v254, v77
    v_mul_f32 v78, v254, v78
    v_mul_f32 v79, v254, v79
    s_cbranch_vccnz L_redo0
    v_cvt_pk_bf16_f32 v36, v72, v73
    v_cvt_pk_bf16_f32 v37, v74, v75
    v_cvt_pk_bf16_f32 v38, v76, v77
    v_cvt_pk_bf16_f32 v39, v78, v79
    s_cmp_lg_u32 s21, 0
    s_cbranch_scc1 L28
    buffer_store_dwordx4 v[36:39], v3, s[8:11], s37 offen offset:0
L29:
    v_add_u32 v13, 6, v9
    ds_write_b32 v0, v13
    v_cvt_pk_bf16_f32 v120, v204, v205
    v_cvt_pk_bf16_f32 v121, v206, v207
    v_cvt_pk_bf16_f32 v122, v208, v209
    v_cvt_pk_bf16_f32 v123, v210, v211
    v_cvt_pk_bf16_f32 v124, v212, v213
    v_cvt_pk_bf16_f32 v125, v214, v215
    v_cvt_pk_bf16_f32 v126, v216, v217
    v_cvt_pk_bf16_f32 v127, v218, v219
    s_waitcnt lgkmcnt(1)
    v_mfma_f32_32x32x16_bf16 v[88:103], v[104:107], v[120:123], v[88:103]
    v_exp_f32 v172, v172
    v_exp_f32 v173, v173
    v_exp_f32 v174, v174
    v_exp_f32 v175, v175
    ds_read_b64_tr_b16 v[112:113], v62 offset:0
    ds_read_b64_tr_b16 v[114:115], v62 offset:64
    ds_read_b64_tr_b16 v[116:117], v62 offset:256
    ds_read_b64_tr_b16 v[118:119], v62 offset:320
    v_mfma_f32_32x32x16_bf16 v[88:103], v[108:111], v[124:127], v[88:103]
    v_exp_f32 v176, v176
    v_exp_f32 v177, v177
    v_exp_f32 v178, v178
    v_exp_f32 v179, v179
    v_exp_f32 v180, v180
    v_exp_f32 v181, v181
    v_mfma_f32_32x32x16_bf16 v[204:219], v[152:155], v[132:135], v[236:251]
    v_exp_f32 v182, v182
    v_exp_f32 v183, v183
    v_exp_f32 v184, v184
    v_exp_f32 v185, v185
    v_exp_f32 v186, v186
    v_exp_f32 v187, v187
    v_cvt_pk_bf16_f32 v48, v172, v173
    v_cvt_pk_bf16_f32 v49, v174, v175
    v_cvt_pk_bf16_f32 v50, v176, v177
    v_cvt_pk_bf16_f32 v51, v178, v179
    v_cvt_pk_bf16_f32 v52, v180, v181
    v_cvt_pk_bf16_f32 v53, v182, v183
    v_cvt_pk_bf16_f32 v54, v184, v185
    v_cvt_pk_bf16_f32 v55, v186, v187
    s_waitcnt lgkmcnt(0)
    v_mfma_f32_32x32x16_bf16 v[88:103], v[112:115], v[48:51], v[88:103]
    v_exp_f32 v188, v188
    v_exp_f32 v189, v189
    v_exp_f32 v190, v190
    v_exp_f32 v191, v191
    ds_read_b64_tr_b16 v[104:105], v61 offset:0
    ds_read_b64_tr_b16 v[106:107], v61 offset:64
    ds_read_b64_tr_b16 v[108:109], v61 offset:256
    ds_read_b64_tr_b16 v[110:111], v61 offset:320
    v_mfma_f32_32x32x16_bf16 v[88:103], v[116:119], v[52:55], v[88:103]
    v_exp_f32 v192, v192
    v_exp_f32 v193, v193
    v_exp_f32 v194, v194
    v_exp_f32 v195, v195
    v_exp_f32 v196, v196
    v_exp_f32 v197, v197
    v_mfma_f32_32x32x16_bf16 v[172:187], v[148:151], v[132:135], v[236:251]
    v_exp_f32 v198, v198
    v_exp_f32 v199, v199
    v_exp_f32 v200, v200
    v_exp_f32 v201, v201
    v_exp_f32 v202, v202
    v_exp_f32 v203, v203
    v_cvt_pk_bf16_f32 v120, v188, v189
    v_cvt_pk_bf16_f32 v121, v190, v191
    v_cvt_pk_bf16_f32 v122, v192, v193
    v_cvt_pk_bf16_f32 v123, v194, v195
    v_cvt_pk_bf16_f32 v124, v196, v197
    v_cvt_pk_bf16_f32 v125, v198, v199
    v_cvt_pk_bf16_f32 v126, v200, v201
    v_cvt_pk_bf16_f32 v127, v202, v203
    s_waitcnt lgkmcnt(0)
    v_mfma_f32_32x32x16_bf16 v[88:103], v[104:107], v[120:123], v[88:103]
    v_exp_f32 v204, v204
    v_exp_f32 v205, v205
    v_exp_f32 v206, v206
    v_exp_f32 v207, v207
    ds_read_b64_tr_b16 v[112:113], v60 offset:0
    ds_read_b64_tr_b16 v[114:115], v60 offset:64
    ds_read_b64_tr_b16 v[116:117], v60 offset:256
    ds_read_b64_tr_b16 v[118:119], v60 offset:320
    v_mfma_f32_32x32x16_bf16 v[88:103], v[108:111], v[124:127], v[88:103]
    v_exp_f32 v208, v208
    v_exp_f32 v209, v209
    v_exp_f32 v210, v210
    v_exp_f32 v211, v211
    v_exp_f32 v212, v212
    v_exp_f32 v213, v213
    v_mfma_f32_32x32x16_bf16 v[188:203], v[144:147], v[132:135], v[236:251]
    v_exp_f32 v214, v214
    v_exp_f32 v215, v215
    v_exp_f32 v216, v216
    v_exp_f32 v217, v217
    v_exp_f32 v218, v218
    v_exp_f32 v219, v219
    s_add_u32 s40, s23, 1
    v_mov_b32 v13, s40
    s_waitcnt vmcnt(0)
    s_mov_b64 exec, 1
    s_cmp_lg_u32 s21, 0
    s_cbranch_scc1 L30
    buffer_store_dword v13, off, s[8:11], s24
L31:
    s_mov_b64 exec, -1
    v_cvt_pk_bf16_f32 v48, v204, v205
    v_cvt_pk_bf16_f32 v49, v206, v207
    v_cvt_pk_bf16_f32 v50, v208, v209
    v_cvt_pk_bf16_f32 v51, v210, v211
    v_cvt_pk_bf16_f32 v52, v212, v213
    v_cvt_pk_bf16_f32 v53, v214, v215
    v_cvt_pk_bf16_f32 v54, v216, v217
    v_cvt_pk_bf16_f32 v55, v218, v219
    s_waitcnt lgkmcnt(0)
    v_mfma_f32_32x32x16_bf16 v[88:103], v[112:115], v[48:51], v[88:103]
    v_exp_f32 v172, v172
    v_exp_f32 v173, v173
    v_exp_f32 v174, v174
    v_exp_f32 v175, v175
    ds_read_b64_tr_b16 v[104:105], v59 offset:0
    ds_read_b64_tr_b16 v[106:107], v59 offset:64
    ds_read_b64_tr_b16 v[108:109], v59 offset:256
    ds_read_b64_tr_b16 v[110:111], v59 offset:320
    v_mfma_f32_32x32x16_bf16 v[88:103], v[116:119], v[52:55], v[88:103]
    v_exp_f32 v176, v176
    v_exp_f32 v177, v177
    v_exp_f32 v178, v178
    v_exp_f32 v179, v179
    v_exp_f32 v180, v180
    v_exp_f32 v181, v181
    v_mfma_f32_32x32x16_bf16 v[204:219], v[140:143], v[132:135], v[236:251]
    v_exp_f32 v182, v182
    v_exp_f32 v183, v183
    v_exp_f32 v184, v184
    v_exp_f32 v185, v185
    v_exp_f32 v186, v186
    v_exp_f32 v187, v187
    v_cvt_pk_bf16_f32 v120, v172, v173
    v_cvt_pk_bf16_f32 v121, v174, v175
    v_cvt_pk_bf16_f32 v122, v176, v177
    v_cvt_pk_bf16_f32 v123, v178, v179
    v_cvt_pk_bf16_f32 v124, v180, v181
    v_cvt_pk_bf16_f32 v125, v182, v183
    v_cvt_pk_bf16_f32 v126, v184, v185
    v_cvt_pk_bf16_f32 v127, v186, v187
    s_waitcnt lgkmcnt(0)
    v_mfma_f32_32x32x16_bf16 v[88:103], v[104:107], v[120:123], v[88:103]
    v_exp_f32 v188, v188
    v_exp_f32 v189, v189
    v_exp_f32 v190, v190
    v_exp_f32 v191, v191
    ds_read_b64_tr_b16 v[112:113], v58 offset:0
    ds_read_b64_tr_b16 v[114:115], v58 offset:64
    ds_read_b64_tr_b16 v[116:117], v58 offset:256
    ds_read_b64_tr_b16 v[118:119], v58 offset:320
    v_mfma_f32_32x32x16_bf16 v[88:103], v[108:111], v[124:127], v[88:103]
    v_exp_f32 v192, v192
    v_exp_f32 v193, v193
    v_exp_f32 v194, v194
    v_exp_f32 v195, v195
    v_exp_f32 v196, v196
    v_exp_f32 v197, v197
    v_mfma_f32_32x32x16_bf16 v[172:187], v[136:139], v[132:135], v[236:251]
    v_exp_f32 v198, v198
    v_exp_f32 v199, v199
    v_exp_f32 v200, v200
    v_exp_f32 v201, v201
    v_exp_f32 v202, v202
    v_exp_f32 v203, v203
    v_cvt_pk_bf16_f32 v48, v188, v189
    v_cvt_pk_bf16_f32 v49, v190, v191
    v_cvt_pk_bf16_f32 v50, v192, v193
    v_cvt_pk_bf16_f32 v51, v194, v195
    v_cvt_pk_bf16_f32 v52, v196, v197
    v_cvt_pk_bf16_f32 v53, v198, v199
    v_cvt_pk_bf16_f32 v54, v200, v201
    v_cvt_pk_bf16_f32 v55, v202, v203
    s_waitcnt lgkmcnt(0)
    v_mfma_f32_32x32x16_bf16 v[88:103], v[112:115], v[48:51], v[88:103]
    v_exp_f32 v204, v204
    v_exp_f32 v205, v205
    v_exp_f32 v206, v206
    v_exp_f32 v207, v207
    ds_read_b64_tr_b16 v[104:105], v57 offset:0
    ds_read_b64_tr_b16 v[106:107], v57 offset:64
    ds_read_b64_tr_b16 v[108:109], v57 offset:256
    ds_read_b64_tr_b16 v[110:111], v57 offset:320
    v_mfma_f32_32x32x16_bf16 v[88:103], v[116:119], v[52:55], v[88:103]
    v_exp_f32 v208, v208
    v_exp_f32 v209, v209
    v_exp_f32 v210, v210
    v_exp_f32 v211, v211
    v_exp_f32 v212, v212
    v_exp_f32 v213, v213
    v_exp_f32 v214, v214
    v_exp_f32 v215, v215
    v_exp_f32 v216, v216
    v_exp_f32 v217, v217
    v_exp_f32 v218, v218
    v_exp_f32 v219, v219
    v_cvt_pk_bf16_f32 v120, v204, v205
    v_cvt_pk_bf16_f32 v121, v206, v207
    v_cvt_pk_bf16_f32 v122, v208, v209
    v_cvt_pk_bf16_f32 v123, v210, v211
    v_cvt_pk_bf16_f32 v124, v212, v213
    v_cvt_pk_bf16_f32 v125, v214, v215
    v_cvt_pk_bf16_f32 v126, v216, v217
    v_cvt_pk_bf16_f32 v127, v218, v219
    s_waitcnt lgkmcnt(0)
    v_mfma_f32_32x32x16_bf16 v[88:103], v[104:107], v[120:123], v[88:103]
    v_exp_f32 v172, v172
    v_exp_f32 v173, v173
    v_exp_f32 v174, v174
    v_exp_f32 v175, v175
    ds_read_b64_tr_b16 v[112:113], v56 offset:0
    ds_read_b64_tr_b16 v[114:115], v56 offset:64
    ds_read_b64_tr_b16 v[116:117], v56 offset:256
    ds_read_b64_tr_b16 v[118:119], v56 offset:320
    v_mfma_f32_32x32x16_bf16 v[88:103], v[108:111], v[124:127], v[88:103]
    v_exp_f32 v176, v176
    v_exp_f32 v177, v177
    v_exp_f32 v178, v178
    v_exp_f32 v179, v179
    v_exp_f32 v180, v180
    v_exp_f32 v181, v181
    buffer_load_dword v23, v21, s[8:11], s26 offen sc1
    v_exp_f32 v182, v182
    v_exp_f32 v183, v183
    v_exp_f32 v184, v184
    v_exp_f32 v185, v185
    v_exp_f32 v186, v186
    v_exp_f32 v187, v187
    v_cvt_pk_bf16_f32 v48, v172, v173
    v_cvt_pk_bf16_f32 v49, v174, v175
    v_cvt_pk_bf16_f32 v50, v176, v177
    v_cvt_pk_bf16_f32 v51, v178, v179
    v_cvt_pk_bf16_f32 v52, v180, v181
    v_cvt_pk_bf16_f32 v53, v182, v183
    v_cvt_pk_bf16_f32 v54, v184, v185
    v_cvt_pk_bf16_f32 v55, v186, v187
    v_and_b32 v48, v40, v48
    v_and_b32 v49, v41, v49
    v_and_b32 v50, v42, v50
    v_and_b32 v51, v43, v51
    v_and_b32 v52, v44, v52
    v_and_b32 v53, v45, v53
    v_and_b32 v54, v46, v54
    v_and_b32 v55, v47, v55
    s_waitcnt lgkmcnt(0)
    v_mfma_f32_32x32x16_bf16 v[88:103], v[112:115], v[48:51], v[88:103]
    v_mfma_f32_32x32x16_bf16 v[88:103], v[116:119], v[52:55], v[88:103]
    s_nop 11
    v_rcp_f32 v254, v96
    v_med3_f32 v252, v96, v69, v68
    v_cmp_neq_f32 vcc, v96, v252
    v_mul_f32 v88, v254, v88
    v_mul_f32 v89, v254, v89
    v_mul_f32 v90, v254, v90
    v_mul_f32 v91, v254, v91
    v_mul_f32 v92, v254, v92
    v_mul_f32 v93, v254, v93
    v_mul_f32 v94, v254, v94
    v_mul_f32 v95, v254, v95
    s_cbranch_vccnz L_redo1
    v_cvt_pk_bf16_f32 v36, v88, v89
    v_cvt_pk_bf16_f32 v37, v90, v91
    v_cvt_pk_bf16_f32 v38, v92, v93
    v_cvt_pk_bf16_f32 v39, v94, v95
    s_cmp_lg_u32 s21, 0
    s_cbranch_scc1 L32
    buffer_store_dwordx4 v[36:39], v3, s[8:11], s37 offen offset:1024
L33:
    v_add_u32 v13, 7, v9
    ds_write_b32 v0, v13
    s_add_u32 s61, s23, 1
    s_waitcnt vmcnt(1)
    v_cmp_gt_u32 vcc, s61, v23
    s_cbranch_vccz L34
L_att_late:
    s_add_u32 s40, s23, 2
    v_mov_b32 v13, s40
    s_waitcnt vmcnt(0)
    s_mov_b64 exec, 1
    s_cmp_lg_u32 s21, 0
    s_cbranch_scc1 L36
    buffer_store_dword v13, off, s[8:11], s24
L37:
    s_mov_b64 exec, -1
    s_add_u32 s61, s23, 1
    s_mov_b32 s41, 0
L38:
    buffer_load_dword v13, v21, s[8:11], s26 offen sc1
    s_add_u32 s41, s41, 1
    s_cmp_gt_u32 s41, 400000
    s_cbranch_scc1 L39
    s_waitcnt vmcnt(0)
    v_cmp_gt_u32 vcc, s61, v13
    s_cbranch_vccnz L38
L39:
    s_add_u32 s43, s60, 0
    buffer_load_dwordx4 v[136:139], v3, s[8:11], s43 offen offset:0 sc1
    s_add_u32 s43, s60, 7168
    buffer_load_dwordx4 v[140:143], v3, s[8:11], s43 offen offset:0 sc1
    s_add_u32 s43, s60, 14336
    buffer_load_dwordx4 v[144:147], v3, s[8:11], s43 offen offset:0 sc1
    s_add_u32 s43, s60, 21504
    buffer_load_dwordx4 v[148:151], v3, s[8:11], s43 offen offset:0 sc1
    s_add_u32 s43, s60, 28672
    buffer_load_dwordx4 v[152:155], v3, s[8:11], s43 offen offset:0 sc1
    s_add_u32 s43, s60, 35840
    buffer_load_dwordx4 v[156:159], v3, s[8:11], s43 offen offset:0 sc1
    s_add_u32 s43, s60, 43008
    buffer_load_dwordx4 v[160:163], v3, s[8:11], s43 offen offset:0 sc1
    s_add_u32 s43, s60, 50176
    buffer_load_dwordx4 v[164:167], v3, s[8:11], s43 offen offset:0 sc1
    s_waitcnt vmcnt(0)
    s_branch L35
L34:
    s_add_u32 s43, s60, 0
    buffer_load_dwordx4 v[136:139], v3, s[8:11], s43 offen offset:0 sc1
    s_add_u32 s43, s60, 7168
    buffer_load_dwordx4 v[140:143], v3, s[8:11], s43 offen offset:0 sc1
    s_add_u32 s43, s60, 14336
    buffer_load_dwordx4 v[144:147], v3, s[8:11], s43 offen offset:0 sc1
    s_add_u32 s43, s60, 21504
    buffer_load_dwordx4 v[148:151], v3, s[8:11], s43 offen offset:0 sc1
    s_add_u32 s43, s60, 28672
    buffer_load_dwordx4 v[152:155], v3, s[8:11], s43 offen offset:0 sc1
    s_add_u32 s43, s60, 35840
    buffer_load_dwordx4 v[156:159], v3, s[8:11], s43 offen offset:0 sc1
    s_add_u32 s43, s60, 43008
    buffer_load_dwordx4 v[160:163], v3, s[8:11], s43 offen offset:0 sc1
    s_add_u32 s43, s60, 50176
    buffer_load_dwordx4 v[164:167], v3, s[8:11], s43 offen offset:0 sc1
    s_add_u32 s40, s23, 2
    v_mov_b32 v13, s40
    s_waitcnt vmcnt(8)
    s_mov_b64 exec, 1
    s_cmp_lg_u32 s21, 0
    s_cbranch_scc1 L40
    buffer_store_dword v13, off, s[8:11], s24
L41:
    s_mov_b64 exec, -1
L35:
    s_add_u32 s58, s53, 6291456
    s_add_u32 s58, s58, s35
    s_add_u32 s59, s54, 5767168
    s_add_u32 s59, s59, s35
    v_lshlrev_b32 v40, 16, v24
    v_and_b32 v41, 0xffff0000, v24
    v_lshlrev_b32 v42, 16, v25
    v_and_b32 v43, 0xffff0000, v25
    v_lshlrev_b32 v44, 16, v26
    v_and_b32 v45, 0xffff0000, v26
    v_lshlrev_b32 v46, 16, v27
    v_and_b32 v47, 0xffff0000, v27
    v_lshlrev_b32 v48, 16, v28
    v_and_b32 v49, 0xffff0000, v28
    v_lshlrev_b32 v50, 16, v29
    v_and_b32 v51, 0xffff0000, v29
    v_lshlrev_b32 v52, 16, v30
    v_and_b32 v53, 0xffff0000, v30
    v_lshlrev_b32 v54, 16, v31
    v_and_b32 v55, 0xffff0000, v31
    v_xor_b32 v36, 64, v32
    v_add_u32 v37, 0x10000, v36
    v_add_u32 v38, 0x20000, v36
    s_xor_b32 s40, s6, 1
    s_lshl_b32 s40, s40, 12
    s_add_u32 s40, s40, 131072
    v_add_u32 v39, s40, v3
    ds_read_b32 v1, v35 offset:0
    s_waitcnt lgkmcnt(0)
    s_add_u32 s39, s7, 9
    v_cmp_gt_u32 s[30:31], s39, v1
    s_nop 0
    s_cmp_eq_u64 s[30:31], 0
    s_cbranch_scc1 L85
L84:
    s_add_u32 s38, s38, 1
    s_cmp_gt_u32 s38, 6400000
    s_cbranch_scc1 L85
    ds_read_b32 v1, v35 offset:0
    s_waitcnt lgkmcnt(0)
    v_cmp_gt_u32 vcc, s39, v1
    s_cbranch_vccnz L84
L85:
    ds_read_b64_tr_b16 v[96:97], v32 offset:32768
    ds_read_b64_tr_b16 v[98:99], v32 offset:33280
    ds_read_b64_tr_b16 v[100:101], v36 offset:32768
    ds_read_b64_tr_b16 v[102:103], v36 offset:33280
    ds_read_b64_tr_b16 v[104:105], v32 offset:36864
    ds_read_b64_tr_b16 v[106:107], v32 offset:37376
    ds_read_b64_tr_b16 v[108:109], v36 offset:36864
    ds_read_b64_tr_b16 v[110:111], v36 offset:37376
    ds_read_b64_tr_b16 v[112:113], v32 offset:40960
    ds_read_b64_tr_b16 v[114:115], v32 offset:41472
    ds_read_b64_tr_b16 v[116:117], v36 offset:40960
    ds_read_b64_tr_b16 v[118:119], v36 offset:41472
    s_waitcnt vmcnt(8)
    s_waitcnt lgkmcnt(10)
    v_mfma_f32_32x32x16_bf16 v[40:55], v[96:99], v[136:139], v[40:55]
    ds_read_b32 v1, v35 offset:16
    ds_read_b64_tr_b16 v[120:121], v32 offset:45056
    ds_read_b64_tr_b16 v[122:123], v32 offset:45568
    s_waitcnt lgkmcnt(11)
    v_mfma_f32_32x32x16_bf16 v[56:71], v[100:103], v[136:139], 0
    ds_read_b64_tr_b16 v[124:125], v36 offset:45056
    ds_read_b64_tr_b16 v[126:127], v36 offset:45568
    s_waitcnt vmcnt(7)
    s_waitcnt lgkmcnt(11)
    v_mfma_f32_32x32x16_bf16 v[40:55], v[104:107], v[140:143], v[40:55]
    ds_read_b64_tr_b16 v[96:97], v32 offset:49152
    ds_read_b64_tr_b16 v[98:99], v32 offset:49664
    s_waitcnt lgkmcnt(11)
    v_mfma_f32_32x32x16_bf16 v[56:71], v[108:111], v[140:143], v[56:71]
    ds_read_b64_tr_b16 v[100:101], v36 offset:49152
    ds_read_b64_tr_b16 v[102:103], v36 offset:49664
    buffer_load_dword v23, v21, s[8:11], s26 offen sc1
    s_waitcnt vmcnt(7)
    s_waitcnt lgkmcnt(11)
    v_mfma_f32_32x32x16_bf16 v[40:55], v[112:115], v[144:147], v[40:55]
    ds_read_b64_tr_b16 v[104:105], v32 offset:53248
    ds_read_b64_tr_b16 v[106:107], v32 offset:53760
    s_waitcnt lgkmcnt(11)
    v_mfma_f32_32x32x16_bf16 v[56:71], v[116:119], v[144:147], v[56:71]
    s_waitcnt lgkmcnt(10)
    s_add_u32 s39, s7, 7
    v_cmp_gt_u32 s[30:31], s39, v1
    ds_read_b64_tr_b16 v[108:109], v36 offset:53248
    ds_read_b64_tr_b16 v[110:111], v36 offset:53760
    s_waitcnt vmcnt(6)
    s_waitcnt lgkmcnt(10)
    v_mfma_f32_32x32x16_bf16 v[40:55], v[120:123], v[148:151], v[40:55]
    s_cmp_eq_u64 s[30:31], 0
    s_cbranch_scc1 L87
L86:
    s_add_u32 s38, s38, 1
    s_cmp_gt_u32 s38, 6400000
    s_cbranch_scc1 L87
    ds_read_b32 v1, v35 offset:16
    s_waitcnt lgkmcnt(0)
    v_cmp_gt_u32 vcc, s39, v1
    s_cbranch_vccnz L86
L87:
    ds_read_b64_tr_b16 v[112:113], v32 offset:57344
    ds_read_b64_tr_b16 v[114:115], v32 offset:57856
    s_waitcnt lgkmcnt(10)
    v_mfma_f32_32x32x16_bf16 v[56:71], v[124:127], v[148:151], v[56:71]
    ds_read_b64_tr_b16 v[116:117], v36 offset:57344
    ds_read_b64_tr_b16 v[118:119], v36 offset:57856
    s_waitcnt vmcnt(5)
    s_waitcnt lgkmcnt(10)
    v_mfma_f32_32x32x16_bf16 v[40:55], v[96:99], v[152:155], v[40:55]
    ds_read_b64_tr_b16 v[120:121], v32 offset:61440
    ds_read_b64_tr_b16 v[122:123], v32 offset:61952
    s_waitcnt lgkmcnt(10)
    v_mfma_f32_32x32x16_bf16 v[56:71], v[100:103], v[152:155], v[56:71]
    ds_read_b64_tr_b16 v[124:125], v36 offset:61440
    ds_read_b64_tr_b16 v[126:127], v36 offset:61952
    s_waitcnt vmcnt(4)
    s_waitcnt lgkmcnt(10)
    v_mfma_f32_32x32x16_bf16 v[40:55], v[104:107], v[156:159], v[40:55]
    ds_read_b64_tr_b16 v[96:97], v37 offset:0
    ds_read_b64_tr_b16 v[98:99], v37 offset:512
    s_waitcnt lgkmcnt(10)
    v_mfma_f32_32x32x16_bf16 v[56:71], v[108:111], v[156:159], v[56:71]
    ds_read_b64_tr_b16 v[100:101], v37 offset:4096
    ds_read_b64_tr_b16 v[102:103], v37 offset:4608
    s_waitcnt vmcnt(3)
    s_waitcnt lgkmcnt(10)
    v_mfma_f32_32x32x16_bf16 v[40:55], v[112:115], v[160:163], v[40:55]
    ds_read_b64_tr_b16 v[104:105], v37 offset:8192
    ds_read_b64_tr_b16 v[106:107], v37 offset:8704
    s_waitcnt lgkmcnt(10)
    v_mfma_f32_32x32x16_bf16 v[56:71], v[116:119], v[160:163], v[56:71]
    ds_read_b64_tr_b16 v[108:109], v37 offset:12288
    ds_read_b64_tr_b16 v[110:111], v37 offset:12800
    s_waitcnt vmcnt(2)
    s_waitcnt lgkmcnt(10)
    v_mfma_f32_32x32x16_bf16 v[40:55], v[120:123], v[164:167], v[40:55]
    ds_read_b64_tr_b16 v[112:113], v37 offset:16384
    ds_read_b64_tr_b16 v[114:115], v37 offset:16896
    s_waitcnt lgkmcnt(10)
    v_mfma_f32_32x32x16_bf16 v[56:71], v[124:127], v[164:167], v[56:71]
    ds_read_b64_tr_b16 v[116:117], v37 offset:20480
    ds_read_b64_tr_b16 v[118:119], v37 offset:20992
    s_add_u32 s61, s23, 2
    s_waitcnt vmcnt(0)
    v_cmp_gt_u32 vcc, s61, v23
    s_cbranch_vccz L88
    s_mov_b32 s41, 0
L89:
    buffer_load_dword v13, v21, s[8:11], s26 offen sc1
    s_add_u32 s41, s41, 1
    s_cmp_gt_u32 s41, 400000
    s_cbranch_scc1 L90
    s_waitcnt vmcnt(0)
    v_cmp_gt_u32 vcc, s61, v13
    s_cbranch_vccnz L89
L90:
L88:
    s_add_u32 s43, s60, 0
    buffer_load_dwordx4 v[168:171], v3, s[8:11], s43 offen offset:1024 sc1
    s_add_u32 s43, s60, 7168
    buffer_load_dwordx4 v[172:175], v3, s[8:11], s43 offen offset:1024 sc1
    s_add_u32 s43, s60, 14336
    buffer_load_dwordx4 v[176:179], v3, s[8:11], s43 offen offset:1024 sc1
    s_add_u32 s43, s60, 21504
    buffer_load_dwordx4 v[180:183], v3, s[8:11], s43 offen offset:1024 sc1
    s_add_u32 s43, s60, 28672
    buffer_load_dwordx4 v[184:187], v3, s[8:11], s43 offen offset:1024 sc1
    s_add_u32 s43, s60, 35840
    buffer_load_dwordx4 v[188:191], v3, s[8:11], s43 offen offset:1024 sc1
    s_add_u32 s43, s60, 43008
    buffer_load_dwordx4 v[192:195], v3, s[8:11], s43 offen offset:1024 sc1
    s_add_u32 s43, s60, 50176
    buffer_load_dwordx4 v[196:199], v3, s[8:11], s43 offen offset:1024 sc1
    v_add_u32 v13, 8, v9
    ds_write_b32 v0, v13
    s_waitcnt vmcnt(7)
    s_waitcnt lgkmcnt(11)
    v_mfma_f32_32x32x16_bf16 v[56:71], v[96:99], v[168:171], v[56:71]
    ds_read_b64_tr_b16 v[120:121], v37 offset:24576
    ds_read_b64_tr_b16 v[122:123], v37 offset:25088
    s_waitcnt vmcnt(6)
    s_waitcnt lgkmcnt(11)
    v_mfma_f32_32x32x16_bf16 v[56:71], v[100:103], v[172:175], v[56:71]
    ds_read_b64_tr_b16 v[124:125], v37 offset:28672
    ds_read_b64_tr_b16 v[126:127], v37 offset:29184
    s_waitcnt vmcnt(5)
    s_waitcnt lgkmcnt(11)
    v_mfma_f32_32x32x16_bf16 v[56:71], v[104:107], v[176:179], v[56:71]
    ds_read_b64_tr_b16 v[96:97], v33 offset:0
    ds_read_b64_tr_b16 v[98:99], v33 offset:512
    s_waitcnt vmcnt(4)
    s_waitcnt lgkmcnt(11)
    v_mfma_f32_32x32x16_bf16 v[56:71], v[108:111], v[180:183], v[56:71]
    ds_read_b64_tr_b16 v[100:101], v33 offset:4096
    ds_read_b64_tr_b16 v[102:103], v33 offset:4608
    s_waitcnt vmcnt(3)
    s_waitcnt lgkmcnt(11)
    v_mfma_f32_32x32x16_bf16 v[56:71], v[112:115], v[184:187], v[56:71]
    ds_read_b64_tr_b16 v[104:105], v33 offset:8192
    ds_read_b64_tr_b16 v[106:107], v33 offset:8704
    s_waitcnt vmcnt(2)
    s_waitcnt lgkmcnt(11)
    v_mfma_f32_32x32x16_bf16 v[56:71], v[116:119], v[188:191], v[56:71]
    ds_read_b64_tr_b16 v[108:109], v33 offset:12288
    ds_read_b64_tr_b16 v[110:111], v33 offset:12800
    s_waitcnt vmcnt(1)
    s_waitcnt lgkmcnt(10)
    v_mfma_f32_32x32x16_bf16 v[56:71], v[120:123], v[192:195], v[56:71]
    ds_read_b64_tr_b16 v[112:113], v33 offset:16384
    ds_read_b64_tr_b16 v[114:115], v33 offset:16896
    s_waitcnt vmcnt(0)
    s_waitcnt lgkmcnt(10)
    v_mfma_f32_32x32x16_bf16 v[56:71], v[124:127], v[196:199], v[56:71]
    ds_read_b64_tr_b16 v[116:117], v33 offset:20480
    ds_read_b64_tr_b16 v[118:119], v33 offset:20992
    s_waitcnt lgkmcnt(10)
    v_mfma_f32_32x32x16_bf16 v[40:55], v[96:99], v[168:171], v[40:55]
    ds_read_b64_tr_b16 v[120:121], v33 offset:24576
    ds_read_b64_tr_b16 v[122:123], v33 offset:25088
    s_waitcnt lgkmcnt(10)
    v_mfma_f32_32x32x16_bf16 v[40:55], v[100:103], v[172:175], v[40:55]
    ds_read_b64_tr_b16 v[124:125], v33 offset:28672
    ds_read_b64_tr_b16 v[126:127], v33 offset:29184
    s_waitcnt lgkmcnt(10)
    v_mfma_f32_32x32x16_bf16 v[40:55], v[104:107], v[176:179], v[40:55]
    ds_write_b128 v39, v[56:59] offset:0
    s_waitcnt lgkmcnt(9)
    v_mfma_f32_32x32x16_bf16 v[40:55], v[108:111], v[180:183], v[40:55]
    ds_write_b128 v39, v[60:63] offset:1024
    s_waitcnt lgkmcnt(8)
    v_mfma_f32_32x32x16_bf16 v[40:55], v[112:115], v[184:187], v[40:55]
    ds_write_b128 v39, v[64:67] offset:2048
    s_waitcnt lgkmcnt(7)
    v_mfma_f32_32x32x16_bf16 v[40:55], v[116:119], v[188:191], v[40:55]
    ds_write_b128 v39, v[68:71] offset:3072
    v_add_u32 v13, 9, v9
    ds_write_b32 v0, v13
    v_xor_b32 v39, 4096, v39
    s_waitcnt lgkmcnt(7)
    v_mfma_f32_32x32x16_bf16 v[40:55], v[120:123], v[192:195], v[40:55]
    s_waitcnt lgkmcnt(5)
    v_mfma_f32_32x32x16_bf16 v[40:55], v[124:127], v[196:199], v[40:55]
    ds_read_b32 v1, v35 offset:16
    ds_read_b128 v[72:75], v39 offset:0
    ds_read_b128 v[76:79], v39 offset:1024
    ds_read_b128 v[80:83], v39 offset:2048
    ds_read_b128 v[84:87], v39 offset:3072
    s_waitcnt lgkmcnt(4)
    s_add_u32 s39, s7, 9
    v_cmp_gt_u32 s[30:31], s39, v1
    s_nop 0
    s_cmp_eq_u64 s[30:31], 0
    s_cbranch_scc1 L92
L91:
    s_add_u32 s38, s38, 1
    s_cmp_gt_u32 s38, 6400000
    s_cbranch_scc1 L92
    ds_read_b32 v1, v35 offset:16
    ds_read_b128 v[72:75], v39 offset:0
    ds_read_b128 v[76:79], v39 offset:1024
    ds_read_b128 v[80:83], v39 offset:2048
    ds_read_b128 v[84:87], v39 offset:3072
    s_waitcnt lgkmcnt(0)
    v_cmp_gt_u32 vcc, s39, v1
    s_cbranch_vccnz L91
L92:
    s_waitcnt lgkmcnt(3)
    v_add_f32 v40, v40, v72
    v_add_f32 v41, v41, v73
    v_add_f32 v42, v42, v74
    v_add_f32 v43, v43, v75
    v_cvt_pk_bf16_f32 v24, v40, v41
    v_cvt_pk_bf16_f32 v25, v42, v43
    s_waitcnt lgkmcnt(2)
    v_add_f32 v44, v44, v76
    v_add_f32 v45, v45, v77
    v_add_f32 v46, v46, v78
    v_add_f32 v47, v47, v79
    v_cvt_pk_bf16_f32 v26, v44, v45
    v_cvt_pk_bf16_f32 v27, v46, v47
    s_waitcnt lgkmcnt(1)
    v_add_f32 v48, v48, v80
    v_add_f32 v49, v49, v81
    v_add_f32 v50, v50, v82
    v_add_f32 v51, v51, v83
    v_cvt_pk_bf16_f32 v28, v48, v49
    v_cvt_pk_bf16_f32 v29, v50, v51
    s_waitcnt lgkmcnt(0)
    v_add_f32 v52, v52, v84
    v_add_f32 v53, v53, v85
    v_add_f32 v54, v54, v86
    v_add_f32 v55, v55, v87
    v_cvt_pk_bf16_f32 v30, v52, v53
    v_cvt_pk_bf16_f32 v31, v54, v55
    v_add_u32 v13, 10, v9
    ds_write_b32 v0, v13
    s_cmp_lg_u32 s21, 0
    s_cbranch_scc1 L93
    buffer_store_dwordx4 v[24:27], v3, s[8:11], s58 offen
L94:
    s_cmp_lg_u32 s21, 0
    s_cbranch_scc1 L95
    buffer_store_dwordx4 v[28:31], v3, s[8:11], s58 offen offset:1024
L96:
    v_dot2_f32_bf16 v56, v24, s20, 0
    v_dot2_f32_bf16 v57, v24, v24, 0
    v_dot2_f32_bf16 v58, v25, s20, 0
    v_dot2_f32_bf16 v59, v25, v25, 0
    v_dot2_f32_bf16 v56, v26, s20, v56
    v_dot2_f32_bf16 v57, v26, v26, v57
    v_dot2_f32_bf16 v58, v27, s20, v58
    v_dot2_f32_bf16 v59, v27, v27, v59
    v_dot2_f32_bf16 v56, v28, s20, v56
    v_dot2_f32_bf16 v57, v28, v28, v57
    v_dot2_f32_bf16 v58, v29, s20, v58
    v_dot2_f32_bf16 v59, v29, v29, v59
    v_dot2_f32_bf16 v56, v30, s20, v56
    v_dot2_f32_bf16 v57, v30, v30, v57
    v_dot2_f32_bf16 v58, v31, s20, v58
    v_dot2_f32_bf16 v59, v31, v31, v59
    s_nop 1
    v_add_f32 v56, v56, v58
    v_add_f32 v57, v57, v59
    s_nop 1
    v_permlane32_swap_b32 v56, v57
    s_nop 0
    v_add_f32 v56, v56, v57
    s_cmp_lg_u32 s21, 0
    s_cbranch_scc1 L97
    buffer_store_dword v56, v3, s[8:11], s59 offen
L98:
    s_add_u32 s40, s23, 3
    v_mov_b32 v13, s40
    s_waitcnt vmcnt(0)
    s_mov_b64 exec, 1
    s_cmp_lg_u32 s21, 0
    s_cbranch_scc1 L99
    buffer_store_dword v13, off, s[8:11], s24
L100:
    s_mov_b64 exec, -1
    s_mul_i32 s60, s27, 114688
    s_mul_i32 s40, s17, 7168
    s_add_u32 s60, s60, s40
    s_add_u32 s60, s60, 8388608
    s_add_u32 s60, s60, s35
    s_lshl_b32 s58, s27, 15
    s_add_u32 s58, s58, 6291456
    s_add_u32 s58, s58, s35
    s_lshl_b32 s59, s27, 12
    s_add_u32 s59, s59, 5767168
    s_add_u32 s59, s59, s35
    s_mul_i32 s29, s48, 114688
    s_mul_i32 s40, s51, 57344
    s_add_u32 s29, s29, s40
    s_add_u32 s29, s29, 8388608
    s_add_u32 s29, s29, s35
    s_add_u32 s61, s23, 3
    s_mov_b32 s41, 0
L101:
    buffer_load_dword v13, v20, s[8:11], s26 offen sc1
    s_add_u32 s41, s41, 1
    s_cmp_gt_u32 s41, 400000
    s_cbranch_scc1 L102
    s_waitcnt vmcnt(0)
    v_cmp_gt_u32 vcc, s61, v13
    s_cbranch_vccnz L101
L102:
    s_add_u32 s43, s58, 0
    buffer_load_dwordx4 v[128:131], v3, s[8:11], s43 offen offset:0 sc1
    buffer_load_dwordx4 v[132:135], v3, s[8:11], s43 offen offset:1024 sc1
    buffer_load_dwordx4 v[136:139], v3, s[8:11], s43 offen offset:2048 sc1
    buffer_load_dwordx4 v[140:143], v3, s[8:11], s43 offen offset:3072 sc1
    s_add_u32 s43, s58, 4096
    buffer_load_dwordx4 v[144:147], v3, s[8:11], s43 offen offset:0 sc1
    buffer_load_dwordx4 v[148:151], v3, s[8:11], s43 offen offset:1024 sc1
    buffer_load_dwordx4 v[88:91], v3, s[8:11], s59 offen offset:0 sc1
    buffer_load_dwordx4 v[92:95], v3, s[8:11], s59 offen offset:1024 sc1
    buffer_load_dwordx4 v[96:99], v3, s[8:11], s59 offen offset:2048 sc1
    buffer_load_dwordx4 v[100:103], v3, s[8:11], s59 offen offset:3072 sc1
    buffer_load_dwordx4 v[152:155], v3, s[8:11], s43 offen offset:2048 sc1
    buffer_load_dwordx4 v[156:159], v3, s[8:11], s43 offen offset:3072 sc1
    s_add_u32 s43, s58, 8192
    buffer_load_dwordx4 v[160:163], v3, s[8:11], s43 offen offset:0 sc1
    buffer_load_dwordx4 v[164:167], v3, s[8:11], s43 offen offset:1024 sc1
    v_add_u32 v13, 11, v9
    ds_write_b32 v0, v13
    ds_read_b32 v1, v35 offset:0
    s_waitcnt lgkmcnt(0)
    s_add_u32 s39, s7, 11
    v_cmp_gt_u32 s[30:31], s39, v1
    s_nop 0
    s_cmp_eq_u64 s[30:31], 0
    s_cbranch_scc1 L104
L103:
    s_add_u32 s38, s38, 1
    s_cmp_gt_u32 s38, 6400000
    s_cbranch_scc1 L104
    ds_read_b32 v1, v35 offset:0
    s_waitcnt lgkmcnt(0)
    v_cmp_gt_u32 vcc, s39, v1
    s_cbranch_vccnz L103
L104:
    ds_read_b128 v[104:107], v4 offset:0
    ds_read_b128 v[108:111], v5 offset:32768
    ds_read_b128 v[112:115], v4 offset:32768
    ds_read_b128 v[116:119], v4 offset:1024
    ds_read_b128 v[120:123], v5 offset:33792
    s_waitcnt vmcnt(13)
    s_waitcnt lgkmcnt(4)
    v_mfma_f32_32x32x16_bf16 v[40:55], v[104:107], v[128:131], 0
    ds_read_b128 v[124:127], v4 offset:33792
    buffer_load_dwordx4 v[168:171], v3, s[8:11], s43 offen offset:2048 sc1
    s_waitcnt lgkmcnt(4)
    v_mfma_f32_32x32x16_bf16 v[56:71], v[108:111], v[128:131], 0
    ds_read_b128 v[104:107], v4 offset:2048
    s_waitcnt lgkmcnt(4)
    v_mfma_f32_32x32x16_bf16 v[72:87], v[112:115], v[128:131], 0
    ds_read_b128 v[108:111], v5 offset:34816
    s_waitcnt vmcnt(13)
    s_waitcnt lgkmcnt(4)
    v_mfma_f32_32x32x16_bf16 v[40:55], v[116:119], v[132:135], v[40:55]
    ds_read_b128 v[112:115], v4 offset:34816
    buffer_load_dwordx4 v[172:175], v3, s[8:11], s43 offen offset:3072 sc1
    s_waitcnt lgkmcnt(4)
    v_mfma_f32_32x32x16_bf16 v[56:71], v[120:123], v[132:135], v[56:71]
    ds_read_b128 v[116:119], v4 offset:3072
    s_waitcnt lgkmcnt(4)
    v_mfma_f32_32x32x16_bf16 v[72:87], v[124:127], v[132:135], v[72:87]
    ds_read_b128 v[120:123], v5 offset:35840
    s_waitcnt vmcnt(13)
    s_waitcnt lgkmcnt(4)
    v_mfma_f32_32x32x16_bf16 v[40:55], v[104:107], v[136:139], v[40:55]
    ds_read_b128 v[124:127], v4 offset:35840
    s_add_u32 s43, s58, 12288
    buffer_load_dwordx4 v[176:179], v3, s[8:11], s43 offen offset:0 sc1
    s_waitcnt lgkmcnt(4)
    v_mfma_f32_32x32x16_bf16 v[56:71], v[108:111], v[136:139], v[56:71]
    ds_read_b128 v[104:107], v4 offset:4096
    s_waitcnt lgkmcnt(4)
    v_mfma_f32_32x32x16_bf16 v[72:87], v[112:115], v[136:139], v[72:87]
    ds_read_b128 v[108:111], v5 offset:36864
    s_waitcnt vmcnt(13)
    s_waitcnt lgkmcnt(4)
    v_mfma_f32_32x32x16_bf16 v[40:55], v[116:119], v[140:143], v[40:55]
    ds_read_b128 v[112:115], v4 offset:36864
    buffer_load_dwordx4 v[180:183], v3, s[8:11], s43 offen offset:1024 sc1
    s_waitcnt lgkmcnt(4)
    v_mfma_f32_32x32x16_bf16 v[56:71], v[120:123], v[140:143], v[56:71]
    ds_read_b128 v[116:119], v4 offset:5120
    s_waitcnt lgkmcnt(4)
    v_mfma_f32_32x32x16_bf16 v[72:87], v[124:127], v[140:143], v[72:87]
    ds_read_b128 v[120:123], v5 offset:37888
    s_waitcnt vmcnt(13)
    s_waitcnt lgkmcnt(4)
    v_mfma_f32_32x32x16_bf16 v[40:55], v[104:107], v[144:147], v[40:55]
    ds_read_b128 v[124:127], v4 offset:37888
    buffer_load_dwordx4 v[184:187], v3, s[8:11], s43 offen offset:2048 sc1
    s_waitcnt lgkmcnt(4)
    v_mfma_f32_32x32x16_bf16 v[56:71], v[108:111], v[144:147], v[56:71]
    ds_read_b128 v[104:107], v4 offset:6144
    s_waitcnt lgkmcnt(4)
    v_mfma_f32_32x32x16_bf16 v[72:87], v[112:115], v[144:147], v[72:87]
    ds_read_b128 v[108:111], v5 offset:38912
    s_waitcnt vmcnt(13)
    s_waitcnt lgkmcnt(4)
    v_mfma_f32_32x32x16_bf16 v[40:55], v[116:119], v[148:151], v[40:55]
    ds_read_b128 v[112:115], v4 offset:38912
    buffer_load_dwordx4 v[188:191], v3, s[8:11], s43 offen offset:3072 sc1
    s_waitcnt lgkmcnt(4)
    v_mfma_f32_32x32x16_bf16 v[56:71], v[120:123], v[148:151], v[56:71]
    ds_read_b128 v[116:119], v4 offset:7168
    s_waitcnt lgkmcnt(4)
    v_mfma_f32_32x32x16_bf16 v[72:87], v[124:127], v[148:151], v[72:87]
    ds_read_b128 v[120:123], v5 offset:39936
    s_waitcnt vmcnt(9)
    s_waitcnt lgkmcnt(4)
    v_mfma_f32_32x32x16_bf16 v[40:55], v[104:107], v[152:155], v[40:55]
    ds_read_b128 v[124:127], v4 offset:39936
    v_add_u32 v13, 12, v9
    ds_write_b32 v0, v13
    s_add_u32 s43, s58, 16384
    buffer_load_dwordx4 v[192:195], v3, s[8:11], s43 offen offset:0 sc1
    s_waitcnt lgkmcnt(5)
    v_mfma_f32_32x32x16_bf16 v[56:71], v[108:111], v[152:155], v[56:71]
    ds_read_b128 v[104:107], v4 offset:8192
    s_waitcnt lgkmcnt(5)
    v_mfma_f32_32x32x16_bf16 v[72:87], v[112:115], v[152:155], v[72:87]
    ds_read_b128 v[108:111], v5 offset:40960
    s_waitcnt vmcnt(9)
    s_waitcnt lgkmcnt(5)
    v_mfma_f32_32x32x16_bf16 v[40:55], v[116:119], v[156:159], v[40:55]
    ds_read_b128 v[112:115], v4 offset:40960
    buffer_load_dwordx4 v[196:199], v3, s[8:11], s43 offen offset:1024 sc1
    s_waitcnt lgkmcnt(5)
    v_mfma_f32_32x32x16_bf16 v[56:71], v[120:123], v[156:159], v[56:71]
    ds_read_b128 v[116:119], v4 offset:9216
    v_add_f32 v88, v88, v96
    v_add_f32 v89, v89, v97
    v_add_f32 v90, v90, v98
    s_waitcnt lgkmcnt(5)
    v_mfma_f32_32x32x16_bf16 v[72:87], v[124:127], v[156:159], v[72:87]
    ds_read_b128 v[120:123], v5 offset:41984
    v_add_f32 v91, v91, v99
    v_add_f32 v92, v92, v100
    v_add_f32 v93, v93, v101
    s_waitcnt vmcnt(9)
    s_waitcnt lgkmcnt(4)
    v_mfma_f32_32x32x16_bf16 v[40:55], v[104:107], v[160:163], v[40:55]
    ds_read_b128 v[124:127], v4 offset:41984
    buffer_load_dwordx4 v[200:203], v3, s[8:11], s43 offen offset:2048 sc1
    s_waitcnt lgkmcnt(4)
    v_mfma_f32_32x32x16_bf16 v[56:71], v[108:111], v[160:163], v[56:71]
    ds_read_b128 v[104:107], v4 offset:10240
    v_add_f32 v94, v94, v102
    v_add_f32 v95, v95, v103
    v_add_f32 v88, v88, v92
    s_waitcnt lgkmcnt(4)
    v_mfma_f32_32x32x16_bf16 v[72:87], v[112:115], v[160:163], v[72:87]
    ds_read_b128 v[108:111], v5 offset:43008
    v_add_f32 v89, v89, v93
    v_add_f32 v90, v90, v94
    v_add_f32 v91, v91, v95
    s_waitcnt vmcnt(9)
    s_waitcnt lgkmcnt(4)
    v_mfma_f32_32x32x16_bf16 v[40:55], v[116:119], v[164:167], v[40:55]
    ds_read_b128 v[112:115], v4 offset:43008
    buffer_load_dwordx4 v[204:207], v3, s[8:11], s43 offen offset:3072 sc1
    s_waitcnt lgkmcnt(4)
    v_mfma_f32_32x32x16_bf16 v[56:71], v[120:123], v[164:167], v[56:71]
    ds_read_b128 v[116:119], v4 offset:11264
    v_add_f32 v88, v88, v90
    v_add_f32 v89, v89, v91
    v_add_f32 v88, v88, v89
    s_waitcnt lgkmcnt(4)
    v_mfma_f32_32x32x16_bf16 v[72:87], v[124:127], v[164:167], v[72:87]
    ds_read_b128 v[120:123], v5 offset:44032
    v_mov_b32 v89, v88
    s_nop 1
    v_permlane32_swap_b32 v88, v89
    s_nop 1
    s_waitcnt vmcnt(9)
    s_waitcnt lgkmcnt(4)
    v_mfma_f32_32x32x16_bf16 v[40:55], v[104:107], v[168:171], v[40:55]
    ds_read_b128 v[124:127], v4 offset:44032
    s_add_u32 s43, s58, 20480
    buffer_load_dwordx4 v[208:211], v3, s[8:11], s43 offen offset:0 sc1
    s_waitcnt lgkmcnt(4)
    v_mfma_f32_32x32x16_bf16 v[56:71], v[108:111], v[168:171], v[56:71]
    ds_read_b128 v[104:107], v4 offset:12288
    v_mul_f32 v88, 0xbb000000, v88
    v_mul_f32 v89, 0x3b000000, v89
    v_fma_f32 v89, -v88, v88, v89
    s_waitcnt lgkmcnt(4)
    v_mfma_f32_32x32x16_bf16 v[72:87], v[112:115], v[168:171], v[72:87]
    ds_read_b128 v[108:111], v5 offset:45056
    v_max_f32 v89, 0, v89
    v_add_f32 v89, 0x3727c5ac, v89
    v_rsq_f32 v10, v89
    s_waitcnt vmcnt(9)
    s_waitcnt lgkmcnt(4)
    v_mfma_f32_32x32x16_bf16 v[40:55], v[116:119], v[172:175], v[40:55]
    ds_read_b128 v[112:115], v4 offset:45056
    buffer_load_dwordx4 v[212:215], v3, s[8:11], s43 offen offset:1024 sc1
    s_waitcnt lgkmcnt(4)
    v_mfma_f32_32x32x16_bf16 v[56:71], v[120:123], v[172:175], v[56:71]
    ds_read_b128 v[116:119], v4 offset:13312
    v_sqrt_f32 v11, v89
    v_cvt_pk_bf16_f32 v16, v88, v88
    v_and_b32 v90, 0xffff0000, v16
    s_waitcnt lgkmcnt(4)
    v_mfma_f32_32x32x16_bf16 v[72:87], v[124:127], v[172:175], v[72:87]
    ds_read_b128 v[120:123], v5 offset:46080
    v_sub_f32 v90, v88, v90
    v_mov_b32 v91, 0
    v_cvt_pk_bf16_f32 v17, v90, v91
    s_waitcnt vmcnt(9)
    s_waitcnt lgkmcnt(4)
    v_mfma_f32_32x32x16_bf16 v[40:55], v[104:107], v[176:179], v[40:55]
    ds_read_b128 v[124:127], v4 offset:46080
    buffer_load_dwordx4 v[216:219], v3, s[8:11], s43 offen offset:2048 sc1
    s_waitcnt lgkmcnt(4)
    v_mfma_f32_32x32x16_bf16 v[56:71], v[108:111], v[176:179], v[56:71]
    ds_read_b128 v[104:107], v4 offset:14336
    v_cndmask_b32_e64 v16, 0, v16, s[62:63]
    v_cndmask_b32_e64 v17, 0, v17, s[62:63]
    v_mul_f32 v12, 0xbfb8aa3b, v10
    s_waitcnt lgkmcnt(4)
    v_mfma_f32_32x32x16_bf16 v[72:87], v[112:115], v[176:179], v[72:87]
    ds_read_b128 v[108:111], v5 offset:47104
    s_waitcnt vmcnt(9)
    s_waitcnt lgkmcnt(4)
    v_mfma_f32_32x32x16_bf16 v[40:55], v[116:119], v[180:183], v[40:55]
    ds_read_b128 v[112:115], v4 offset:47104
    buffer_load_dwordx4 v[220:223], v3, s[8:11], s43 offen offset:3072 sc1
    s_waitcnt lgkmcnt(4)
    v_mfma_f32_32x32x16_bf16 v[56:71], v[120:123], v[180:183], v[56:71]
    ds_read_b128 v[116:119], v4 offset:15360
    s_waitcnt lgkmcnt(4)
    v_mfma_f32_32x32x16_bf16 v[72:87], v[124:127], v[180:183], v[72:87]
    ds_read_b128 v[120:123], v5 offset:48128
    s_waitcnt vmcnt(9)
    s_waitcnt lgkmcnt(4)
    v_mfma_f32_32x32x16_bf16 v[40:55], v[104:107], v[184:187], v[40:55]
    ds_read_b128 v[124:127], v4 offset:48128
    v_add_u32 v13, 13, v9
    ds_write_b32 v0, v13
    s_add_u32 s43, s58, 24576
    buffer_load_dwordx4 v[224:227], v3, s[8:11], s43 offen offset:0 sc1
    s_waitcnt lgkmcnt(5)
    v_mfma_f32_32x32x16_bf16 v[56:71], v[108:111], v[184:187], v[56:71]
    ds_read_b128 v[104:107], v4 offset:16384
    s_waitcnt lgkmcnt(5)
    v_mfma_f32_32x32x16_bf16 v[72:87], v[112:115], v[184:187], v[72:87]
    ds_read_b128 v[108:111], v5 offset:49152
    s_waitcnt vmcnt(9)
    s_waitcnt lgkmcnt(5)
    v_mfma_f32_32x32x16_bf16 v[40:55], v[116:119], v[188:191], v[40:55]
    ds_read_b128 v[112:115], v4 offset:49152
    buffer_load_dwordx4 v[228:231], v3, s[8:11], s43 offen offset:1024 sc1
    s_waitcnt lgkmcnt(5)
    v_mfma_f32_32x32x16_bf16 v[56:71], v[120:123], v[188:191], v[56:71]
    ds_read_b128 v[116:119], v4 offset:17408
    s_waitcnt lgkmcnt(5)
    v_mfma_f32_32x32x16_bf16 v[72:87], v[124:127], v[188:191], v[72:87]
    ds_read_b128 v[120:123], v5 offset:50176
    s_waitcnt vmcnt(9)
    s_waitcnt lgkmcnt(4)
    v_mfma_f32_32x32x16_bf16 v[40:55], v[104:107], v[192:195], v[40:55]
    ds_read_b128 v[124:127], v4 offset:50176
    buffer_load_dwordx4 v[232:235], v3, s[8:11], s43 offen offset:2048 sc1
    s_waitcnt lgkmcnt(4)
    v_mfma_f32_32x32x16_bf16 v[56:71], v[108:111], v[192:195], v[56:71]
    ds_read_b128 v[104:107], v4 offset:18432
    s_waitcnt lgkmcnt(4)
    v_mfma_f32_32x32x16_bf16 v[72:87], v[112:115], v[192:195], v[72:87]
    ds_read_b128 v[108:111], v5 offset:51200
    s_waitcnt vmcnt(9)
    s_waitcnt lgkmcnt(4)
    v_mfma_f32_32x32x16_bf16 v[40:55], v[116:119], v[196:199], v[40:55]
    ds_read_b128 v[112:115], v4 offset:51200
    buffer_load_dwordx4 v[236:239], v3, s[8:11], s43 offen offset:3072 sc1
    s_waitcnt lgkmcnt(4)
    v_mfma_f32_32x32x16_bf16 v[56:71], v[120:123], v[196:199], v[56:71]
    ds_read_b128 v[116:119], v4 offset:19456
    s_waitcnt lgkmcnt(4)
    v_mfma_f32_32x32x16_bf16 v[72:87], v[124:127], v[196:199], v[72:87]
    ds_read_b128 v[120:123], v5 offset:52224
    s_waitcnt vmcnt(9)
    s_waitcnt lgkmcnt(4)
    v_mfma_f32_32x32x16_bf16 v[40:55], v[104:107], v[200:203], v[40:55]
    ds_read_b128 v[124:127], v4 offset:52224
    s_add_u32 s43, s58, 28672
    buffer_load_dwordx4 v[240:243], v3, s[8:11], s43 offen offset:0 sc1
    s_waitcnt lgkmcnt(4)
    v_mfma_f32_32x32x16_bf16 v[56:71], v[108:111], v[200:203], v[56:71]
    ds_read_b128 v[104:107], v4 offset:20480
    s_waitcnt lgkmcnt(4)
    v_mfma_f32_32x32x16_bf16 v[72:87], v[112:115], v[200:203], v[72:87]
    ds_read_b128 v[108:111], v5 offset:53248
    s_waitcnt vmcnt(9)
    s_waitcnt lgkmcnt(4)
    v_mfma_f32_32x32x16_bf16 v[40:55], v[116:119], v[204:207], v[40:55]
    ds_read_b128 v[112:115], v4 offset:53248
    buffer_load_dwordx4 v[244:247], v3, s[8:11], s43 offen offset:1024 sc1
    s_waitcnt lgkmcnt(4)
    v_mfma_f32_32x32x16_bf16 v[56:71], v[120:123], v[204:207], v[56:71]
    ds_read_b128 v[116:119], v4 offset:21504
    s_waitcnt lgkmcnt(4)
    v_mfma_f32_32x32x16_bf16 v[72:87], v[124:127], v[204:207], v[72:87]
    ds_read_b128 v[120:123], v5 offset:54272
    s_waitcnt vmcnt(9)
    s_waitcnt lgkmcnt(4)
    v_mfma_f32_32x32x16_bf16 v[40:55], v[104:107], v[208:211], v[40:55]
    ds_read_b128 v[124:127], v4 offset:54272
    buffer_load_dwordx4 v[248:251], v3, s[8:11], s43 offen offset:2048 sc1
    s_waitcnt lgkmcnt(4)
    v_mfma_f32_32x32x16_bf16 v[56:71], v[108:111], v[208:211], v[56:71]
    ds_read_b128 v[104:107], v4 offset:22528
    s_waitcnt lgkmcnt(4)
    v_mfma_f32_32x32x16_bf16 v[72:87], v[112:115], v[208:211], v[72:87]
    ds_read_b128 v[108:111], v5 offset:55296
    s_waitcnt vmcnt(9)
    s_waitcnt lgkmcnt(4)
    v_mfma_f32_32x32x16_bf16 v[40:55], v[116:119], v[212:215], v[40:55]
    ds_read_b128 v[112:115], v4 offset:55296
    buffer_load_dwordx4 v[252:255], v3, s[8:11], s43 offen offset:3072 sc1
    s_waitcnt lgkmcnt(4)
    v_mfma_f32_32x32x16_bf16 v[56:71], v[120:123], v[212:215], v[56:71]
    ds_read_b128 v[116:119], v4 offset:23552
    s_waitcnt lgkmcnt(4)
    v_mfma_f32_32x32x16_bf16 v[72:87], v[124:127], v[212:215], v[72:87]
    ds_read_b128 v[120:123], v5 offset:56320
    s_waitcnt vmcnt(9)
    s_waitcnt lgkmcnt(4)
    v_mfma_f32_32x32x16_bf16 v[40:55], v[104:107], v[216:219], v[40:55]
    ds_read_b128 v[124:127], v4 offset:56320
    v_add_u32 v13, 14, v9
    ds_write_b32 v0, v13
    s_waitcnt lgkmcnt(5)
    v_mfma_f32_32x32x16_bf16 v[56:71], v[108:111], v[216:219], v[56:71]
    ds_read_b128 v[104:107], v4 offset:24576
    s_waitcnt lgkmcnt(5)
    v_mfma_f32_32x32x16_bf16 v[72:87], v[112:115], v[216:219], v[72:87]
    ds_read_b128 v[108:111], v5 offset:57344
    s_waitcnt vmcnt(8)
    s_waitcnt lgkmcnt(5)
    v_mfma_f32_32x32x16_bf16 v[40:55], v[116:119], v[220:223], v[40:55]
    ds_read_b128 v[112:115], v4 offset:57344
    s_waitcnt lgkmcnt(5)
    v_mfma_f32_32x32x16_bf16 v[56:71], v[120:123], v[220:223], v[56:71]
    ds_read_b128 v[116:119], v4 offset:25600
    v_and_b32 v36, 1, v2
    v_add_u32 v36, 1, v36
    s_sub_u32 s40, 15, s16
    v_min_u32 v36, s40, v36
    v_lshlrev_b32 v36, 11, v36
    buffer_load_dword v23, v36, s[8:11], s36 offen sc1
    s_waitcnt lgkmcnt(5)
    v_mfma_f32_32x32x16_bf16 v[72:87], v[124:127], v[220:223], v[72:87]
    ds_read_b128 v[120:123], v5 offset:58368
    s_waitcnt vmcnt(8)
    s_waitcnt lgkmcnt(4)
    v_mfma_f32_32x32x16_bf16 v[40:55], v[104:107], v[224:227], v[40:55]
    ds_read_b128 v[124:127], v4 offset:58368
    s_waitcnt lgkmcnt(4)
    v_mfma_f32_32x32x16_bf16 v[56:71], v[108:111], v[224:227], v[56:71]
    ds_read_b128 v[104:107], v4 offset:26624
    s_waitcnt lgkmcnt(4)
    v_mfma_f32_32x32x16_bf16 v[72:87], v[112:115], v[224:227], v[72:87]
    ds_read_b128 v[108:111], v5 offset:59392
    s_waitcnt vmcnt(7)
    s_waitcnt lgkmcnt(4)
    v_mfma_f32_32x32x16_bf16 v[40:55], v[116:119], v[228:231], v[40:55]
    ds_read_b128 v[112:115], v4 offset:59392
    s_waitcnt lgkmcnt(4)
    v_mfma_f32_32x32x16_bf16 v[56:71], v[120:123], v[228:231], v[56:71]
    ds_read_b128 v[116:119], v4 offset:27648
    s_waitcnt lgkmcnt(4)
    v_mfma_f32_32x32x16_bf16 v[72:87], v[124:127], v[228:231], v[72:87]
    ds_read_b128 v[120:123], v5 offset:60416
    s_waitcnt vmcnt(6)
    s_waitcnt lgkmcnt(4)
    v_mfma_f32_32x32x16_bf16 v[40:55], v[104:107], v[232:235], v[40:55]
    ds_read_b128 v[124:127], v4 offset:60416
    s_waitcnt lgkmcnt(4)
    v_mfma_f32_32x32x16_bf16 v[56:71], v[108:111], v[232:235], v[56:71]
    ds_read_b128 v[104:107], v4 offset:28672
    s_waitcnt lgkmcnt(4)
    v_mfma_f32_32x32x16_bf16 v[72:87], v[112:115], v[232:235], v[72:87]
    ds_read_b128 v[108:111], v5 offset:61440
    s_waitcnt vmcnt(5)
    s_waitcnt lgkmcnt(4)
    v_mfma_f32_32x32x16_bf16 v[40:55], v[116:119], v[236:239], v[40:55]
    ds_read_b128 v[112:115], v4 offset:61440
    s_waitcnt lgkmcnt(4)
    v_mfma_f32_32x32x16_bf16 v[56:71], v[120:123], v[236:239], v[56:71]
    ds_read_b128 v[116:119], v4 offset:29696
    s_waitcnt lgkmcnt(4)
    v_mfma_f32_32x32x16_bf16 v[72:87], v[124:127], v[236:239], v[72:87]
    ds_read_b128 v[120:123], v5 offset:62464
    s_waitcnt vmcnt(4)
    s_waitcnt lgkmcnt(4)
    v_mfma_f32_32x32x16_bf16 v[40:55], v[104:107], v[240:243], v[40:55]
    ds_read_b128 v[124:127], v4 offset:62464
    s_waitcnt lgkmcnt(4)
    v_mfma_f32_32x32x16_bf16 v[56:71], v[108:111], v[240:243], v[56:71]
    ds_read_b128 v[104:107], v4 offset:30720
    s_waitcnt lgkmcnt(4)
    v_mfma_f32_32x32x16_bf16 v[72:87], v[112:115], v[240:243], v[72:87]
    ds_read_b128 v[108:111], v5 offset:63488
    s_waitcnt vmcnt(3)
    s_waitcnt lgkmcnt(4)
    v_mfma_f32_32x32x16_bf16 v[40:55], v[116:119], v[244:247], v[40:55]
    ds_read_b128 v[112:115], v4 offset:63488
    s_waitcnt lgkmcnt(4)
    v_mfma_f32_32x32x16_bf16 v[56:71], v[120:123], v[244:247], v[56:71]
    ds_read_b128 v[116:119], v4 offset:31744
    s_waitcnt lgkmcnt(4)
    v_mfma_f32_32x32x16_bf16 v[72:87], v[124:127], v[244:247], v[72:87]
    ds_read_b32 v1, v35 offset:0
    ds_read_b128 v[120:123], v5 offset:64512
    s_waitcnt vmcnt(2)
    s_waitcnt lgkmcnt(5)
    v_mfma_f32_32x32x16_bf16 v[40:55], v[104:107], v[248:251], v[40:55]
    ds_read_b128 v[124:127], v4 offset:64512
    v_add_u32 v13, 15, v9
    ds_write_b32 v0, v13
    s_waitcnt lgkmcnt(6)
    v_mfma_f32_32x32x16_bf16 v[56:71], v[108:111], v[248:251], v[56:71]
    ds_read_b64 v[104:105], v22 offset:768
    s_waitcnt lgkmcnt(6)
    v_mfma_f32_32x32x16_bf16 v[72:87], v[112:115], v[248:251], v[72:87]
    ds_read_b64 v[108:109], v22 offset:1024
    s_waitcnt vmcnt(1)
    s_waitcnt lgkmcnt(6)
    v_mfma_f32_32x32x16_bf16 v[40:55], v[116:119], v[252:255], v[40:55]
    s_waitcnt lgkmcnt(5)
    s_add_u32 s39, s7, 15
    v_cmp_gt_u32 s[30:31], s39, v1
    ds_read_b64 v[112:113], v22 offset:1280
    s_waitcnt lgkmcnt(5)
    v_mfma_f32_32x32x16_bf16 v[56:71], v[120:123], v[252:255], v[56:71]
    s_cmp_eq_u64 s[30:31], 0
    s_cbranch_scc1 L106
L105:
    s_add_u32 s38, s38, 1
    s_cmp_gt_u32 s38, 6400000
    s_cbranch_scc1 L106
    ds_read_b32 v1, v35 offset:0
    s_waitcnt lgkmcnt(0)
    v_cmp_gt_u32 vcc, s39, v1
    s_cbranch_vccnz L105
L106:
    ds_read_b128 v[116:119], v5 offset:0
    s_waitcnt lgkmcnt(5)
    v_mfma_f32_32x32x16_bf16 v[72:87], v[124:127], v[252:255], v[72:87]
    ds_read_b128 v[120:123], v5 offset:1024
    s_waitcnt lgkmcnt(4)
    v_mfma_f32_32x32x16_bf16 v[40:55], v[104:107], v[16:19], v[40:55]
    ds_read_b128 v[124:127], v5 offset:2048
    s_waitcnt lgkmcnt(4)
    v_mfma_f32_32x32x16_bf16 v[56:71], v[108:111], v[16:19], v[56:71]
    ds_read_b128 v[104:107], v5 offset:3072
    s_waitcnt lgkmcnt(4)
    v_mfma_f32_32x32x16_bf16 v[72:87], v[112:115], v[16:19], v[72:87]
    ds_read_b128 v[108:111], v5 offset:4096
    s_nop 4
    v_mul_f32 v40, v12, v40
    v_mul_f32 v41, v12, v41
    v_mul_f32 v42, v12, v42
    s_waitcnt lgkmcnt(3)
    v_mfma_f32_32x32x16_bf16 v[88:103], v[116:119], v[128:131], 0
    ds_read_b128 v[112:115], v5 offset:5120
    v_mul_f32 v43, v12, v43
    v_mul_f32 v44, v12, v44
    v_mul_f32 v45, v12, v45
    v_mfma_f32_32x32x16_bf16 v[88:103], v[120:123], v[132:135], v[88:103]
    ds_read_b128 v[116:119], v5 offset:6144
    v_mul_f32 v46, v12, v46
    v_mul_f32 v47, v12, v47
    v_exp_f32 v40, v40
    s_waitcnt lgkmcnt(3)
    v_mfma_f32_32x32x16_bf16 v[88:103], v[124:127], v[136:139], v[88:103]
    ds_read_b128 v[120:123], v5 offset:7168
    v_exp_f32 v41, v41
    v_exp_f32 v42, v42
    v_mfma_f32_32x32x16_bf16 v[88:103], v[104:107], v[140:143], v[88:103]
    ds_read_b128 v[124:127], v5 offset:8192
    s_add_u32 s61, s22, 1
    s_waitcnt vmcnt(0)
    v_cmp_gt_u32 vcc, s61, v23
    s_cbranch_vccz L107
    s_mov_b32 s41, 0
L108:
    buffer_load_dword v13, v36, s[8:11], s36 offen sc1
    s_add_u32 s41, s41, 1
    s_cmp_gt_u32 s41, 400000
    s_cbranch_scc1 L109
    s_waitcnt vmcnt(0)
    v_cmp_gt_u32 vcc, s61, v13
    s_cbranch_vccnz L108
L109:
L107:
    v_exp_f32 v43, v43
    v_exp_f32 v44, v44
    s_waitcnt lgkmcnt(3)
    v_mfma_f32_32x32x16_bf16 v[88:103], v[108:111], v[144:147], v[88:103]
    ds_read_b128 v[104:107], v5 offset:9216
    v_exp_f32 v45, v45
    v_exp_f32 v46, v46
    v_mfma_f32_32x32x16_bf16 v[88:103], v[112:115], v[148:151], v[88:103]
    ds_read_b128 v[108:111], v5 offset:10240
    v_exp_f32 v47, v47
    v_fma_f32 v40, v40, v11, v11
    s_waitcnt lgkmcnt(3)
    v_mfma_f32_32x32x16_bf16 v[88:103], v[116:119], v[152:155], v[88:103]
    ds_read_b128 v[112:115], v5 offset:11264
    v_fma_f32 v41, v41, v11, v11
    v_fma_f32 v42, v42, v11, v11
    v_fma_f32 v43, v43, v11, v11
    v_mfma_f32_32x32x16_bf16 v[88:103], v[120:123], v[156:159], v[88:103]
    ds_read_b128 v[116:119], v5 offset:12288
    v_fma_f32 v44, v44, v11, v11
    v_fma_f32 v45, v45, v11, v11
    v_fma_f32 v46, v46, v11, v11
    s_waitcnt lgkmcnt(3)
    v_mfma_f32_32x32x16_bf16 v[88:103], v[124:127], v[160:163], v[88:103]
    ds_read_b128 v[120:123], v5 offset:13312
    v_fma_f32 v47, v47, v11, v11
    v_rcp_f32 v40, v40
    v_mfma_f32_32x32x16_bf16 v[88:103], v[104:107], v[164:167], v[88:103]
    ds_read_b128 v[124:127], v5 offset:14336
    v_rcp_f32 v41, v41
    v_rcp_f32 v42, v42
    s_waitcnt lgkmcnt(3)
    v_mfma_f32_32x32x16_bf16 v[88:103], v[108:111], v[168:171], v[88:103]
    ds_read_b128 v[104:107], v5 offset:15360
    v_rcp_f32 v43, v43
    v_rcp_f32 v44, v44
    v_mfma_f32_32x32x16_bf16 v[88:103], v[112:115], v[172:175], v[88:103]
    ds_read_b128 v[108:111], v5 offset:16384
    v_rcp_f32 v45, v45
    v_rcp_f32 v46, v46
    s_waitcnt lgkmcnt(3)
    v_mfma_f32_32x32x16_bf16 v[88:103], v[116:119], v[176:179], v[88:103]
    ds_read_b128 v[112:115], v5 offset:17408
    v_rcp_f32 v47, v47
    v_mul_f32 v40, v40, v48
    v_mfma_f32_32x32x16_bf16 v[88:103], v[120:123], v[180:183], v[88:103]
    ds_read_b128 v[116:119], v5 offset:18432
    v_mul_f32 v41, v41, v49
    v_mul_f32 v42, v42, v50
    v_mul_f32 v43, v43, v51
    s_waitcnt lgkmcnt(3)
    v_mfma_f32_32x32x16_bf16 v[88:103], v[124:127], v[184:187], v[88:103]
    ds_read_b128 v[120:123], v5 offset:19456
    v_mul_f32 v44, v44, v52
    v_mul_f32 v45, v45, v53
    v_mul_f32 v46, v46, v54
    v_mfma_f32_32x32x16_bf16 v[88:103], v[104:107], v[188:191], v[88:103]
    ds_read_b128 v[124:127], v5 offset:20480
    v_mul_f32 v47, v47, v55
    v_cvt_pk_bf16_f32 v36, v40, v41
    v_cvt_pk_bf16_f32 v37, v42, v43
    s_waitcnt lgkmcnt(3)
    v_mfma_f32_32x32x16_bf16 v[88:103], v[108:111], v[192:195], v[88:103]
    ds_read_b128 v[104:107], v5 offset:21504
    v_cvt_pk_bf16_f32 v38, v44, v45
    v_cvt_pk_bf16_f32 v39, v46, v47
    s_add_u32 s43, s60, 0
    buffer_store_dwordx4 v[36:39], v3, s[8:11], s43 offen sc1
    v_mfma_f32_32x32x16_bf16 v[88:103], v[112:115], v[196:199], v[88:103]
    ds_read_b128 v[108:111], v5 offset:22528
    v_mul_f32 v56, v12, v56
    v_mul_f32 v57, v12, v57
    v_mul_f32 v58, v12, v58
    s_waitcnt lgkmcnt(3)
    v_mfma_f32_32x32x16_bf16 v[88:103], v[116:119], v[200:203], v[88:103]
    ds_read_b128 v[112:115], v5 offset:23552
    v_mul_f32 v59, v12, v59
    v_mul_f32 v60, v12, v60
    v_mul_f32 v61, v12, v61
    v_mfma_f32_32x32x16_bf16 v[88:103], v[120:123], v[204:207], v[88:103]
    ds_read_b128 v[116:119], v5 offset:24576
    v_mul_f32 v62, v12, v62
    v_mul_f32 v63, v12, v63
    v_exp_f32 v56, v56
    s_waitcnt lgkmcnt(3)
    v_mfma_f32_32x32x16_bf16 v[88:103], v[124:127], v[208:211], v[88:103]
    ds_read_b128 v[120:123], v5 offset:25600
    v_exp_f32 v57, v57
    v_exp_f32 v58, v58
    v_mfma_f32_32x32x16_bf16 v[88:103], v[104:107], v[212:215], v[88:103]
    ds_read_b128 v[124:127], v5 offset:26624
    v_exp_f32 v59, v59
    v_exp_f32 v60, v60
    s_waitcnt lgkmcnt(3)
    v_mfma_f32_32x32x16_bf16 v[88:103], v[108:111], v[216:219], v[88:103]
    ds_read_b128 v[104:107], v5 offset:27648
    v_exp_f32 v61, v61
    v_exp_f32 v62, v62
    v_mfma_f32_32x32x16_bf16 v[88:103], v[112:115], v[220:223], v[88:103]
    ds_read_b32 v1, v35 offset:0
    ds_read_b128 v[108:111], v5 offset:28672
    v_exp_f32 v63, v63
    v_fma_f32 v56, v56, v11, v11
    s_waitcnt lgkmcnt(4)
    v_mfma_f32_32x32x16_bf16 v[88:103], v[116:119], v[224:227], v[88:103]
    ds_read_b128 v[112:115], v5 offset:29696
    v_fma_f32 v57, v57, v11, v11
    v_fma_f32 v58, v58, v11, v11
    v_fma_f32 v59, v59, v11, v11
    v_mfma_f32_32x32x16_bf16 v[88:103], v[120:123], v[228:231], v[88:103]
    ds_read_b128 v[116:119], v5 offset:30720
    v_fma_f32 v60, v60, v11, v11
    v_fma_f32 v61, v61, v11, v11
    v_fma_f32 v62, v62, v11, v11
    s_waitcnt lgkmcnt(4)
    v_mfma_f32_32x32x16_bf16 v[88:103], v[124:127], v[232:235], v[88:103]
    ds_read_b128 v[120:123], v5 offset:31744
    v_add_u32 v13, 16, v9
    ds_write_b32 v0, v13
    v_fma_f32 v63, v63, v11, v11
    v_rcp_f32 v56, v56
    v_mfma_f32_32x32x16_bf16 v[88:103], v[104:107], v[236:239], v[88:103]
    s_waitcnt lgkmcnt(5)
    s_add_u32 s39, s7, 16
    v_cmp_gt_u32 s[30:31], s39, v1
    ds_read_b64 v[124:125], v22 offset:1536
    v_rcp_f32 v57, v57
    v_rcp_f32 v58, v58
    s_waitcnt lgkmcnt(4)
    v_mfma_f32_32x32x16_bf16 v[88:103], v[108:111], v[240:243], v[88:103]
    s_cmp_eq_u64 s[30:31], 0
    s_cbranch_scc1 L113
L112:
    s_add_u32 s38, s38, 1
    s_cmp_gt_u32 s38, 6400000
    s_cbranch_scc1 L113
    ds_read_b32 v1, v35 offset:0
    s_waitcnt lgkmcnt(0)
    v_cmp_gt_u32 vcc, s39, v1
    s_cbranch_vccnz L112
L113:
    ds_read_b128 v[104:107], v4 offset:32768
    v_rcp_f32 v59, v59
    v_rcp_f32 v60, v60
    v_mfma_f32_32x32x16_bf16 v[88:103], v[112:115], v[244:247], v[88:103]
    ds_read_b128 v[108:111], v4 offset:33792
    v_rcp_f32 v61, v61
    v_rcp_f32 v62, v62
    s_waitcnt lgkmcnt(4)
    v_mfma_f32_32x32x16_bf16 v[88:103], v[116:119], v[248:251], v[88:103]
    ds_read_b128 v[112:115], v4 offset:34816
    v_rcp_f32 v63, v63
    v_mul_f32 v56, v56, v64
    v_mfma_f32_32x32x16_bf16 v[88:103], v[120:123], v[252:255], v[88:103]
    ds_read_b128 v[116:119], v4 offset:35840
    v_mul_f32 v57, v57, v65
    v_mul_f32 v58, v58, v66
    v_mul_f32 v59, v59, v67
    s_waitcnt lgkmcnt(4)
    v_mfma_f32_32x32x16_bf16 v[88:103], v[124:127], v[16:19], v[88:103]
    ds_read_b128 v[120:123], v4 offset:36864
    v_mul_f32 v60, v60, v68
    v_mul_f32 v61, v61, v69
    v_mul_f32 v62, v62, v70
    s_waitcnt lgkmcnt(3)
    v_mfma_f32_32x32x16_bf16 v[40:55], v[104:107], v[128:131], 0
    ds_read_b128 v[124:127], v4 offset:37888
    v_mul_f32 v63, v63, v71
    v_cvt_pk_bf16_f32 v36, v56, v57
    v_cvt_pk_bf16_f32 v37, v58, v59
    v_mfma_f32_32x32x16_bf16 v[40:55], v[108:111], v[132:135], v[40:55]
    ds_read_b128 v[104:107], v4 offset:38912
    v_cvt_pk_bf16_f32 v38, v60, v61
    v_cvt_pk_bf16_f32 v39, v62, v63
    s_add_u32 s43, s60, 1024
    buffer_store_dwordx4 v[36:39], v3, s[8:11], s43 offen sc1
    s_waitcnt lgkmcnt(3)
    v_mfma_f32_32x32x16_bf16 v[40:55], v[112:115], v[136:139], v[40:55]
    ds_read_b128 v[108:111], v4 offset:39936
    v_mul_f32 v72, v12, v72
    v_mul_f32 v73, v12, v73
    v_mul_f32 v74, v12, v74
    v_mfma_f32_32x32x16_bf16 v[40:55], v[116:119], v[140:143], v[40:55]
    ds_read_b128 v[112:115], v4 offset:40960
    v_mul_f32 v75, v12, v75
    v_mul_f32 v76, v12, v76
    v_mul_f32 v77, v12, v77
    s_waitcnt lgkmcnt(3)
    v_mfma_f32_32x32x16_bf16 v[40:55], v[120:123], v[144:147], v[40:55]
    ds_read_b128 v[116:119], v4 offset:41984
    v_mul_f32 v78, v12, v78
    v_mul_f32 v79, v12, v79
    v_exp_f32 v72, v72
    v_mfma_f32_32x32x16_bf16 v[40:55], v[124:127], v[148:151], v[40:55]
    ds_read_b128 v[120:123], v4 offset:43008
    v_exp_f32 v73, v73
    v_exp_f32 v74, v74
    s_waitcnt lgkmcnt(3)
    v_mfma_f32_32x32x16_bf16 v[40:55], v[104:107], v[152:155], v[40:55]
    ds_read_b128 v[124:127], v4 offset:44032
    v_exp_f32 v75, v75
    v_exp_f32 v76, v76
    v_mfma_f32_32x32x16_bf16 v[40:55], v[108:111], v[156:159], v[40:55]
    ds_read_b128 v[104:107], v4 offset:45056
    v_exp_f32 v77, v77
    v_exp_f32 v78, v78
    s_waitcnt lgkmcnt(3)
    v_mfma_f32_32x32x16_bf16 v[40:55], v[112:115], v[160:163], v[40:55]
    ds_read_b128 v[108:111], v4 offset:46080
    v_exp_f32 v79, v79
    v_fma_f32 v72, v72, v11, v11
    v_mfma_f32_32x32x16_bf16 v[40:55], v[116:119], v[164:167], v[40:55]
    ds_read_b128 v[112:115], v4 offset:47104
    v_fma_f32 v73, v73, v11, v11
    v_fma_f32 v74, v74, v11, v11
    v_fma_f32 v75, v75, v11, v11
    s_waitcnt lgkmcnt(3)
    v_mfma_f32_32x32x16_bf16 v[40:55], v[120:123], v[168:171], v[40:55]
    ds_read_b128 v[116:119], v4 offset:48128
    v_fma_f32 v76, v76, v11, v11
    v_fma_f32 v77, v77, v11, v11
    v_fma_f32 v78, v78, v11, v11
    v_mfma_f32_32x32x16_bf16 v[40:55], v[124:127], v[172:175], v[40:55]
    ds_read_b128 v[120:123], v4 offset:49152
    v_fma_f32 v79, v79, v11, v11
    v_rcp_f32 v72, v72
    s_waitcnt lgkmcnt(3)
    v_mfma_f32_32x32x16_bf16 v[40:55], v[104:107], v[176:179], v[40:55]
    ds_read_b128 v[124:127], v4 offset:50176
    v_rcp_f32 v73, v73
    v_rcp_f32 v74, v74
    v_mfma_f32_32x32x16_bf16 v[40:55], v[108:111], v[180:183], v[40:55]
    ds_read_b128 v[104:107], v4 offset:51200
    v_rcp_f32 v75, v75
    v_rcp_f32 v76, v76
    s_waitcnt lgkmcnt(3)
    v_mfma_f32_32x32x16_bf16 v[40:55], v[112:115], v[184:187], v[40:55]
    ds_read_b128 v[108:111], v4 offset:52224
    v_rcp_f32 v77, v77
    v_rcp_f32 v78, v78
    v_mfma_f32_32x32x16_bf16 v[40:55], v[116:119], v[188:191], v[40:55]
    ds_read_b128 v[112:115], v4 offset:53248
    v_rcp_f32 v79, v79
    v_mul_f32 v72, v72, v80
    s_waitcnt lgkmcnt(3)
    v_mfma_f32_32x32x16_bf16 v[40:55], v[120:123], v[192:195], v[40:55]
    ds_read_b128 v[116:119], v4 offset:54272
    v_mul_f32 v73, v73, v81
    v_mul_f32 v74, v74, v82
    v_mul_f32 v75, v75, v83
    v_mfma_f32_32x32x16_bf16 v[40:55], v[124:127], v[196:199], v[40:55]
    ds_read_b128 v[120:123], v4 offset:55296
    v_mul_f32 v76, v76, v84
    v_mul_f32 v77, v77, v85
    v_mul_f32 v78, v78, v86
    s_waitcnt lgkmcnt(3)
    v_mfma_f32_32x32x16_bf16 v[40:55], v[104:107], v[200:203], v[40:55]
    ds_read_b128 v[124:127], v4 offset:56320
    v_mul_f32 v79, v79, v87
    v_cvt_pk_bf16_f32 v36, v72, v73
    v_cvt_pk_bf16_f32 v37, v74, v75
    v_mfma_f32_32x32x16_bf16 v[40:55], v[108:111], v[204:207], v[40:55]
    ds_read_b128 v[104:107], v4 offset:57344
    v_cvt_pk_bf16_f32 v38, v76, v77
    v_cvt_pk_bf16_f32 v39, v78, v79
    s_add_u32 s43, s60, 2048
    buffer_store_dwordx4 v[36:39], v3, s[8:11], s43 offen sc1
    s_waitcnt lgkmcnt(3)
    v_mfma_f32_32x32x16_bf16 v[40:55], v[112:115], v[208:211], v[40:55]
    ds_read_b128 v[108:111], v4 offset:58368
    v_mul_f32 v88, v12, v88
    v_mul_f32 v89, v12, v89
    v_mul_f32 v90, v12, v90
    v_mfma_f32_32x32x16_bf16 v[40:55], v[116:119], v[212:215], v[40:55]
    ds_read_b128 v[112:115], v4 offset:59392
    v_mul_f32 v91, v12, v91
    v_mul_f32 v92, v12, v92
    v_mul_f32 v93, v12, v93
    s_waitcnt lgkmcnt(3)
    v_mfma_f32_32x32x16_bf16 v[40:55], v[120:123], v[216:219], v[40:55]
    ds_read_b128 v[116:119], v4 offset:60416
    v_mul_f32 v94, v12, v94
    v_mul_f32 v95, v12, v95
    v_exp_f32 v88, v88
    v_mfma_f32_32x32x16_bf16 v[40:55], v[124:127], v[220:223], v[40:55]
    ds_read_b32 v1, v35 offset:0
    ds_read_b128 v[120:123], v4 offset:61440
    v_exp_f32 v89, v89
    v_exp_f32 v90, v90
    s_waitcnt lgkmcnt(4)
    v_mfma_f32_32x32x16_bf16 v[40:55], v[104:107], v[224:227], v[40:55]
    ds_read_b128 v[124:127], v4 offset:62464
    v_exp_f32 v91, v91
    v_exp_f32 v92, v92
    v_mfma_f32_32x32x16_bf16 v[40:55], v[108:111], v[228:231], v[40:55]
    ds_read_b128 v[104:107], v4 offset:63488
    v_exp_f32 v93, v93
    v_exp_f32 v94, v94
    s_waitcnt lgkmcnt(4)
    v_mfma_f32_32x32x16_bf16 v[40:55], v[112:115], v[232:235], v[40:55]
    ds_read_b128 v[108:111], v4 offset:64512
    v_add_u32 v13, 17, v9
    ds_write_b32 v0, v13
    v_exp_f32 v95, v95
    v_fma_f32 v88, v88, v11, v11
    v_mfma_f32_32x32x16_bf16 v[40:55], v[116:119], v[236:239], v[40:55]
    s_waitcnt lgkmcnt(5)
    s_add_u32 s39, s7, 17
    v_cmp_gt_u32 s[30:31], s39, v1
    ds_read_b64 v[112:113], v22 offset:1792
    v_fma_f32 v89, v89, v11, v11
    v_fma_f32 v90, v90, v11, v11
    v_fma_f32 v91, v91, v11, v11
    s_waitcnt lgkmcnt(4)
    v_mfma_f32_32x32x16_bf16 v[40:55], v[120:123], v[240:243], v[40:55]
    s_cmp_eq_u64 s[30:31], 0
    s_cbranch_scc1 L119
L118:
    s_add_u32 s38, s38, 1
    s_cmp_gt_u32 s38, 6400000
    s_cbranch_scc1 L119
    ds_read_b32 v1, v35 offset:0
    s_waitcnt lgkmcnt(0)
    v_cmp_gt_u32 vcc, s39, v1
    s_cbranch_vccnz L118
L119:
    ds_read_b128 v[116:119], v5 offset:32768
    v_fma_f32 v92, v92, v11, v11
    v_fma_f32 v93, v93, v11, v11
    v_fma_f32 v94, v94, v11, v11
    v_mfma_f32_32x32x16_bf16 v[40:55], v[124:127], v[244:247], v[40:55]
    ds_read_b128 v[120:123], v5 offset:33792
    v_fma_f32 v95, v95, v11, v11
    v_rcp_f32 v88, v88
    s_waitcnt lgkmcnt(4)
    v_mfma_f32_32x32x16_bf16 v[40:55], v[104:107], v[248:251], v[40:55]
    ds_read_b128 v[124:127], v5 offset:34816
    v_rcp_f32 v89, v89
    v_rcp_f32 v90, v90
    v_mfma_f32_32x32x16_bf16 v[40:55], v[108:111], v[252:255], v[40:55]
    ds_read_b128 v[104:107], v5 offset:35840
    v_rcp_f32 v91, v91
    v_rcp_f32 v92, v92
    s_waitcnt lgkmcnt(4)
    v_mfma_f32_32x32x16_bf16 v[40:55], v[112:115], v[16:19], v[40:55]
    ds_read_b128 v[108:111], v5 offset:36864
    v_rcp_f32 v93, v93
    v_rcp_f32 v94, v94
    s_waitcnt lgkmcnt(3)
    v_mfma_f32_32x32x16_bf16 v[56:71], v[116:119], v[128:131], 0
    ds_read_b128 v[112:115], v5 offset:37888
    v_rcp_f32 v95, v95
    v_mul_f32 v88, v88, v96
    v_mfma_f32_32x32x16_bf16 v[56:71], v[120:123], v[132:135], v[56:71]
    ds_read_b128 v[116:119], v5 offset:38912
    v_mul_f32 v89, v89, v97
    v_mul_f32 v90, v90, v98
    v_mul_f32 v91, v91, v99
    s_waitcnt lgkmcnt(3)
    v_mfma_f32_32x32x16_bf16 v[56:71], v[124:127], v[136:139], v[56:71]
    ds_read_b128 v[120:123], v5 offset:39936
    v_mul_f32 v92, v92, v100
    v_mul_f32 v93, v93, v101
    v_mul_f32 v94, v94, v102
    v_mfma_f32_32x32x16_bf16 v[56:71], v[104:107], v[140:143], v[56:71]
    ds_read_b128 v[124:127], v5 offset:40960
    v_mul_f32 v95, v95, v103
    v_cvt_pk_bf16_f32 v36, v88, v89
    v_cvt_pk_bf16_f32 v37, v90, v91
    s_waitcnt lgkmcnt(3)
    v_mfma_f32_32x32x16_bf16 v[56:71], v[108:111], v[144:147], v[56:71]
    ds_read_b128 v[104:107], v5 offset:41984
    v_cvt_pk_bf16_f32 v38, v92, v93
    v_cvt_pk_bf16_f32 v39, v94, v95
    s_add_u32 s43, s60, 3072
    buffer_store_dwordx4 v[36:39], v3, s[8:11], s43 offen sc1
    v_mfma_f32_32x32x16_bf16 v[56:71], v[112:115], v[148:151], v[56:71]
    ds_read_b128 v[108:111], v5 offset:43008
    v_mul_f32 v40, v12, v40
    v_mul_f32 v41, v12, v41
    v_mul_f32 v42, v12, v42
    s_waitcnt lgkmcnt(3)
    v_mfma_f32_32x32x16_bf16 v[56:71], v[116:119], v[152:155], v[56:71]
    ds_read_b128 v[112:115], v5 offset:44032
    v_mul_f32 v43, v12, v43
    v_mul_f32 v44, v12, v44
    v_mul_f32 v45, v12, v45
    v_mfma_f32_32x32x16_bf16 v[56:71], v[120:123], v[156:159], v[56:71]
    ds_read_b128 v[116:119], v5 offset:45056
    v_mul_f32 v46, v12, v46
    v_mul_f32 v47, v12, v47
    v_exp_f32 v40, v40
    s_waitcnt lgkmcnt(3)
    v_mfma_f32_32x32x16_bf16 v[56:71], v[124:127], v[160:163], v[56:71]
    ds_read_b128 v[120:123], v5 offset:46080
    v_exp_f32 v41, v41
    v_exp_f32 v42, v42
    v_mfma_f32_32x32x16_bf16 v[56:71], v[104:107], v[164:167], v[56:71]
    ds_read_b128 v[124:127], v5 offset:47104
    v_exp_f32 v43, v43
    v_exp_f32 v44, v44
    s_waitcnt lgkmcnt(3)
    v_mfma_f32_32x32x16_bf16 v[56:71], v[108:111], v[168:171], v[56:71]
    ds_read_b128 v[104:107], v5 offset:48128
    v_exp_f32 v45, v45
    v_exp_f32 v46, v46
    v_mfma_f32_32x32x16_bf16 v[56:71], v[112:115], v[172:175], v[56:71]
    ds_read_b128 v[108:111], v5 offset:49152
    v_exp_f32 v47, v47
    v_fma_f32 v40, v40, v11, v11
    s_waitcnt lgkmcnt(3)
    v_mfma_f32_32x32x16_bf16 v[56:71], v[116:119], v[176:179], v[56:71]
    ds_read_b128 v[112:115], v5 offset:50176
    v_fma_f32 v41, v41, v11, v11
    v_fma_f32 v42, v42, v11, v11
    v_fma_f32 v43, v43, v11, v11
    v_mfma_f32_32x32x16_bf16 v[56:71], v[120:123], v[180:183], v[56:71]
    ds_read_b128 v[116:119], v5 offset:51200
    v_fma_f32 v44, v44, v11, v11
    v_fma_f32 v45, v45, v11, v11
    v_fma_f32 v46, v46, v11, v11
    s_waitcnt lgkmcnt(3)
    v_mfma_f32_32x32x16_bf16 v[56:71], v[124:127], v[184:187], v[56:71]
    ds_read_b128 v[120:123], v5 offset:52224
    v_fma_f32 v47, v47, v11, v11
    v_rcp_f32 v40, v40
    v_mfma_f32_32x32x16_bf16 v[56:71], v[104:107], v[188:191], v[56:71]
    ds_read_b128 v[124:127], v5 offset:53248
    v_rcp_f32 v41, v41
    v_rcp_f32 v42, v42
    s_waitcnt lgkmcnt(3)
    v_mfma_f32_32x32x16_bf16 v[56:71], v[108:111], v[192:195], v[56:71]
    ds_read_b128 v[104:107], v5 offset:54272
    v_rcp_f32 v43, v43
    v_rcp_f32 v44, v44
    v_mfma_f32_32x32x16_bf16 v[56:71], v[112:115], v[196:199], v[56:71]
    ds_read_b128 v[108:111], v5 offset:55296
    v_rcp_f32 v45, v45
    v_rcp_f32 v46, v46
    s_add_u32 s40, s23, 7
    v_mov_b32 v13, s40
    s_waitcnt vmcnt(0)
    s_mov_b64 exec, 1
    s_cmp_lg_u32 s21, 0
    s_cbranch_scc1 L122
    buffer_store_dword v13, off, s[8:11], s24
L123:
    s_mov_b64 exec, -1
    s_waitcnt lgkmcnt(3)
    v_mfma_f32_32x32x16_bf16 v[56:71], v[116:119], v[200:203], v[56:71]
    ds_read_b128 v[112:115], v5 offset:56320
    v_rcp_f32 v47, v47
    v_mul_f32 v40, v40, v48
    v_mfma_f32_32x32x16_bf16 v[56:71], v[120:123], v[204:207], v[56:71]
    ds_read_b128 v[116:119], v5 offset:57344
    v_mul_f32 v41, v41, v49
    v_mul_f32 v42, v42, v50
    v_mul_f32 v43, v43, v51
    s_waitcnt lgkmcnt(3)
    v_mfma_f32_32x32x16_bf16 v[56:71], v[124:127], v[208:211], v[56:71]
    ds_read_b128 v[120:123], v5 offset:58368
    v_mul_f32 v44, v44, v52
    v_mul_f32 v45, v45, v53
    v_mul_f32 v46, v46, v54
    v_mfma_f32_32x32x16_bf16 v[56:71], v[104:107], v[212:215], v[56:71]
    ds_read_b128 v[124:127], v5 offset:59392
    v_mul_f32 v47, v47, v55
    v_cvt_pk_bf16_f32 v36, v40, v41
    v_cvt_pk_bf16_f32 v37, v42, v43
    s_waitcnt lgkmcnt(3)
    v_mfma_f32_32x32x16_bf16 v[56:71], v[108:111], v[216:219], v[56:71]
    ds_read_b128 v[104:107], v5 offset:60416
    v_cvt_pk_bf16_f32 v38, v44, v45
    v_cvt_pk_bf16_f32 v39, v46, v47
    s_add_u32 s43, s60, 4096
    buffer_store_dwordx4 v[36:39], v3, s[8:11], s43 offen sc1
    v_mfma_f32_32x32x16_bf16 v[56:71], v[112:115], v[220:223], v[56:71]
    ds_read_b32 v1, v35 offset:0
    ds_read_b128 v[108:111], v5 offset:61440
    s_waitcnt lgkmcnt(4)
    v_mfma_f32_32x32x16_bf16 v[56:71], v[116:119], v[224:227], v[56:71]
    ds_read_b128 v[112:115], v5 offset:62464
    v_mfma_f32_32x32x16_bf16 v[56:71], v[120:123], v[228:231], v[56:71]
    ds_read_b128 v[116:119], v5 offset:63488
    s_waitcnt lgkmcnt(4)
    v_mfma_f32_32x32x16_bf16 v[56:71], v[124:127], v[232:235], v[56:71]
    ds_read_b128 v[120:123], v5 offset:64512
    v_add_u32 v13, 18, v9
    ds_write_b32 v0, v13
    v_mfma_f32_32x32x16_bf16 v[56:71], v[104:107], v[236:239], v[56:71]
    s_waitcnt lgkmcnt(5)
    s_add_u32 s39, s7, 18
    v_cmp_gt_u32 s[30:31], s39, v1
    ds_read_b64 v[124:125], v22 offset:2048
    s_waitcnt lgkmcnt(4)
    v_mfma_f32_32x32x16_bf16 v[56:71], v[108:111], v[240:243], v[56:71]
    s_cmp_eq_u64 s[30:31], 0
    s_cbranch_scc1 L127
L126:
    s_add_u32 s38, s38, 1
    s_cmp_gt_u32 s38, 6400000
    s_cbranch_scc1 L127
    ds_read_b32 v1, v35 offset:0
    s_waitcnt lgkmcnt(0)
    v_cmp_gt_u32 vcc, s39, v1
    s_cbranch_vccnz L126
L127:
    ds_read_b128 v[104:107], v4 offset:0
    v_mfma_f32_32x32x16_bf16 v[56:71], v[112:115], v[244:247], v[56:71]
    ds_read_b128 v[108:111], v4 offset:1024
    s_waitcnt lgkmcnt(4)
    v_mfma_f32_32x32x16_bf16 v[56:71], v[116:119], v[248:251], v[56:71]
    ds_read_b128 v[112:115], v4 offset:2048
    v_mfma_f32_32x32x16_bf16 v[56:71], v[120:123], v[252:255], v[56:71]
    ds_read_b128 v[116:119], v4 offset:3072
    s_waitcnt lgkmcnt(4)
    v_mfma_f32_32x32x16_bf16 v[56:71], v[124:127], v[16:19], v[56:71]
    ds_read_b128 v[120:123], v4 offset:4096
    s_waitcnt lgkmcnt(3)
    v_mfma_f32_32x32x16_bf16 v[72:87], v[104:107], v[128:131], 0
    ds_read_b128 v[124:127], v4 offset:5120
    v_mfma_f32_32x32x16_bf16 v[72:87], v[108:111], v[132:135], v[72:87]
    ds_read_b128 v[104:107], v4 offset:6144
    s_nop 5
    v_mul_f32 v56, v12, v56
    v_mul_f32 v57, v12, v57
    v_mul_f32 v58, v12, v58
    buffer_load_dword v23, v21, s[8:11], s26 offen sc1
    s_waitcnt lgkmcnt(3)
    v_mfma_f32_32x32x16_bf16 v[72:87], v[112:115], v[136:139], v[72:87]
    ds_read_b128 v[108:111], v4 offset:7168
    v_mul_f32 v59, v12, v59
    v_mul_f32 v60, v12, v60
    v_mul_f32 v61, v12, v61
    v_mfma_f32_32x32x16_bf16 v[72:87], v[116:119], v[140:143], v[72:87]
    ds_read_b128 v[112:115], v4 offset:8192
    v_mul_f32 v62, v12, v62
    v_mul_f32 v63, v12, v63
    v_exp_f32 v56, v56
    s_waitcnt lgkmcnt(3)
    v_mfma_f32_32x32x16_bf16 v[72:87], v[120:123], v[144:147], v[72:87]
    ds_read_b128 v[116:119], v4 offset:9216
    v_exp_f32 v57, v57
    v_exp_f32 v58, v58
    v_mfma_f32_32x32x16_bf16 v[72:87], v[124:127], v[148:151], v[72:87]
    ds_read_b128 v[120:123], v4 offset:10240
    v_exp_f32 v59, v59
    v_exp_f32 v60, v60
    s_waitcnt lgkmcnt(3)
    v_mfma_f32_32x32x16_bf16 v[72:87], v[104:107], v[152:155], v[72:87]
    ds_read_b128 v[124:127], v4 offset:11264
    v_exp_f32 v61, v61
    v_exp_f32 v62, v62
    v_mfma_f32_32x32x16_bf16 v[72:87], v[108:111], v[156:159], v[72:87]
    ds_read_b128 v[104:107], v4 offset:12288
    v_exp_f32 v63, v63
    v_fma_f32 v56, v56, v11, v11
    s_waitcnt lgkmcnt(3)
    v_mfma_f32_32x32x16_bf16 v[72:87], v[112:115], v[160:163], v[72:87]
    ds_read_b128 v[108:111], v4 offset:13312
    v_fma_f32 v57, v57, v11, v11
    v_fma_f32 v58, v58, v11, v11
    v_fma_f32 v59, v59, v11, v11
    v_mfma_f32_32x32x16_bf16 v[72:87], v[116:119], v[164:167], v[72:87]
    ds_read_b128 v[112:115], v4 offset:14336
    v_fma_f32 v60, v60, v11, v11
    v_fma_f32 v61, v61, v11, v11
    v_fma_f32 v62, v62, v11, v11
    s_waitcnt lgkmcnt(3)
    v_mfma_f32_32x32x16_bf16 v[72:87], v[120:123], v[168:171], v[72:87]
    ds_read_b128 v[116:119], v4 offset:15360
    v_fma_f32 v63, v63, v11, v11
    v_rcp_f32 v56, v56
    v_mfma_f32_32x32x16_bf16 v[72:87], v[124:127], v[172:175], v[72:87]
    ds_read_b128 v[120:123], v4 offset:16384
    v_rcp_f32 v57, v57
    v_rcp_f32 v58, v58
    s_waitcnt lgkmcnt(3)
    v_mfma_f32_32x32x16_bf16 v[72:87], v[104:107], v[176:179], v[72:87]
    ds_read_b128 v[124:127], v4 offset:17408
    v_rcp_f32 v59, v59
    v_rcp_f32 v60, v60
    v_mfma_f32_32x32x16_bf16 v[72:87], v[108:111], v[180:183], v[72:87]
    ds_read_b128 v[104:107], v4 offset:18432
    v_rcp_f32 v61, v61
    v_rcp_f32 v62, v62
    s_waitcnt lgkmcnt(3)
    v_mfma_f32_32x32x16_bf16 v[72:87], v[112:115], v[184:187], v[72:87]
    ds_read_b128 v[108:111], v4 offset:19456
    v_rcp_f32 v63, v63
    v_mul_f32 v56, v56, v64
    v_mfma_f32_32x32x16_bf16 v[72:87], v[116:119], v[188:191], v[72:87]
    ds_read_b128 v[112:115], v4 offset:20480
    v_mul_f32 v57, v57, v65
    v_mul_f32 v58, v58, v66
    v_mul_f32 v59, v59, v67
    s_add_u32 s61, s23, 7
    s_waitcnt vmcnt(0)
    v_cmp_gt_u32 vcc, s61, v23
    s_cbranch_vccz L128
    s_mov_b32 s41, 0
L129:
    buffer_load_dword v13, v21, s[8:11], s26 offen sc1
    s_add_u32 s41, s41, 1
    s_cmp_gt_u32 s41, 400000
    s_cbranch_scc1 L130
    s_waitcnt vmcnt(0)
    v_cmp_gt_u32 vcc, s61, v13
    s_cbranch_vccnz L129
L130:
L128:
    s_waitcnt lgkmcnt(3)
    v_mfma_f32_32x32x16_bf16 v[72:87], v[120:123], v[192:195], v[72:87]
    ds_read_b128 v[116:119], v4 offset:21504
    v_mul_f32 v60, v60, v68
    v_mul_f32 v61, v61, v69
    v_mul_f32 v62, v62, v70
    s_add_u32 s43, s29, 0
    buffer_load_dwordx4 v[128:131], v3, s[8:11], s43 offen sc1
    v_mfma_f32_32x32x16_bf16 v[72:87], v[124:127], v[196:199], v[72:87]
    ds_read_b128 v[120:123], v4 offset:22528
    v_mul_f32 v63, v63, v71
    v_cvt_pk_bf16_f32 v36, v56, v57
    v_cvt_pk_bf16_f32 v37, v58, v59
    s_add_u32 s43, s29, 7168
    buffer_load_dwordx4 v[132:135], v3, s[8:11], s43 offen sc1
    s_waitcnt lgkmcnt(3)
    v_mfma_f32_32x32x16_bf16 v[72:87], v[104:107], v[200:203], v[72:87]
    ds_read_b128 v[124:127], v4 offset:23552
    v_cvt_pk_bf16_f32 v38, v60, v61
    v_cvt_pk_bf16_f32 v39, v62, v63
    s_add_u32 s43, s60, 5120
    buffer_store_dwordx4 v[36:39], v3, s[8:11], s43 offen sc1
    s_add_u32 s43, s29, 14336
    buffer_load_dwordx4 v[136:139], v3, s[8:11], s43 offen sc1
    v_mfma_f32_32x32x16_bf16 v[72:87], v[108:111], v[204:207], v[72:87]
    ds_read_b128 v[104:107], v4 offset:24576
    s_add_u32 s43, s29, 21504
    buffer_load_dwordx4 v[140:143], v3, s[8:11], s43 offen sc1
    s_waitcnt lgkmcnt(3)
    v_mfma_f32_32x32x16_bf16 v[72:87], v[112:115], v[208:211], v[72:87]
    ds_read_b128 v[108:111], v4 offset:25600
    s_add_u32 s43, s29, 28672
    buffer_load_dwordx4 v[144:147], v3, s[8:11], s43 offen sc1
    v_mfma_f32_32x32x16_bf16 v[72:87], v[116:119], v[212:215], v[72:87]
    ds_read_b128 v[112:115], v4 offset:26624
    s_add_u32 s43, s29, 35840
    buffer_load_dwordx4 v[148:151], v3, s[8:11], s43 offen sc1
    s_waitcnt lgkmcnt(3)
    v_mfma_f32_32x32x16_bf16 v[72:87], v[120:123], v[216:219], v[72:87]
    ds_read_b128 v[116:119], v4 offset:27648
    s_add_u32 s43, s29, 43008
    buffer_load_dwordx4 v[152:155], v3, s[8:11], s43 offen sc1
    v_mfma_f32_32x32x16_bf16 v[72:87], v[124:127], v[220:223], v[72:87]
    ds_read_b128 v[120:123], v4 offset:28672
    s_add_u32 s43, s29, 50176
    buffer_load_dwordx4 v[156:159], v3, s[8:11], s43 offen sc1
    s_waitcnt lgkmcnt(3)
    v_mfma_f32_32x32x16_bf16 v[72:87], v[104:107], v[224:227], v[72:87]
    ds_read_b128 v[124:127], v4 offset:29696
    s_add_u32 s43, s29, 1024
    buffer_load_dwordx4 v[160:163], v3, s[8:11], s43 offen sc1
    v_mfma_f32_32x32x16_bf16 v[72:87], v[108:111], v[228:231], v[72:87]
    ds_read_b128 v[104:107], v4 offset:30720
    s_add_u32 s43, s29, 8192
    buffer_load_dwordx4 v[164:167], v3, s[8:11], s43 offen sc1
    s_waitcnt lgkmcnt(3)
    v_mfma_f32_32x32x16_bf16 v[72:87], v[112:115], v[232:235], v[72:87]
    ds_read_b128 v[108:111], v4 offset:31744
    v_add_u32 v13, 19, v9
    ds_write_b32 v0, v13
    s_add_u32 s43, s29, 15360
    buffer_load_dwordx4 v[168:171], v3, s[8:11], s43 offen sc1
    v_mfma_f32_32x32x16_bf16 v[72:87], v[116:119], v[236:239], v[72:87]
    ds_read_b64 v[112:113], v22 offset:2304
    s_add_u32 s43, s29, 22528
    buffer_load_dwordx4 v[172:175], v3, s[8:11], s43 offen sc1
    s_waitcnt lgkmcnt(4)
    v_mfma_f32_32x32x16_bf16 v[72:87], v[120:123], v[240:243], v[72:87]
    s_add_u32 s43, s29, 29696
    buffer_load_dwordx4 v[176:179], v3, s[8:11], s43 offen sc1
    v_mfma_f32_32x32x16_bf16 v[72:87], v[124:127], v[244:247], v[72:87]
    s_add_u32 s43, s29, 36864
    buffer_load_dwordx4 v[180:183], v3, s[8:11], s43 offen sc1
    s_waitcnt lgkmcnt(2)
    v_mfma_f32_32x32x16_bf16 v[72:87], v[104:107], v[248:251], v[72:87]
    s_add_u32 s43, s29, 44032
    buffer_load_dwordx4 v[184:187], v3, s[8:11], s43 offen sc1
    v_mfma_f32_32x32x16_bf16 v[72:87], v[108:111], v[252:255], v[72:87]
    s_add_u32 s43, s29, 51200
    buffer_load_dwordx4 v[188:191], v3, s[8:11], s43 offen sc1
    s_waitcnt lgkmcnt(0)
    v_mfma_f32_32x32x16_bf16 v[72:87], v[112:115], v[16:19], v[72:87]
    s_nop 11
    v_mul_f32 v72, v12, v72
    v_mul_f32 v73, v12, v73
    v_mul_f32 v74, v12, v74
    v_mul_f32 v75, v12, v75
    v_mul_f32 v76, v12, v76
    v_mul_f32 v77, v12, v77
    v_mul_f32 v78, v12, v78
    v_mul_f32 v79, v12, v79
    v_exp_f32 v72, v72
    v_exp_f32 v73, v73
    v_exp_f32 v74, v74
    v_exp_f32 v75, v75
    v_exp_f32 v76, v76
    v_exp_f32 v77, v77
    v_exp_f32 v78, v78
    v_exp_f32 v79, v79
    v_fma_f32 v72, v72, v11, v11
    v_fma_f32 v73, v73, v11, v11
    v_fma_f32 v74, v74, v11, v11
    v_fma_f32 v75, v75, v11, v11
    v_fma_f32 v76, v76, v11, v11
    v_fma_f32 v77, v77, v11, v11
    v_fma_f32 v78, v78, v11, v11
    v_fma_f32 v79, v79, v11, v11
    v_rcp_f32 v72, v72
    v_rcp_f32 v73, v73
    v_rcp_f32 v74, v74
    v_rcp_f32 v75, v75
    v_rcp_f32 v76, v76
    v_rcp_f32 v77, v77
    v_rcp_f32 v78, v78
    v_rcp_f32 v79, v79
    v_mul_f32 v72, v72, v80
    v_mul_f32 v73, v73, v81
    v_mul_f32 v74, v74, v82
    v_mul_f32 v75, v75, v83
    v_mul_f32 v76, v76, v84
    v_mul_f32 v77, v77, v85
    v_mul_f32 v78, v78, v86
    v_mul_f32 v79, v79, v87
    v_cvt_pk_bf16_f32 v36, v72, v73
    v_cvt_pk_bf16_f32 v37, v74, v75
    v_cvt_pk_bf16_f32 v38, v76, v77
    v_cvt_pk_bf16_f32 v39, v78, v79
    s_add_u32 s43, s60, 6144
    buffer_store_dwordx4 v[36:39], v3, s[8:11], s43 offen sc1
    s_add_u32 s58, s53, 6291456
    s_add_u32 s58, s58, s34
    s_add_u32 s59, s54, 5767168
    s_add_u32 s59, s59, s34
    v_lshlrev_b32 v40, 16, v24
    v_and_b32 v41, 0xffff0000, v24
    v_lshlrev_b32 v42, 16, v25
    v_and_b32 v43, 0xffff0000, v25
    v_lshlrev_b32 v44, 16, v26
    v_and_b32 v45, 0xffff0000, v26
    v_lshlrev_b32 v46, 16, v27
    v_and_b32 v47, 0xffff0000, v27
    v_lshlrev_b32 v48, 16, v28
    v_and_b32 v49, 0xffff0000, v28
    v_lshlrev_b32 v50, 16, v29
    v_and_b32 v51, 0xffff0000, v29
    v_lshlrev_b32 v52, 16, v30
    v_and_b32 v53, 0xffff0000, v30
    v_lshlrev_b32 v54, 16, v31
    v_and_b32 v55, 0xffff0000, v31
    v_xor_b32 v36, 64, v32
    v_add_u32 v37, 0x10000, v36
    v_add_u32 v38, 0x20000, v36
    s_xor_b32 s40, s6, 1
    s_lshl_b32 s40, s40, 12
    s_add_u32 s40, s40, 131072
    v_add_u32 v39, s40, v3
    ds_read_b32 v1, v35 offset:0
    s_waitcnt lgkmcnt(0)
    s_add_u32 s39, s7, 19
    v_cmp_gt_u32 s[30:31], s39, v1
    s_nop 0
    s_cmp_eq_u64 s[30:31], 0
    s_cbranch_scc1 L136
L135:
    s_add_u32 s38, s38, 1
    s_cmp_gt_u32 s38, 6400000
    s_cbranch_scc1 L136
    ds_read_b32 v1, v35 offset:0
    s_waitcnt lgkmcnt(0)
    v_cmp_gt_u32 vcc, s39, v1
    s_cbranch_vccnz L135
L136:
    ds_read_b64_tr_b16 v[96:97], v34 offset:0
    ds_read_b64_tr_b16 v[98:99], v34 offset:512
    ds_read_b64_tr_b16 v[100:101], v38 offset:0
    ds_read_b64_tr_b16 v[102:103], v38 offset:512
    ds_read_b64_tr_b16 v[104:105], v34 offset:4096
    ds_read_b64_tr_b16 v[106:107], v34 offset:4608
    ds_read_b64_tr_b16 v[108:109], v38 offset:4096
    ds_read_b64_tr_b16 v[110:111], v38 offset:4608
    ds_read_b64_tr_b16 v[112:113], v34 offset:8192
    ds_read_b64_tr_b16 v[114:115], v34 offset:8704
    ds_read_b64_tr_b16 v[116:117], v38 offset:8192
    ds_read_b64_tr_b16 v[118:119], v38 offset:8704
    s_waitcnt vmcnt(17)
    s_waitcnt lgkmcnt(10)
    v_mfma_f32_32x32x16_bf16 v[40:55], v[96:99], v[128:131], v[40:55]
    ds_read_b64_tr_b16 v[120:121], v34 offset:12288
    ds_read_b64_tr_b16 v[122:123], v34 offset:12800
    s_waitcnt lgkmcnt(10)
    v_mfma_f32_32x32x16_bf16 v[56:71], v[100:103], v[128:131], 0
    ds_read_b64_tr_b16 v[124:125], v38 offset:12288
    ds_read_b64_tr_b16 v[126:127], v38 offset:12800
    s_waitcnt vmcnt(16)
    s_waitcnt lgkmcnt(10)
    v_mfma_f32_32x32x16_bf16 v[40:55], v[104:107], v[132:135], v[40:55]
    ds_read_b64_tr_b16 v[96:97], v34 offset:16384
    ds_read_b64_tr_b16 v[98:99], v34 offset:16896
    s_waitcnt lgkmcnt(10)
    v_mfma_f32_32x32x16_bf16 v[56:71], v[108:111], v[132:135], v[56:71]
    ds_read_b64_tr_b16 v[100:101], v38 offset:16384
    ds_read_b64_tr_b16 v[102:103], v38 offset:16896
    s_waitcnt vmcnt(14)
    s_waitcnt lgkmcnt(10)
    v_mfma_f32_32x32x16_bf16 v[40:55], v[112:115], v[136:139], v[40:55]
    ds_read_b64_tr_b16 v[104:105], v34 offset:20480
    ds_read_b64_tr_b16 v[106:107], v34 offset:20992
    s_waitcnt lgkmcnt(10)
    v_mfma_f32_32x32x16_bf16 v[56:71], v[116:119], v[136:139], v[56:71]
    ds_read_b64_tr_b16 v[108:109], v38 offset:20480
    ds_read_b64_tr_b16 v[110:111], v38 offset:20992
    s_add_u32 s43, s29, 2048
    buffer_load_dwordx4 v[192:195], v3, s[8:11], s43 offen sc1
    s_waitcnt vmcnt(14)
    s_waitcnt lgkmcnt(10)
    v_mfma_f32_32x32x16_bf16 v[40:55], v[120:123], v[140:143], v[40:55]
    ds_read_b64_tr_b16 v[112:113], v34 offset:24576
    ds_read_b64_tr_b16 v[114:115], v34 offset:25088
    s_waitcnt lgkmcnt(10)
    v_mfma_f32_32x32x16_bf16 v[56:71], v[124:127], v[140:143], v[56:71]
    ds_read_b64_tr_b16 v[116:117], v38 offset:24576
    ds_read_b64_tr_b16 v[118:119], v38 offset:25088
    v_add_u32 v13, 20, v9
    ds_write_b32 v0, v13
    s_add_u32 s43, s29, 9216
    buffer_load_dwordx4 v[196:199], v3, s[8:11], s43 offen sc1
    s_waitcnt vmcnt(14)
    s_waitcnt lgkmcnt(11)
    v_mfma_f32_32x32x16_bf16 v[40:55], v[96:99], v[144:147], v[40:55]
    ds_read_b64_tr_b16 v[120:121], v33 offset:0
    ds_read_b64_tr_b16 v[122:123], v33 offset:512
    s_waitcnt lgkmcnt(11)
    v_mfma_f32_32x32x16_bf16 v[56:71], v[100:103], v[144:147], v[56:71]
    ds_read_b64_tr_b16 v[124:125], v37 offset:0
    ds_read_b64_tr_b16 v[126:127], v37 offset:512
    s_add_u32 s43, s29, 16384
    buffer_load_dwordx4 v[200:203], v3, s[8:11], s43 offen sc1
    s_add_u32 s40, s23, 9
    v_mov_b32 v13, s40
    s_waitcnt vmcnt(3)
    s_mov_b64 exec, 1
    s_cmp_lg_u32 s21, 0
    s_cbranch_scc1 L137
    buffer_store_dword v13, off, s[8:11], s24
L138:
    s_mov_b64 exec, -1
    s_waitcnt lgkmcnt(11)
    v_mfma_f32_32x32x16_bf16 v[40:55], v[104:107], v[148:151], v[40:55]
    ds_read_b64_tr_b16 v[96:97], v33 offset:4096
    ds_read_b64_tr_b16 v[98:99], v33 offset:4608
    s_waitcnt lgkmcnt(11)
    v_mfma_f32_32x32x16_bf16 v[56:71], v[108:111], v[148:151], v[56:71]
    ds_read_b64_tr_b16 v[100:101], v37 offset:4096
    ds_read_b64_tr_b16 v[102:103], v37 offset:4608
    s_add_u32 s43, s29, 23552
    buffer_load_dwordx4 v[204:207], v3, s[8:11], s43 offen sc1
    s_waitcnt lgkmcnt(11)
    v_mfma_f32_32x32x16_bf16 v[40:55], v[112:115], v[152:155], v[40:55]
    ds_read_b64_tr_b16 v[104:105], v33 offset:8192
    ds_read_b64_tr_b16 v[106:107], v33 offset:8704
    s_waitcnt lgkmcnt(11)
    v_mfma_f32_32x32x16_bf16 v[56:71], v[116:119], v[152:155], v[56:71]
    ds_read_b64_tr_b16 v[108:109], v37 offset:8192
    ds_read_b64_tr_b16 v[110:111], v37 offset:8704
    s_add_u32 s43, s29, 30720
    buffer_load_dwordx4 v[208:211], v3, s[8:11], s43 offen sc1
    s_waitcnt lgkmcnt(10)
    v_mfma_f32_32x32x16_bf16 v[40:55], v[120:123], v[156:159], v[40:55]
    ds_read_b64_tr_b16 v[112:113], v33 offset:12288
    ds_read_b64_tr_b16 v[114:115], v33 offset:12800
    s_waitcnt lgkmcnt(10)
    v_mfma_f32_32x32x16_bf16 v[56:71], v[124:127], v[156:159], v[56:71]
    ds_read_b64_tr_b16 v[116:117], v37 offset:12288
    ds_read_b64_tr_b16 v[118:119], v37 offset:12800
    s_add_u32 s43, s29, 37888
    buffer_load_dwordx4 v[212:215], v3, s[8:11], s43 offen sc1
    s_waitcnt lgkmcnt(10)
    v_mfma_f32_32x32x16_bf16 v[40:55], v[96:99], v[160:163], v[40:55]
    ds_read_b64_tr_b16 v[120:121], v33 offset:16384
    ds_read_b64_tr_b16 v[122:123], v33 offset:16896
    s_waitcnt lgkmcnt(10)
    v_mfma_f32_32x32x16_bf16 v[56:71], v[100:103], v[160:163], v[56:71]
    ds_read_b64_tr_b16 v[124:125], v37 offset:16384
    ds_read_b64_tr_b16 v[126:127], v37 offset:16896
    s_add_u32 s43, s29, 45056
    buffer_load_dwordx4 v[216:219], v3, s[8:11], s43 offen sc1
    s_waitcnt lgkmcnt(10)
    v_mfma_f32_32x32x16_bf16 v[40:55], v[104:107], v[164:167], v[40:55]
    ds_read_b64_tr_b16 v[96:97], v33 offset:20480
    ds_read_b64_tr_b16 v[98:99], v33 offset:20992
    s_waitcnt lgkmcnt(10)
    v_mfma_f32_32x32x16_bf16 v[56:71], v[108:111], v[164:167], v[56:71]
    ds_read_b64_tr_b16 v[100:101], v37 offset:20480
    ds_read_b64_tr_b16 v[102:103], v37 offset:20992
    s_add_u32 s43, s29, 52224
    buffer_load_dwordx4 v[220:223], v3, s[8:11], s43 offen sc1
    buffer_load_dword v23, v21, s[8:11], s26 offen sc1
    s_waitcnt lgkmcnt(10)
    v_mfma_f32_32x32x16_bf16 v[40:55], v[112:115], v[168:171], v[40:55]
    ds_read_b64_tr_b16 v[104:105], v33 offset:24576
    ds_read_b64_tr_b16 v[106:107], v33 offset:25088
    s_waitcnt lgkmcnt(10)
    v_mfma_f32_32x32x16_bf16 v[56:71], v[116:119], v[168:171], v[56:71]
    ds_read_b64_tr_b16 v[108:109], v37 offset:24576
    ds_read_b64_tr_b16 v[110:111], v37 offset:25088
    s_add_u32 s43, s29, 3072
    buffer_load_dwordx4 v[224:227], v3, s[8:11], s43 offen sc1
    s_waitcnt lgkmcnt(10)
    v_mfma_f32_32x32x16_bf16 v[40:55], v[120:123], v[172:175], v[40:55]
    ds_read_b64_tr_b16 v[112:113], v33 offset:28672
    ds_read_b64_tr_b16 v[114:115], v33 offset:29184
    s_waitcnt lgkmcnt(10)
    v_mfma_f32_32x32x16_bf16 v[56:71], v[124:127], v[172:175], v[56:71]
    ds_read_b64_tr_b16 v[116:117], v37 offset:28672
    ds_read_b64_tr_b16 v[118:119], v37 offset:29184
    v_add_u32 v13, 21, v9
    ds_write_b32 v0, v13
    s_add_u32 s43, s29, 10240
    buffer_load_dwordx4 v[228:231], v3, s[8:11], s43 offen sc1
    s_waitcnt lgkmcnt(11)
    v_mfma_f32_32x32x16_bf16 v[40:55], v[96:99], v[176:179], v[40:55]
    ds_read_b64_tr_b16 v[120:121], v32 offset:32768
    ds_read_b64_tr_b16 v[122:123], v32 offset:33280
    s_waitcnt lgkmcnt(11)
    v_mfma_f32_32x32x16_bf16 v[56:71], v[100:103], v[176:179], v[56:71]
    ds_read_b64_tr_b16 v[124:125], v36 offset:32768
    ds_read_b64_tr_b16 v[126:127], v36 offset:33280
    s_add_u32 s43, s29, 17408
    buffer_load_dwordx4 v[232:235], v3, s[8:11], s43 offen sc1
    s_waitcnt lgkmcnt(11)
    v_mfma_f32_32x32x16_bf16 v[40:55], v[104:107], v[180:183], v[40:55]
    ds_read_b64_tr_b16 v[96:97], v32 offset:36864
    ds_read_b64_tr_b16 v[98:99], v32 offset:37376
    s_waitcnt lgkmcnt(11)
    v_mfma_f32_32x32x16_bf16 v[56:71], v[108:111], v[180:183], v[56:71]
    ds_read_b64_tr_b16 v[100:101], v36 offset:36864
    ds_read_b64_tr_b16 v[102:103], v36 offset:37376
    s_add_u32 s43, s29, 24576
    buffer_load_dwordx4 v[236:239], v3, s[8:11], s43 offen sc1
    s_waitcnt lgkmcnt(11)
    v_mfma_f32_32x32x16_bf16 v[40:55], v[112:115], v[184:187], v[40:55]
    ds_read_b64_tr_b16 v[104:105], v32 offset:40960
    ds_read_b64_tr_b16 v[106:107], v32 offset:41472
    s_waitcnt lgkmcnt(11)
    v_mfma_f32_32x32x16_bf16 v[56:71], v[116:119], v[184:187], v[56:71]
    ds_read_b64_tr_b16 v[108:109], v36 offset:40960
    ds_read_b64_tr_b16 v[110:111], v36 offset:41472
    s_add_u32 s43, s29, 31744
    buffer_load_dwordx4 v[240:243], v3, s[8:11], s43 offen sc1
    s_waitcnt lgkmcnt(10)
    v_mfma_f32_32x32x16_bf16 v[40:55], v[120:123], v[188:191], v[40:55]
    ds_read_b64_tr_b16 v[112:113], v32 offset:45056
    ds_read_b64_tr_b16 v[114:115], v32 offset:45568
    s_waitcnt lgkmcnt(10)
    v_mfma_f32_32x32x16_bf16 v[56:71], v[124:127], v[188:191], v[56:71]
    ds_read_b64_tr_b16 v[116:117], v36 offset:45056
    ds_read_b64_tr_b16 v[118:119], v36 offset:45568
    s_add_u32 s43, s29, 38912
    buffer_load_dwordx4 v[244:247], v3, s[8:11], s43 offen sc1
    s_waitcnt vmcnt(15)
    s_waitcnt lgkmcnt(10)
    v_mfma_f32_32x32x16_bf16 v[40:55], v[96:99], v[192:195], v[40:55]
    ds_read_b64_tr_b16 v[120:121], v32 offset:49152
    ds_read_b64_tr_b16 v[122:123], v32 offset:49664
    s_waitcnt lgkmcnt(10)
    v_mfma_f32_32x32x16_bf16 v[56:71], v[100:103], v[192:195], v[56:71]
    ds_read_b64_tr_b16 v[124:125], v36 offset:49152
    ds_read_b64_tr_b16 v[126:127], v36 offset:49664
    s_add_u32 s43, s29, 46080
    buffer_load_dwordx4 v[248:251], v3, s[8:11], s43 offen sc1
    s_add_u32 s61, s23, 9
    s_waitcnt vmcnt(7)
    v_cmp_gt_u32 vcc, s61, v23
    s_cbranch_vccz L139
    s_mov_b32 s41, 0
L140:
    buffer_load_dword v13, v21, s[8:11], s26 offen sc1
    s_add_u32 s41, s41, 1
    s_cmp_gt_u32 s41, 400000
    s_cbranch_scc1 L141
    s_waitcnt vmcnt(0)
    v_cmp_gt_u32 vcc, s61, v13
    s_cbranch_vccnz L140
L141:
L139:
    s_waitcnt lgkmcnt(10)
    v_mfma_f32_32x32x16_bf16 v[40:55], v[104:107], v[196:199], v[40:55]
    ds_read_b32 v1, v35 offset:0
    ds_read_b64_tr_b16 v[96:97], v32 offset:53248
    ds_read_b64_tr_b16 v[98:99], v32 offset:53760
    s_waitcnt lgkmcnt(11)
    v_mfma_f32_32x32x16_bf16 v[56:71], v[108:111], v[196:199], v[56:71]
    ds_read_b64_tr_b16 v[100:101], v36 offset:53248
    ds_read_b64_tr_b16 v[102:103], v36 offset:53760
    s_add_u32 s43, s29, 53248
    buffer_load_dwordx4 v[252:255], v3, s[8:11], s43 offen sc1
    s_waitcnt lgkmcnt(11)
    v_mfma_f32_32x32x16_bf16 v[40:55], v[112:115], v[200:203], v[40:55]
    ds_read_b64_tr_b16 v[104:105], v32 offset:57344
    ds_read_b64_tr_b16 v[106:107], v32 offset:57856
    s_waitcnt lgkmcnt(11)
    v_mfma_f32_32x32x16_bf16 v[56:71], v[116:119], v[200:203], v[56:71]
    ds_read_b64_tr_b16 v[108:109], v36 offset:57344
    ds_read_b64_tr_b16 v[110:111], v36 offset:57856
    s_add_u32 s43, s29, 4096
    buffer_load_dwordx4 v[128:131], v3, s[8:11], s43 offen sc1
    s_waitcnt lgkmcnt(11)
    v_mfma_f32_32x32x16_bf16 v[40:55], v[120:123], v[204:207], v[40:55]
    ds_read_b64_tr_b16 v[112:113], v32 offset:61440
    ds_read_b64_tr_b16 v[114:115], v32 offset:61952
    s_waitcnt lgkmcnt(11)
    v_mfma_f32_32x32x16_bf16 v[56:71], v[124:127], v[204:207], v[56:71]
    s_waitcnt lgkmcnt(10)
    s_add_u32 s39, s7, 20
    v_cmp_gt_u32 s[30:31], s39, v1
    ds_read_b64_tr_b16 v[116:117], v36 offset:61440
    ds_read_b64_tr_b16 v[118:119], v36 offset:61952
    v_add_u32 v13, 22, v9
    ds_write_b32 v0, v13
    s_add_u32 s43, s29, 11264
    buffer_load_dwordx4 v[132:135], v3, s[8:11], s43 offen sc1
    s_waitcnt lgkmcnt(11)
    v_mfma_f32_32x32x16_bf16 v[40:55], v[96:99], v[208:211], v[40:55]
    s_cmp_eq_u64 s[30:31], 0
    s_cbranch_scc1 L143
L142:
    s_add_u32 s38, s38, 1
    s_cmp_gt_u32 s38, 6400000
    s_cbranch_scc1 L143
    ds_read_b32 v1, v35 offset:0
    s_waitcnt lgkmcnt(0)
    v_cmp_gt_u32 vcc, s39, v1
    s_cbranch_vccnz L142
L143:
    ds_read_b64_tr_b16 v[120:121], v33 offset:32768
    ds_read_b64_tr_b16 v[122:123], v33 offset:33280
    s_waitcnt lgkmcnt(11)
    v_mfma_f32_32x32x16_bf16 v[56:71], v[100:103], v[208:211], v[56:71]
    ds_read_b64_tr_b16 v[124:125], v37 offset:32768
    ds_read_b64_tr_b16 v[126:127], v37 offset:33280
    s_add_u32 s43, s29, 18432
    buffer_load_dwordx4 v[136:139], v3, s[8:11], s43 offen sc1
    s_waitcnt lgkmcnt(11)
    v_mfma_f32_32x32x16_bf16 v[40:55], v[104:107], v[212:215], v[40:55]
    ds_read_b64_tr_b16 v[96:97], v33 offset:36864
    ds_read_b64_tr_b16 v[98:99], v33 offset:37376
    s_waitcnt lgkmcnt(11)
    v_mfma_f32_32x32x16_bf16 v[56:71], v[108:111], v[212:215], v[56:71]
    ds_read_b64_tr_b16 v[100:101], v37 offset:36864
    ds_read_b64_tr_b16 v[102:103], v37 offset:37376
    s_add_u32 s43, s29, 25600
    buffer_load_dwordx4 v[140:143], v3, s[8:11], s43 offen sc1
    s_waitcnt lgkmcnt(11)
    v_mfma_f32_32x32x16_bf16 v[40:55], v[112:115], v[216:219], v[40:55]
    ds_read_b64_tr_b16 v[104:105], v33 offset:40960
    ds_read_b64_tr_b16 v[106:107], v33 offset:41472
    s_waitcnt lgkmcnt(11)
    v_mfma_f32_32x32x16_bf16 v[56:71], v[116:119], v[216:219], v[56:71]
    ds_read_b64_tr_b16 v[108:109], v37 offset:40960
    ds_read_b64_tr_b16 v[110:111], v37 offset:41472
    s_add_u32 s43, s29, 32768
    buffer_load_dwordx4 v[144:147], v3, s[8:11], s43 offen sc1
    s_waitcnt lgkmcnt(10)
    v_mfma_f32_32x32x16_bf16 v[40:55], v[120:123], v[220:223], v[40:55]
    ds_read_b64_tr_b16 v[112:113], v33 offset:45056
    ds_read_b64_tr_b16 v[114:115], v33 offset:45568
    s_waitcnt lgkmcnt(10)
    v_mfma_f32_32x32x16_bf16 v[56:71], v[124:127], v[220:223], v[56:71]
    ds_read_b64_tr_b16 v[116:117], v37 offset:45056
    ds_read_b64_tr_b16 v[118:119], v37 offset:45568
    s_add_u32 s43, s29, 39936
    buffer_load_dwordx4 v[148:151], v3, s[8:11], s43 offen sc1
    s_waitcnt vmcnt(13)
    s_waitcnt lgkmcnt(10)
    v_mfma_f32_32x32x16_bf16 v[40:55], v[96:99], v[224:227], v[40:55]
    ds_read_b64_tr_b16 v[120:121], v33 offset:49152
    ds_read_b64_tr_b16 v[122:123], v33 offset:49664
    s_waitcnt lgkmcnt(10)
    v_mfma_f32_32x32x16_bf16 v[56:71], v[100:103], v[224:227], v[56:71]
    ds_read_b64_tr_b16 v[124:125], v37 offset:49152
    ds_read_b64_tr_b16 v[126:127], v37 offset:49664
    s_add_u32 s43, s29, 47104
    buffer_load_dwordx4 v[152:155], v3, s[8:11], s43 offen sc1
    s_waitcnt vmcnt(13)
    s_waitcnt lgkmcnt(10)
    v_mfma_f32_32x32x16_bf16 v[40:55], v[104:107], v[228:231], v[40:55]
    ds_read_b32 v1, v35 offset:0
    ds_read_b64_tr_b16 v[96:97], v33 offset:53248
    ds_read_b64_tr_b16 v[98:99], v33 offset:53760
    s_waitcnt lgkmcnt(11)
    v_mfma_f32_32x32x16_bf16 v[56:71], v[108:111], v[228:231], v[56:71]
    ds_read_b64_tr_b16 v[100:101], v37 offset:53248
    ds_read_b64_tr_b16 v[102:103], v37 offset:53760
    s_add_u32 s43, s29, 54272
    buffer_load_dwordx4 v[156:159], v3, s[8:11], s43 offen sc1
    s_waitcnt vmcnt(13)
    s_waitcnt lgkmcnt(11)
    v_mfma_f32_32x32x16_bf16 v[40:55], v[112:115], v[232:235], v[40:55]
    ds_read_b64_tr_b16 v[104:105], v33 offset:57344
    ds_read_b64_tr_b16 v[106:107], v33 offset:57856
    s_waitcnt lgkmcnt(11)
    v_mfma_f32_32x32x16_bf16 v[56:71], v[116:119], v[232:235], v[56:71]
    ds_read_b64_tr_b16 v[108:109], v37 offset:57344
    ds_read_b64_tr_b16 v[110:111], v37 offset:57856
    s_add_u32 s43, s29, 5120
    buffer_load_dwordx4 v[160:163], v3, s[8:11], s43 offen sc1
    s_waitcnt vmcnt(13)
    s_waitcnt lgkmcnt(11)
    v_mfma_f32_32x32x16_bf16 v[40:55], v[120:123], v[236:239], v[40:55]
    ds_read_b64_tr_b16 v[112:113], v33 offset:61440
    ds_read_b64_tr_b16 v[114:115], v33 offset:61952
    s_waitcnt lgkmcnt(11)
    v_mfma_f32_32x32x16_bf16 v[56:71], v[124:127], v[236:239], v[56:71]
    s_waitcnt lgkmcnt(10)
    s_add_u32 s39, s7, 21
    v_cmp_gt_u32 s[30:31], s39, v1
    ds_read_b64_tr_b16 v[116:117], v37 offset:61440
    ds_read_b64_tr_b16 v[118:119], v37 offset:61952
    s_add_u32 s43, s29, 12288
    buffer_load_dwordx4 v[164:167], v3, s[8:11], s43 offen sc1
    s_waitcnt vmcnt(13)
    s_waitcnt lgkmcnt(10)
    v_mfma_f32_32x32x16_bf16 v[40:55], v[96:99], v[240:243], v[40:55]
    s_cmp_eq_u64 s[30:31], 0
    s_cbranch_scc1 L145
L144:
    s_add_u32 s38, s38, 1
    s_cmp_gt_u32 s38, 6400000
    s_cbranch_scc1 L145
    ds_read_b32 v1, v35 offset:0
    s_waitcnt lgkmcnt(0)
    v_cmp_gt_u32 vcc, s39, v1
    s_cbranch_vccnz L144
L145:
    ds_read_b64_tr_b16 v[120:121], v32 offset:0
    ds_read_b64_tr_b16 v[122:123], v32 offset:512
    s_waitcnt lgkmcnt(10)
    v_mfma_f32_32x32x16_bf16 v[56:71], v[100:103], v[240:243], v[56:71]
    ds_read_b64_tr_b16 v[124:125], v36 offset:0
    ds_read_b64_tr_b16 v[126:127], v36 offset:512
    s_add_u32 s43, s29, 19456
    buffer_load_dwordx4 v[168:171], v3, s[8:11], s43 offen sc1
    s_waitcnt vmcnt(13)
    s_waitcnt lgkmcnt(10)
    v_mfma_f32_32x32x16_bf16 v[40:55], v[104:107], v[244:247], v[40:55]
    ds_read_b64_tr_b16 v[96:97], v32 offset:4096
    ds_read_b64_tr_b16 v[98:99], v32 offset:4608
    s_waitcnt lgkmcnt(10)
    v_mfma_f32_32x32x16_bf16 v[56:71], v[108:111], v[244:247], v[56:71]
    ds_read_b64_tr_b16 v[100:101], v36 offset:4096
    ds_read_b64_tr_b16 v[102:103], v36 offset:4608
    v_add_u32 v13, 23, v9
    ds_write_b32 v0, v13
    s_add_u32 s43, s29, 26624
    buffer_load_dwordx4 v[172:175], v3, s[8:11], s43 offen sc1
    s_waitcnt vmcnt(13)
    s_waitcnt lgkmcnt(11)
    v_mfma_f32_32x32x16_bf16 v[40:55], v[112:115], v[248:251], v[40:55]
    ds_read_b64_tr_b16 v[104:105], v32 offset:8192
    ds_read_b64_tr_b16 v[106:107], v32 offset:8704
    s_waitcnt lgkmcnt(11)
    v_mfma_f32_32x32x16_bf16 v[56:71], v[116:119], v[248:251], v[56:71]
    ds_read_b64_tr_b16 v[108:109], v36 offset:8192
    ds_read_b64_tr_b16 v[110:111], v36 offset:8704
    s_add_u32 s43, s29, 33792
    buffer_load_dwordx4 v[176:179], v3, s[8:11], s43 offen sc1
    s_waitcnt vmcnt(13)
    s_waitcnt lgkmcnt(11)
    v_mfma_f32_32x32x16_bf16 v[40:55], v[120:123], v[252:255], v[40:55]
    ds_read_b64_tr_b16 v[112:113], v32 offset:12288
    ds_read_b64_tr_b16 v[114:115], v32 offset:12800
    s_waitcnt lgkmcnt(11)
    v_mfma_f32_32x32x16_bf16 v[56:71], v[124:127], v[252:255], v[56:71]
    ds_read_b64_tr_b16 v[116:117], v36 offset:12288
    ds_read_b64_tr_b16 v[118:119], v36 offset:12800
    s_add_u32 s43, s29, 40960
    buffer_load_dwordx4 v[180:183], v3, s[8:11], s43 offen sc1
    s_waitcnt vmcnt(13)
    s_waitcnt lgkmcnt(11)
    v_mfma_f32_32x32x16_bf16 v[40:55], v[96:99], v[128:131], v[40:55]
    ds_read_b64_tr_b16 v[120:121], v32 offset:16384
    ds_read_b64_tr_b16 v[122:123], v32 offset:16896
    s_waitcnt lgkmcnt(11)
    v_mfma_f32_32x32x16_bf16 v[56:71], v[100:103], v[128:131], v[56:71]
    ds_read_b64_tr_b16 v[124:125], v36 offset:16384
    ds_read_b64_tr_b16 v[126:127], v36 offset:16896
    s_add_u32 s43, s29, 48128
    buffer_load_dwordx4 v[184:187], v3, s[8:11], s43 offen sc1
    s_waitcnt vmcnt(13)
    s_waitcnt lgkmcnt(10)
    v_mfma_f32_32x32x16_bf16 v[40:55], v[104:107], v[132:135], v[40:55]
    ds_read_b32 v1, v35 offset:0
    ds_read_b64_tr_b16 v[96:97], v32 offset:20480
    ds_read_b64_tr_b16 v[98:99], v32 offset:20992
    s_waitcnt lgkmcnt(11)
    v_mfma_f32_32x32x16_bf16 v[56:71], v[108:111], v[132:135], v[56:71]
    ds_read_b64_tr_b16 v[100:101], v36 offset:20480
    ds_read_b64_tr_b16 v[102:103], v36 offset:20992
    s_add_u32 s43, s29, 55296
    buffer_load_dwordx4 v[188:191], v3, s[8:11], s43 offen sc1
    s_waitcnt vmcnt(13)
    s_waitcnt lgkmcnt(11)
    v_mfma_f32_32x32x16_bf16 v[40:55], v[112:115], v[136:139], v[40:55]
    ds_read_b64_tr_b16 v[104:105], v32 offset:24576
    ds_read_b64_tr_b16 v[106:107], v32 offset:25088
    s_waitcnt lgkmcnt(11)
    v_mfma_f32_32x32x16_bf16 v[56:71], v[116:119], v[136:139], v[56:71]
    ds_read_b64_tr_b16 v[108:109], v36 offset:24576
    ds_read_b64_tr_b16 v[110:111], v36 offset:25088
    s_add_u32 s43, s29, 6144
    buffer_load_dwordx4 v[192:195], v3, s[8:11], s43 offen sc1
    s_waitcnt vmcnt(13)
    s_waitcnt lgkmcnt(11)
    v_mfma_f32_32x32x16_bf16 v[40:55], v[120:123], v[140:143], v[40:55]
    ds_read_b64_tr_b16 v[112:113], v32 offset:28672
    ds_read_b64_tr_b16 v[114:115], v32 offset:29184
    s_waitcnt lgkmcnt(11)
    v_mfma_f32_32x32x16_bf16 v[56:71], v[124:127], v[140:143], v[56:71]
    s_waitcnt lgkmcnt(10)
    s_add_u32 s39, s7, 22
    v_cmp_gt_u32 s[30:31], s39, v1
    ds_read_b64_tr_b16 v[116:117], v36 offset:28672
    ds_read_b64_tr_b16 v[118:119], v36 offset:29184
    v_add_u32 v13, 24, v9
    ds_write_b32 v0, v13
    s_add_u32 s43, s29, 13312
    buffer_load_dwordx4 v[196:199], v3, s[8:11], s43 offen sc1
    s_waitcnt vmcnt(13)
    s_waitcnt lgkmcnt(11)
    v_mfma_f32_32x32x16_bf16 v[40:55], v[96:99], v[144:147], v[40:55]
    s_cmp_eq_u64 s[30:31], 0
    s_cbranch_scc1 L147
L146:
    s_add_u32 s38, s38, 1
    s_cmp_gt_u32 s38, 6400000
    s_cbranch_scc1 L147
    ds_read_b32 v1, v35 offset:0
    s_waitcnt lgkmcnt(0)
    v_cmp_gt_u32 vcc, s39, v1
    s_cbranch_vccnz L146
L147:
    ds_read_b64_tr_b16 v[120:121], v34 offset:0
    ds_read_b64_tr_b16 v[122:123], v34 offset:512
    s_waitcnt lgkmcnt(11)
    v_mfma_f32_32x32x16_bf16 v[56:71], v[100:103], v[144:147], v[56:71]
    ds_read_b64_tr_b16 v[124:125], v38 offset:0
    ds_read_b64_tr_b16 v[126:127], v38 offset:512
    s_add_u32 s43, s29, 20480
    buffer_load_dwordx4 v[200:203], v3, s[8:11], s43 offen sc1
    s_waitcnt vmcnt(13)
    s_waitcnt lgkmcnt(11)
    v_mfma_f32_32x32x16_bf16 v[40:55], v[104:107], v[148:151], v[40:55]
    ds_read_b64_tr_b16 v[96:97], v34 offset:4096
    ds_read_b64_tr_b16 v[98:99], v34 offset:4608
    s_waitcnt lgkmcnt(11)
    v_mfma_f32_32x32x16_bf16 v[56:71], v[108:111], v[148:151], v[56:71]
    ds_read_b64_tr_b16 v[100:101], v38 offset:4096
    ds_read_b64_tr_b16 v[102:103], v38 offset:4608
    s_add_u32 s43, s29, 27648
    buffer_load_dwordx4 v[204:207], v3, s[8:11], s43 offen sc1
    s_waitcnt vmcnt(13)
    s_waitcnt lgkmcnt(11)
    v_mfma_f32_32x32x16_bf16 v[40:55], v[112:115], v[152:155], v[40:55]
    ds_read_b64_tr_b16 v[104:105], v34 offset:8192
    ds_read_b64_tr_b16 v[106:107], v34 offset:8704
    s_waitcnt lgkmcnt(11)
    v_mfma_f32_32x32x16_bf16 v[56:71], v[116:119], v[152:155], v[56:71]
    ds_read_b64_tr_b16 v[108:109], v38 offset:8192
    ds_read_b64_tr_b16 v[110:111], v38 offset:8704
    s_add_u32 s43, s29, 34816
    buffer_load_dwordx4 v[208:211], v3, s[8:11], s43 offen sc1
    s_waitcnt vmcnt(13)
    s_waitcnt lgkmcnt(10)
    v_mfma_f32_32x32x16_bf16 v[40:55], v[120:123], v[156:159], v[40:55]
    ds_read_b64_tr_b16 v[112:113], v34 offset:12288
    ds_read_b64_tr_b16 v[114:115], v34 offset:12800
    s_waitcnt lgkmcnt(10)
    v_mfma_f32_32x32x16_bf16 v[56:71], v[124:127], v[156:159], v[56:71]
    ds_read_b64_tr_b16 v[116:117], v38 offset:12288
    ds_read_b64_tr_b16 v[118:119], v38 offset:12800
    v_add_u32 v13, 25, v9
    ds_write_b32 v0, v13
    s_add_u32 s43, s29, 41984
    buffer_load_dwordx4 v[212:215], v3, s[8:11], s43 offen sc1
    s_waitcnt vmcnt(13)
    s_waitcnt lgkmcnt(11)
    v_mfma_f32_32x32x16_bf16 v[40:55], v[96:99], v[160:163], v[40:55]
    ds_read_b32 v1, v35 offset:0
    ds_read_b64_tr_b16 v[120:121], v34 offset:16384
    ds_read_b64_tr_b16 v[122:123], v34 offset:16896
    s_waitcnt lgkmcnt(12)
    v_mfma_f32_32x32x16_bf16 v[56:71], v[100:103], v[160:163], v[56:71]
    ds_read_b64_tr_b16 v[124:125], v38 offset:16384
    ds_read_b64_tr_b16 v[126:127], v38 offset:16896
    s_add_u32 s43, s29, 49152
    buffer_load_dwordx4 v[216:219], v3, s[8:11], s43 offen sc1
    s_waitcnt vmcnt(13)
    s_waitcnt lgkmcnt(12)
    v_mfma_f32_32x32x16_bf16 v[40:55], v[104:107], v[164:167], v[40:55]
    ds_read_b64_tr_b16 v[96:97], v34 offset:20480
    ds_read_b64_tr_b16 v[98:99], v34 offset:20992
    s_waitcnt lgkmcnt(12)
    v_mfma_f32_32x32x16_bf16 v[56:71], v[108:111], v[164:167], v[56:71]
    ds_read_b64_tr_b16 v[100:101], v38 offset:20480
    ds_read_b64_tr_b16 v[102:103], v38 offset:20992
    s_add_u32 s43, s29, 56320
    buffer_load_dwordx4 v[220:223], v3, s[8:11], s43 offen sc1
    s_waitcnt vmcnt(13)
    s_waitcnt lgkmcnt(12)
    v_mfma_f32_32x32x16_bf16 v[40:55], v[112:115], v[168:171], v[40:55]
    ds_read_b64_tr_b16 v[104:105], v34 offset:24576
    ds_read_b64_tr_b16 v[106:107], v34 offset:25088
    s_waitcnt lgkmcnt(12)
    v_mfma_f32_32x32x16_bf16 v[56:71], v[116:119], v[168:171], v[56:71]
    s_waitcnt lgkmcnt(10)
    s_add_u32 s39, s7, 23
    v_cmp_gt_u32 s[30:31], s39, v1
    ds_read_b64_tr_b16 v[108:109], v38 offset:24576
    ds_read_b64_tr_b16 v[110:111], v38 offset:25088
    s_waitcnt vmcnt(12)
    s_waitcnt lgkmcnt(10)
    v_mfma_f32_32x32x16_bf16 v[40:55], v[120:123], v[172:175], v[40:55]
    s_cmp_eq_u64 s[30:31], 0
    s_cbranch_scc1 L149
L148:
    s_add_u32 s38, s38, 1
    s_cmp_gt_u32 s38, 6400000
    s_cbranch_scc1 L149
    ds_read_b32 v1, v35 offset:0
    s_waitcnt lgkmcnt(0)
    v_cmp_gt_u32 vcc, s39, v1
    s_cbranch_vccnz L148
L149:
    ds_read_b64_tr_b16 v[112:113], v33 offset:32768
    ds_read_b64_tr_b16 v[114:115], v33 offset:33280
    s_waitcnt lgkmcnt(10)
    v_mfma_f32_32x32x16_bf16 v[56:71], v[124:127], v[172:175], v[56:71]
    ds_read_b64_tr_b16 v[116:117], v37 offset:32768
    ds_read_b64_tr_b16 v[118:119], v37 offset:33280
    s_waitcnt vmcnt(11)
    s_waitcnt lgkmcnt(10)
    v_mfma_f32_32x32x16_bf16 v[40:55], v[96:99], v[176:179], v[40:55]
    ds_read_b32 v1, v35 offset:16
    ds_read_b64_tr_b16 v[120:121], v33 offset:36864
    ds_read_b64_tr_b16 v[122:123], v33 offset:37376
    s_waitcnt lgkmcnt(11)
    v_mfma_f32_32x32x16_bf16 v[56:71], v[100:103], v[176:179], v[56:71]
    ds_read_b64_tr_b16 v[124:125], v37 offset:36864
    ds_read_b64_tr_b16 v[126:127], v37 offset:37376
    s_waitcnt vmcnt(10)
    s_waitcnt lgkmcnt(11)
    v_mfma_f32_32x32x16_bf16 v[40:55], v[104:107], v[180:183], v[40:55]
    ds_read_b64_tr_b16 v[96:97], v37 offset:40960
    ds_read_b64_tr_b16 v[98:99], v37 offset:41472
    s_waitcnt lgkmcnt(11)
    v_mfma_f32_32x32x16_bf16 v[56:71], v[108:111], v[180:183], v[56:71]
    ds_read_b64_tr_b16 v[100:101], v37 offset:45056
    ds_read_b64_tr_b16 v[102:103], v37 offset:45568
    s_waitcnt vmcnt(9)
    s_waitcnt lgkmcnt(11)
    v_mfma_f32_32x32x16_bf16 v[40:55], v[112:115], v[184:187], v[40:55]
    ds_read_b64_tr_b16 v[104:105], v37 offset:49152
    ds_read_b64_tr_b16 v[106:107], v37 offset:49664
    s_waitcnt lgkmcnt(11)
    v_mfma_f32_32x32x16_bf16 v[56:71], v[116:119], v[184:187], v[56:71]
    s_waitcnt lgkmcnt(10)
    s_add_u32 s39, s7, 25
    v_cmp_gt_u32 s[30:31], s39, v1
    ds_read_b64_tr_b16 v[108:109], v37 offset:53248
    ds_read_b64_tr_b16 v[110:111], v37 offset:53760
    s_waitcnt vmcnt(8)
    s_waitcnt lgkmcnt(10)
    v_mfma_f32_32x32x16_bf16 v[40:55], v[120:123], v[188:191], v[40:55]
    s_cmp_eq_u64 s[30:31], 0
    s_cbranch_scc1 L151
L150:
    s_add_u32 s38, s38, 1
    s_cmp_gt_u32 s38, 6400000
    s_cbranch_scc1 L151
    ds_read_b32 v1, v35 offset:16
    s_waitcnt lgkmcnt(0)
    v_cmp_gt_u32 vcc, s39, v1
    s_cbranch_vccnz L150
L151:
    ds_read_b64_tr_b16 v[112:113], v37 offset:57344
    ds_read_b64_tr_b16 v[114:115], v37 offset:57856
    s_waitcnt lgkmcnt(10)
    v_mfma_f32_32x32x16_bf16 v[56:71], v[124:127], v[188:191], v[56:71]
    ds_read_b64_tr_b16 v[116:117], v37 offset:61440
    ds_read_b64_tr_b16 v[118:119], v37 offset:61952
    s_waitcnt vmcnt(7)
    s_waitcnt lgkmcnt(10)
    v_mfma_f32_32x32x16_bf16 v[56:71], v[96:99], v[192:195], v[56:71]
    ds_read_b64_tr_b16 v[120:121], v36 offset:0
    ds_read_b64_tr_b16 v[122:123], v36 offset:512
    s_waitcnt vmcnt(6)
    s_waitcnt lgkmcnt(10)
    v_mfma_f32_32x32x16_bf16 v[56:71], v[100:103], v[196:199], v[56:71]
    ds_read_b64_tr_b16 v[124:125], v36 offset:4096
    ds_read_b64_tr_b16 v[126:127], v36 offset:4608
    s_waitcnt vmcnt(5)
    s_waitcnt lgkmcnt(10)
    v_mfma_f32_32x32x16_bf16 v[56:71], v[104:107], v[200:203], v[56:71]
    ds_read_b64_tr_b16 v[96:97], v33 offset:40960
    ds_read_b64_tr_b16 v[98:99], v33 offset:41472
    s_waitcnt vmcnt(4)
    s_waitcnt lgkmcnt(10)
    v_mfma_f32_32x32x16_bf16 v[56:71], v[108:111], v[204:207], v[56:71]
    ds_read_b64_tr_b16 v[100:101], v33 offset:45056
    ds_read_b64_tr_b16 v[102:103], v33 offset:45568
    s_waitcnt vmcnt(3)
    s_waitcnt lgkmcnt(10)
    v_mfma_f32_32x32x16_bf16 v[56:71], v[112:115], v[208:211], v[56:71]
    ds_read_b64_tr_b16 v[104:105], v33 offset:49152
    ds_read_b64_tr_b16 v[106:107], v33 offset:49664
    s_waitcnt vmcnt(2)
    s_waitcnt lgkmcnt(10)
    v_mfma_f32_32x32x16_bf16 v[56:71], v[116:119], v[212:215], v[56:71]
    ds_read_b64_tr_b16 v[108:109], v33 offset:53248
    ds_read_b64_tr_b16 v[110:111], v33 offset:53760
    s_waitcnt vmcnt(1)
    s_waitcnt lgkmcnt(10)
    v_mfma_f32_32x32x16_bf16 v[56:71], v[120:123], v[216:219], v[56:71]
    ds_read_b64_tr_b16 v[112:113], v33 offset:57344
    ds_read_b64_tr_b16 v[114:115], v33 offset:57856
    s_waitcnt vmcnt(0)
    s_waitcnt lgkmcnt(10)
    v_mfma_f32_32x32x16_bf16 v[56:71], v[124:127], v[220:223], v[56:71]
    ds_read_b64_tr_b16 v[116:117], v33 offset:61440
    ds_read_b64_tr_b16 v[118:119], v33 offset:61952
    s_waitcnt lgkmcnt(10)
    v_mfma_f32_32x32x16_bf16 v[40:55], v[96:99], v[192:195], v[40:55]
    ds_read_b64_tr_b16 v[120:121], v32 offset:0
    ds_read_b64_tr_b16 v[122:123], v32 offset:512
    s_waitcnt lgkmcnt(10)
    v_mfma_f32_32x32x16_bf16 v[40:55], v[100:103], v[196:199], v[40:55]
    ds_read_b64_tr_b16 v[124:125], v32 offset:4096
    ds_read_b64_tr_b16 v[126:127], v32 offset:4608
    v_add_u32 v13, 26, v9
    ds_write_b32 v0, v13
    s_waitcnt lgkmcnt(11)
    v_mfma_f32_32x32x16_bf16 v[40:55], v[104:107], v[200:203], v[40:55]
    ds_write_b128 v39, v[56:59] offset:0
    s_waitcnt lgkmcnt(10)
    v_mfma_f32_32x32x16_bf16 v[40:55], v[108:111], v[204:207], v[40:55]
    ds_write_b128 v39, v[60:63] offset:1024
    s_waitcnt lgkmcnt(9)
    v_mfma_f32_32x32x16_bf16 v[40:55], v[112:115], v[208:211], v[40:55]
    ds_write_b128 v39, v[64:67] offset:2048
    s_waitcnt lgkmcnt(8)
    v_mfma_f32_32x32x16_bf16 v[40:55], v[116:119], v[212:215], v[40:55]
    ds_write_b128 v39, v[68:71] offset:3072
    v_add_u32 v13, 27, v9
    ds_write_b32 v0, v13
    v_xor_b32 v39, 4096, v39
    s_waitcnt lgkmcnt(8)
    v_mfma_f32_32x32x16_bf16 v[40:55], v[120:123], v[216:219], v[40:55]
    s_waitcnt lgkmcnt(6)
    v_mfma_f32_32x32x16_bf16 v[40:55], v[124:127], v[220:223], v[40:55]
    ds_read_b32 v1, v35 offset:16
    ds_read_b128 v[72:75], v39 offset:0
    ds_read_b128 v[76:79], v39 offset:1024
    ds_read_b128 v[80:83], v39 offset:2048
    ds_read_b128 v[84:87], v39 offset:3072
    s_waitcnt lgkmcnt(4)
    s_add_u32 s39, s7, 27
    v_cmp_gt_u32 s[30:31], s39, v1
    s_nop 0
    s_cmp_eq_u64 s[30:31], 0
    s_cbranch_scc1 L153
L152:
    s_add_u32 s38, s38, 1
    s_cmp_gt_u32 s38, 6400000
    s_cbranch_scc1 L153
    ds_read_b32 v1, v35 offset:16
    ds_read_b128 v[72:75], v39 offset:0
    ds_read_b128 v[76:79], v39 offset:1024
    ds_read_b128 v[80:83], v39 offset:2048
    ds_read_b128 v[84:87], v39 offset:3072
    s_waitcnt lgkmcnt(0)
    v_cmp_gt_u32 vcc, s39, v1
    s_cbranch_vccnz L152
L153:
    s_waitcnt lgkmcnt(3)
    v_add_f32 v40, v40, v72
    v_add_f32 v41, v41, v73
    v_add_f32 v42, v42, v74
    v_add_f32 v43, v43, v75
    v_cvt_pk_bf16_f32 v24, v40, v41
    v_cvt_pk_bf16_f32 v25, v42, v43
    s_waitcnt lgkmcnt(2)
    v_add_f32 v44, v44, v76
    v_add_f32 v45, v45, v77
    v_add_f32 v46, v46, v78
    v_add_f32 v47, v47, v79
    v_cvt_pk_bf16_f32 v26, v44, v45
    v_cvt_pk_bf16_f32 v27, v46, v47
    s_waitcnt lgkmcnt(1)
    v_add_f32 v48, v48, v80
    v_add_f32 v49, v49, v81
    v_add_f32 v50, v50, v82
    v_add_f32 v51, v51, v83
    v_cvt_pk_bf16_f32 v28, v48, v49
    v_cvt_pk_bf16_f32 v29, v50, v51
    s_waitcnt lgkmcnt(0)
    v_add_f32 v52, v52, v84
    v_add_f32 v53, v53, v85
    v_add_f32 v54, v54, v86
    v_add_f32 v55, v55, v87
    v_cvt_pk_bf16_f32 v30, v52, v53
    v_cvt_pk_bf16_f32 v31, v54, v55
    s_cmp_lg_u32 s22, 0
    s_cbranch_scc1 L_c_final
    s_cmp_lg_u32 s21, 0
    s_cbranch_scc1 L154
    buffer_store_dwordx4 v[24:27], v3, s[8:11], s58 offen
L155:
    s_cmp_lg_u32 s21, 0
    s_cbranch_scc1 L156
    buffer_store_dwordx4 v[28:31], v3, s[8:11], s58 offen offset:1024
L157:
    v_dot2_f32_bf16 v56, v24, s20, 0
    v_dot2_f32_bf16 v57, v24, v24, 0
    v_dot2_f32_bf16 v58, v25, s20, 0
    v_dot2_f32_bf16 v59, v25, v25, 0
    v_dot2_f32_bf16 v56, v26, s20, v56
    v_dot2_f32_bf16 v57, v26, v26, v57
    v_dot2_f32_bf16 v58, v27, s20, v58
    v_dot2_f32_bf16 v59, v27, v27, v59
    v_dot2_f32_bf16 v56, v28, s20, v56
    v_dot2_f32_bf16 v57, v28, v28, v57
    v_dot2_f32_bf16 v58, v29, s20, v58
    v_dot2_f32_bf16 v59, v29, v29, v59
    v_dot2_f32_bf16 v56, v30, s20, v56
    v_dot2_f32_bf16 v57, v30, v30, v57
    v_dot2_f32_bf16 v58, v31, s20, v58
    v_dot2_f32_bf16 v59, v31, v31, v59
    s_nop 1
    v_add_f32 v56, v56, v58
    v_add_f32 v57, v57, v59
    s_nop 1
    v_permlane32_swap_b32 v56, v57
    s_nop 0
    v_add_f32 v56, v56, v57
    s_cmp_lg_u32 s21, 0
    s_cbranch_scc1 L158
    buffer_store_dword v56, v3, s[8:11], s59 offen
L159:
    s_add_u32 s40, s23, 10
    v_mov_b32 v13, s40
    s_waitcnt vmcnt(0)
    s_mov_b64 exec, 1
    s_cmp_lg_u32 s21, 0
    s_cbranch_scc1 L160
    buffer_store_dword v13, off, s[8:11], s24
L161:
    s_mov_b64 exec, -1
    s_lshl_b32 s55, s27, 15
    s_add_u32 s55, s55, 6291456
    s_add_u32 s55, s55, s34
    s_lshl_b32 s56, s27, 12
    s_add_u32 s56, s56, 5767168
    s_add_u32 s56, s56, s34
    s_mov_b32 s57, 10
    s_mov_b32 s22, 1
    s_mov_b32 s23, 16
    s_mov_b32 s7, 64
    s_add_u32 s4, s4, 1
    v_mov_b32 v9, 64
    s_mul_i32 s35, s21, 33554432
    s_nop 1
    s_branch L_c_loop
L_c_final:
    s_lshl_b32 s40, s48, 15
    s_lshl_b32 s41, s49, 6
    s_add_u32 s40, s40, s41
    buffer_store_dwordx4 v[24:27], v8, s[12:15], s40 offen
    buffer_store_dwordx4 v[28:31], v8, s[12:15], s40 offen offset:32
    s_endpgm
L_helper:
    v_lshrrev_b32 v26, 2, v2
    v_mul_u32_u24 v16, 3072, v26
    v_and_b32 v26, 3, v2
    v_lshl_add_u32 v16, v26, 4, v16
    s_add_u32 s30, s28, s6
    s_lshl_b32 s31, s17, 6
    s_mov_b32 s46, 1572864
    s_mov_b32 s47, 0x20000
    s_mov_b64 s[44:45], s[66:67]
    s_mul_i32 s83, s2, 9363
    s_lshr_b32 s83, s83, 18
    s_mul_i32 s40, s83, 28
    s_sub_u32 s84, s2, s40
    s_mul_i32 s40, s84, 37
    s_lshr_b32 s40, s40, 8
    s_mul_i32 s41, s40, 7
    s_sub_u32 s41, s84, s41
    s_lshl_b32 s41, s41, 3
    s_add_u32 s41, s41, s83
    s_lshl_b32 s40, s40, 6
    s_add_u32 s40, s40, s41
    s_lshl_b32 s40, s40, 3
    s_add_u32 s88, s40, 1753088
    s_cmp_lt_u32 s2, 224
    s_cselect_b32 s88, s88, 0x7ff00000
    s_cmp_eq_u32 s6, 3
    s_cbranch_scc0 L162
    s_cmp_eq_u32 s2, 0
    s_cbranch_scc0 L163
    s_memrealtime s[42:43]
    s_mov_b64 s[12:13], s[70:71]
    s_mov_b32 s14, 256
    s_mov_b32 s15, 0x20000
    s_waitcnt lgkmcnt(0)
    s_lshl_b64 s[42:43], s[42:43], 3
    s_or_b32 s43, s43, 0x80000000
    v_mov_b32 v44, s42
    v_mov_b32 v45, s43
    s_mov_b64 exec, 1
    buffer_store_dwordx2 v[44:45], off, s[12:15], 0 sc1
    s_mov_b64 exec, -1
L163:
    v_mov_b32 v40, 0
    v_mov_b32 v41, 0
    v_mov_b32 v42, 0
    v_mov_b32 v43, 0
    s_sub_u32 s40, s24, 28
    s_lshl_b32 s81, s16, 11
    s_lshl_b32 s41, s17, 7
    s_add_u32 s81, s81, s41
    s_add_u32 s81, s81, 1720320
    s_mov_b64 exec, 1
    buffer_store_dwordx4 v[40:43], off, s[8:11], s40 sc1
    buffer_store_dwordx4 v[40:43], off, s[8:11], s81 sc1
    buffer_store_dwordx2 v[40:41], off, s[8:11], s88 sc1
    s_mov_b64 exec, -1
L162:
    s_cmp_eq_u32 s6, 1
    s_cbranch_scc0 L164
    v_lshrrev_b32 v26, 3, v2
    v_mul_u32_u24 v26, 3072, v26
    v_and_b32 v27, 7, v2
    v_lshl_add_u32 v26, v27, 7, v26
    s_mul_i32 s41, s2, 6144
    s_mov_b64 exec, 0xffff
    buffer_load_dword v31, v26, s[44:47], s41 offen
    s_mov_b64 exec, -1
L164:
    s_cmp_eq_u32 s6, 0
    s_cbranch_scc0 L165
    v_and_b32 v26, 15, v2
    v_mul_u32_u24 v26, 3072, v26
    v_lshrrev_b32 v27, 4, v2
    v_lshl_add_u32 v26, v27, 10, v26
    s_lshr_b32 s41, s2, 3
    s_mul_i32 s41, s41, 49152
    s_add_u32 s41, s41, 384
    s_mov_b32 exec_hi, 0xffff
    buffer_load_dword v31, v26, s[44:47], s41 offen
    s_mov_b64 exec, -1
L165:
    s_add_u32 s41, s30, 0
    s_and_b32 s41, s41, 31
    s_mul_i32 s41, s41, 49152
    s_add_u32 s41, s41, s31
    s_add_u32 s40, s41, 1024
    s_add_u32 m0, s25, 32768
    s_nop 0
    buffer_load_dwordx4 v16, s[44:47], s40 offen lds
    s_add_u32 s40, s41, 2048
    s_add_u32 m0, s25, 65536
    s_nop 0
    buffer_load_dwordx4 v16, s[44:47], s40 offen lds
    s_add_u32 s41, s30, 4
    s_and_b32 s41, s41, 31
    s_mul_i32 s41, s41, 49152
    s_add_u32 s41, s41, s31
    s_add_u32 s40, s41, 1024
    s_add_u32 m0, s25, 36864
    s_nop 0
    buffer_load_dwordx4 v16, s[44:47], s40 offen lds
    s_add_u32 s40, s41, 2048
    s_add_u32 m0, s25, 69632
    s_nop 0
    buffer_load_dwordx4 v16, s[44:47], s40 offen lds
    s_mov_b64 s[12:13], s[70:71]
    s_mov_b32 s14, 256
    s_mov_b32 s15, 0x20000
    s_mov_b64 s[48:49], s[68:69]
    s_mov_b32 s50, 524288
    s_mov_b32 s51, 0x20000
    s_mov_b64 s[52:53], s[76:77]
    s_mov_b32 s54, 1835008
    s_mov_b32 s55, 0x20000
    v_lshrrev_b32 v26, 3, v2
    v_bfe_u32 v27, v2, 4, 1
    v_lshlrev_b32 v27, 2, v27
    v_and_b32 v28, 7, v2
    v_xor_b32 v28, v27, v28
    v_lshlrev_b32 v28, 4, v28
    v_lshl_add_u32 v23, v26, 10, v28
    v_mul_u32_u24 v29, 3584, v26
    v_add_u32 v29, v29, v28
    s_and_b32 s85, s83, 1
    s_lshr_b32 s86, s83, 1
    s_add_u32 s80, s6, 1
    s_cmp_eq_u32 s6, 0
    s_cselect_b32 s80, 0, s80
    s_cmp_eq_u32 s6, 3
    s_cselect_b32 s80, 1, s80
    s_lshl_b32 s86, s86, 1
    s_add_u32 s86, s86, s80
    s_cmp_eq_u32 s85, 0
    s_cselect_b64 s[56:57], s[72:73], s[74:75]
    s_mov_b32 s58, 1835008
    s_mov_b32 s59, 0x20000
    s_cmp_lt_u32 s2, 224
    s_cselect_b32 s87, 1, 0
    s_cmp_lt_u32 s80, 2
    s_cselect_b32 s87, s87, 0
    s_lshl_b32 s32, s19, 7
    s_and_b32 s40, s6, 1
    s_lshl_b32 s40, s40, 13
    s_add_u32 s32, s32, s40
    s_lshr_b32 s40, s6, 1
    s_mul_i32 s33, s40, 917504
    s_add_u32 s33, s33, s32
    s_lshl_b32 s40, s40, 18
    s_add_u32 s32, s32, s40
    s_mul_i32 s29, s17, 229376
    s_add_u32 s29, s29, 2097152
    s_add_u32 s29, s29, s25
    v_add_u32 v20, s25, v3
    v_add_u32 v21, 0x10000, v20
    v_add_u32 v22, 0x20000, v20
    v_lshrrev_b32 v26, 5, v2
    v_lshlrev_b32 v24, 9, v26
    v_bfe_u32 v26, v2, 2, 2
    v_lshl_add_u32 v24, v26, 6, v24
    v_bfe_u32 v26, v2, 4, 1
    v_lshl_add_u32 v24, v26, 5, v24
    v_and_b32 v26, 1, v2
    v_lshl_add_u32 v24, v26, 4, v24
    v_bfe_u32 v26, v2, 1, 1
    v_lshl_add_u32 v24, v26, 3, v24
    s_lshl_b32 s40, s6, 15
    v_add_u32 v24, s40, v24
    v_mov_b32 v64, s20
    v_mov_b32 v65, s20
    v_mov_b32 v66, s20
    v_mov_b32 v67, s20
    v_mov_b32 v48, s20
    v_mov_b32 v49, s20
    v_mov_b32 v50, 0
    v_mov_b32 v51, 0
    v_mov_b32 v52, 163072
    ds_write_b128 v52, v[48:51] offset:0
    ds_write_b128 v52, v[48:51] offset:64
    ds_write_b128 v52, v[48:51] offset:256
    ds_write_b128 v52, v[48:51] offset:320
    v_and_b32 v25, 3, v2
    v_lshlrev_b32 v25, 2, v25
    v_add_u32 v25, 163456, v25
    s_lshr_b32 s40, s6, 1
    s_lshl_b32 s41, s18, 1
    s_add_u32 s40, s40, s41
    s_lshl_b32 s41, s16, 2
    s_add_u32 s40, s40, s41
    s_and_b32 s41, s6, 1
    s_lshl_b32 s42, s19, 1
    s_add_u32 s41, s41, s42
    s_lshl_b32 s60, s40, 15
    s_lshl_b32 s42, s41, 11
    s_add_u32 s60, s60, s42
    s_lshl_b32 s61, s40, 12
    s_lshr_b32 s42, s41, 2
    s_lshl_b32 s42, s42, 10
    s_add_u32 s61, s61, s42
    s_mul_i32 s63, s27, 114688
    s_mul_i32 s42, s17, 7168
    s_add_u32 s63, s63, s42
    s_and_b32 s40, s80, 1
    s_lshl_b32 s40, s40, 6
    s_mul_i32 s41, s2, 7168
    s_add_u32 s41, s41, s40
    s_add_u32 s64, s52, s41
    s_addc_u32 s65, s53, 0
    s_lshl_b32 s41, s2, 11
    s_add_u32 s41, s41, s40
    s_add_u32 s66, s48, s41
    s_addc_u32 s67, s49, 0
    s_add_u32 s41, s30, 8
    s_and_b32 s41, s41, 31
    s_mul_i32 s41, s41, 49152
    s_add_u32 s41, s41, s31
    s_add_u32 s40, s41, 1024
    s_add_u32 m0, s25, 40960
    s_nop 0
    buffer_load_dwordx4 v16, s[44:47], s40 offen lds
    s_cmp_lt_u32 s80, 2
    s_cbranch_scc0 L166
    s_load_dword s95, s[66:67], 0
    s_load_dword s95, s[66:67], 128
L166:
    s_add_u32 s40, s41, 2048
    s_add_u32 m0, s25, 73728
    s_nop 0
    buffer_load_dwordx4 v16, s[44:47], s40 offen lds
    s_cmp_lt_u32 s80, 2
    s_cbranch_scc0 L167
    s_load_dword s95, s[66:67], 256
    s_load_dword s95, s[66:67], 384
L167:
    s_add_u32 s41, s30, 12
    s_and_b32 s41, s41, 31
    s_mul_i32 s41, s41, 49152
    s_add_u32 s41, s41, s31
    s_add_u32 s40, s41, 1024
    s_add_u32 m0, s25, 45056
    s_nop 0
    buffer_load_dwordx4 v16, s[44:47], s40 offen lds
    s_cmp_lt_u32 s80, 2
    s_cbranch_scc0 L168
    s_load_dword s95, s[66:67], 512
    s_load_dword s95, s[66:67], 640
L168:
    s_waitcnt vmcnt(6)
    s_add_u32 s40, s41, 2048
    s_add_u32 m0, s25, 77824
    s_nop 0
    buffer_load_dwordx4 v16, s[44:47], s40 offen lds
    s_cmp_lt_u32 s80, 2
    s_cbranch_scc0 L169
    s_load_dword s95, s[66:67], 768
    s_load_dword s95, s[66:67], 896
L169:
    s_waitcnt vmcnt(6)
    s_waitcnt vmcnt(4)
    v_mov_b32 v13, 1
    ds_max_u32 v0, v13
    s_cmp_eq_u32 s6, 3
    s_cbranch_scc0 L170
    s_load_dwordx2 s[92:93], s[70:71], 0
L170:
    s_add_u32 s41, s30, 16
    s_and_b32 s41, s41, 31
    s_mul_i32 s41, s41, 49152
    s_add_u32 s41, s41, s31
    s_add_u32 s40, s41, 1024
    s_add_u32 m0, s25, 49152
    s_nop 0
    buffer_load_dwordx4 v16, s[44:47], s40 offen lds
    s_cmp_lt_u32 s80, 2
    s_cbranch_scc0 L171
    s_load_dword s95, s[66:67], 1024
    s_load_dword s95, s[66:67], 1152
L171:
    s_add_u32 s40, s41, 2048
    s_add_u32 m0, s25, 81920
    s_nop 0
    buffer_load_dwordx4 v16, s[44:47], s40 offen lds
    s_cmp_lt_u32 s80, 2
    s_cbranch_scc0 L172
    s_load_dword s95, s[66:67], 1280
    s_load_dword s95, s[66:67], 1408
L172:
    s_add_u32 s41, s30, 20
    s_and_b32 s41, s41, 31
    s_mul_i32 s41, s41, 49152
    s_add_u32 s41, s41, s31
    s_add_u32 s40, s41, 1024
    s_add_u32 m0, s25, 53248
    s_nop 0
    buffer_load_dwordx4 v16, s[44:47], s40 offen lds
    s_cmp_lt_u32 s80, 2
    s_cbranch_scc0 L173
    s_load_dword s95, s[66:67], 1536
    s_load_dword s95, s[66:67], 1664
L173:
    s_waitcnt vmcnt(6)
    s_add_u32 s40, s41, 2048
    s_add_u32 m0, s25, 86016
    s_nop 0
    buffer_load_dwordx4 v16, s[44:47], s40 offen lds
    s_cmp_lt_u32 s80, 2
    s_cbranch_scc0 L174
    s_load_dword s95, s[66:67], 1792
    s_load_dword s95, s[66:67], 1920
L174:
    s_waitcnt vmcnt(6)
    s_add_u32 s41, s30, 24
    s_and_b32 s41, s41, 31
    s_mul_i32 s41, s41, 49152
    s_add_u32 s41, s41, s31
    s_add_u32 s40, s41, 1024
    s_add_u32 m0, s25, 57344
    s_nop 0
    buffer_load_dwordx4 v16, s[44:47], s40 offen lds
    s_waitcnt vmcnt(6)
    s_add_u32 s40, s41, 2048
    s_add_u32 m0, s25, 90112
    s_nop 0
    buffer_load_dwordx4 v16, s[44:47], s40 offen lds
    s_waitcnt vmcnt(6)
    v_mov_b32 v13, 2
    ds_max_u32 v0, v13
    s_add_u32 s41, s30, 28
    s_and_b32 s41, s41, 31
    s_mul_i32 s41, s41, 49152
    s_add_u32 s41, s41, s31
    s_add_u32 s40, s41, 1024
    s_add_u32 m0, s25, 61440
    s_nop 0
    buffer_load_dwordx4 v16, s[44:47], s40 offen lds
    s_waitcnt vmcnt(6)
    s_add_u32 s40, s41, 2048
    s_add_u32 m0, s25, 94208
    s_nop 0
    buffer_load_dwordx4 v16, s[44:47], s40 offen lds
    s_waitcnt vmcnt(6)
    s_cmp_gt_u32 s87, 0
    s_cbranch_scc0 L175
    s_mul_i32 s41, s86, 229376
    s_lshl_b32 s40, s84, 7
    s_add_u32 s41, s41, s40
    buffer_load_dwordx4 v[128:131], v29, s[56:59], s41 offen
    s_add_u32 s41, s41, 28672
    buffer_load_dwordx4 v[132:135], v29, s[56:59], s41 offen
    s_add_u32 s41, s41, 28672
    buffer_load_dwordx4 v[136:139], v29, s[56:59], s41 offen
    s_add_u32 s41, s41, 28672
    buffer_load_dwordx4 v[140:143], v29, s[56:59], s41 offen
    s_add_u32 s41, s41, 28672
    buffer_load_dwordx4 v[144:147], v29, s[56:59], s41 offen
    s_add_u32 s41, s41, 28672
    buffer_load_dwordx4 v[148:151], v29, s[56:59], s41 offen
    s_add_u32 s41, s41, 28672
    buffer_load_dwordx4 v[152:155], v29, s[56:59], s41 offen
    s_add_u32 s41, s41, 28672
    buffer_load_dwordx4 v[156:159], v29, s[56:59], s41 offen
L175:
    s_waitcnt vmcnt(12)
    s_cmp_lg_u32 s87, 0
    s_cbranch_scc1 L176
    s_waitcnt vmcnt(4)
L176:
    v_mov_b32 v13, 3
    ds_max_u32 v0, v13
    s_waitcnt vmcnt(8)
    s_cmp_lg_u32 s87, 0
    s_cbranch_scc1 L177
    s_waitcnt vmcnt(0)
L177:
    v_mov_b32 v13, 4
    ds_max_u32 v0, v13
    s_cmp_eq_u32 s6, 3
    s_cbranch_scc0 L178
    s_waitcnt lgkmcnt(0)
    s_cmp_eq_u32 s93, 0
    s_cbranch_scc0 L179
    s_mov_b32 s41, 0
    buffer_load_dwordx2 v[26:27], off, s[12:15], 0 sc1
    s_branch L182
L180:
    s_sleep 4
    buffer_load_dwordx2 v[26:27], off, s[12:15], 0 sc1
L182:
    s_add_u32 s41, s41, 1
    s_cmp_gt_u32 s41, 400000
    s_cbranch_scc1 L181
    s_waitcnt vmcnt(0)
    v_readfirstlane_b32 s92, v26
    v_readfirstlane_b32 s93, v27
    s_nop 0
    s_cmp_eq_u32 s93, 0
    s_cbranch_scc1 L180
L181:
L179:
    v_mov_b32 v26, s92
    v_mov_b32 v27, s93
    v_mov_b32 v28, 163496
    ds_write_b64 v28, v[26:27]
    s_getreg_b32 s40, hwreg(HW_REG_XCC_ID)
    s_and_b32 s40, s40, 7
    s_or_b32 s91, s40, s92
    v_mov_b32 v26, s91
    v_mov_b32 v27, s93
    s_lshl_b32 s40, s16, 7
    s_lshl_b32 s41, s17, 3
    s_add_u32 s40, s40, s41
    s_add_u32 s40, s40, 1761280
    s_mov_b64 exec, 1
    buffer_store_dwordx2 v[26:27], off, s[8:11], s40 sc1
    s_mov_b64 exec, -1
L178:
    s_setprio 3
    s_sub_u32 s40, s6, 1
    s_cmp_lt_u32 s40, 2
    s_cbranch_scc0 L183
    ds_read_b32 v1, v25 offset:0
    s_waitcnt lgkmcnt(0)
    s_movk_i32 s39, 4
    v_cmp_gt_u32 vcc, s39, v1
    s_cbranch_vccz L185
L186:
    s_sleep 1
    s_add_u32 s38, s38, 1
    s_cmp_gt_u32 s38, 6400000
    s_cbranch_scc1 L185
    ds_read_b32 v1, v25 offset:0
    s_waitcnt lgkmcnt(0)
    v_cmp_gt_u32 vcc, s39, v1
    s_cbranch_vccnz L186
L185:
    ds_read_b64_tr_b16 v[72:73], v24 offset:0
    ds_read_b64_tr_b16 v[74:75], v24 offset:256
    ds_read_b64_tr_b16 v[76:77], v24 offset:1024
    ds_read_b64_tr_b16 v[78:79], v24 offset:1280
    ds_read_b64_tr_b16 v[80:81], v24 offset:2048
    ds_read_b64_tr_b16 v[82:83], v24 offset:2304
    ds_read_b64_tr_b16 v[84:85], v24 offset:3072
    ds_read_b64_tr_b16 v[86:87], v24 offset:3328
    ds_read_b64_tr_b16 v[88:89], v24 offset:4096
    ds_read_b64_tr_b16 v[90:91], v24 offset:4352
    ds_read_b64_tr_b16 v[92:93], v24 offset:5120
    ds_read_b64_tr_b16 v[94:95], v24 offset:5376
    s_waitcnt lgkmcnt(10)
    v_mfma_f32_32x32x16_bf16 v[112:127], v[64:67], v[72:75], 0
    ds_read_b64_tr_b16 v[96:97], v24 offset:6144
    ds_read_b64_tr_b16 v[98:99], v24 offset:6400
    s_waitcnt lgkmcnt(10)
    v_mfma_f32_32x32x16_bf16 v[112:127], v[64:67], v[76:79], v[112:127]
    ds_read_b64_tr_b16 v[100:101], v24 offset:7168
    ds_read_b64_tr_b16 v[102:103], v24 offset:7424
    s_waitcnt lgkmcnt(10)
    v_mfma_f32_32x32x16_bf16 v[112:127], v[64:67], v[80:83], v[112:127]
    ds_read_b64_tr_b16 v[72:73], v24 offset:8192
    ds_read_b64_tr_b16 v[74:75], v24 offset:8448
    s_waitcnt lgkmcnt(10)
    v_mfma_f32_32x32x16_bf16 v[112:127], v[64:67], v[84:87], v[112:127]
    ds_read_b64_tr_b16 v[76:77], v24 offset:9216
    ds_read_b64_tr_b16 v[78:79], v24 offset:9472
    s_waitcnt lgkmcnt(10)
    v_mfma_f32_32x32x16_bf16 v[112:127], v[64:67], v[88:91], v[112:127]
    ds_read_b64_tr_b16 v[80:81], v24 offset:10240
    ds_read_b64_tr_b16 v[82:83], v24 offset:10496
    s_waitcnt lgkmcnt(10)
    v_mfma_f32_32x32x16_bf16 v[112:127], v[64:67], v[92:95], v[112:127]
    ds_read_b64_tr_b16 v[84:85], v24 offset:11264
    ds_read_b64_tr_b16 v[86:87], v24 offset:11520
    s_waitcnt lgkmcnt(10)
    v_mfma_f32_32x32x16_bf16 v[112:127], v[64:67], v[96:99], v[112:127]
    ds_read_b64_tr_b16 v[88:89], v24 offset:12288
    ds_read_b64_tr_b16 v[90:91], v24 offset:12544
    s_waitcnt lgkmcnt(10)
    v_mfma_f32_32x32x16_bf16 v[112:127], v[64:67], v[100:103], v[112:127]
    ds_read_b64_tr_b16 v[92:93], v24 offset:13312
    ds_read_b64_tr_b16 v[94:95], v24 offset:13568
    s_waitcnt lgkmcnt(10)
    v_mfma_f32_32x32x16_bf16 v[112:127], v[64:67], v[72:75], v[112:127]
    ds_read_b64_tr_b16 v[96:97], v24 offset:14336
    ds_read_b64_tr_b16 v[98:99], v24 offset:14592
    s_waitcnt lgkmcnt(10)
    v_mfma_f32_32x32x16_bf16 v[112:127], v[64:67], v[76:79], v[112:127]
    ds_read_b64_tr_b16 v[100:101], v24 offset:15360
    ds_read_b64_tr_b16 v[102:103], v24 offset:15616
    s_waitcnt lgkmcnt(10)
    v_mfma_f32_32x32x16_bf16 v[112:127], v[64:67], v[80:83], v[112:127]
    s_waitcnt lgkmcnt(8)
    v_mfma_f32_32x32x16_bf16 v[112:127], v[64:67], v[84:87], v[112:127]
    s_waitcnt lgkmcnt(6)
    v_mfma_f32_32x32x16_bf16 v[112:127], v[64:67], v[88:91], v[112:127]
    s_waitcnt lgkmcnt(4)
    v_mfma_f32_32x32x16_bf16 v[112:127], v[64:67], v[92:95], v[112:127]
    s_waitcnt lgkmcnt(2)
    v_mfma_f32_32x32x16_bf16 v[112:127], v[64:67], v[96:99], v[112:127]
    s_waitcnt lgkmcnt(0)
    v_mfma_f32_32x32x16_bf16 v[112:127], v[64:67], v[100:103], v[112:127]
L183:
    s_cmp_gt_u32 s87, 0
    s_cbranch_scc0 L187
    s_waitcnt vmcnt(1)
    s_cmp_eq_u32 s6, 0
    s_cbranch_scc0 L188
    s_waitcnt vmcnt(0)
L188:
    s_lshl_b32 s40, s80, 12
    s_add_u32 s40, s40, 147456
    v_add_u32 v45, s40, v3
    v_bfe_u32 v40, v2, 2, 2
    v_lshlrev_b32 v41, 7, v40
    v_lshrrev_b32 v40, 1, v40
    v_lshrrev_b32 v42, 5, v2
    v_xor_b32 v40, v40, v42
    v_lshl_add_u32 v41, v40, 6, v41
    v_and_b32 v40, 63, v24
    v_add_u32 v41, v41, v40
    v_add_u32 v41, s40, v41
    ds_write_b128 v45, v[128:131] offset:0
    ds_write_b128 v45, v[132:135] offset:1024
    ds_write_b128 v45, v[136:139] offset:2048
    ds_write_b128 v45, v[140:143] offset:3072
    ds_read_b64_tr_b16 v[72:73], v41 offset:0
    ds_read_b64_tr_b16 v[74:75], v41 offset:512
    ds_read_b64_tr_b16 v[76:77], v41 offset:1024
    ds_read_b64_tr_b16 v[78:79], v41 offset:1536
    ds_read_b64_tr_b16 v[80:81], v41 offset:2048
    ds_read_b64_tr_b16 v[82:83], v41 offset:2560
    ds_read_b64_tr_b16 v[84:85], v41 offset:3072
    ds_read_b64_tr_b16 v[86:87], v41 offset:3584
    s_waitcnt lgkmcnt(0)
    ds_write_b128 v45, v[144:147] offset:0
    ds_write_b128 v45, v[148:151] offset:1024
    ds_write_b128 v45, v[152:155] offset:2048
    ds_write_b128 v45, v[156:159] offset:3072
    ds_read_b64_tr_b16 v[88:89], v41 offset:0
    ds_read_b64_tr_b16 v[90:91], v41 offset:512
    ds_read_b64_tr_b16 v[92:93], v41 offset:1024
    ds_read_b64_tr_b16 v[94:95], v41 offset:1536
    ds_read_b64_tr_b16 v[96:97], v41 offset:2048
    ds_read_b64_tr_b16 v[98:99], v41 offset:2560
    ds_read_b64_tr_b16 v[100:101], v41 offset:3072
    ds_read_b64_tr_b16 v[102:103], v41 offset:3584
    s_waitcnt lgkmcnt(0)
    v_lshrrev_b32 v40, 4, v2
    v_lshlrev_b32 v40, 15, v40
    v_and_b32 v42, 15, v2
    v_lshl_add_u32 v40, v42, 4, v40
    s_lshl_b32 s40, s84, 17
    s_lshl_b32 s41, s86, 12
    s_add_u32 s40, s40, s41
    s_lshl_b32 s41, s85, 8
    s_add_u32 s40, s40, s41
    s_add_u32 s40, s40, 2097152
    v_mov_b32 v43, 0
    v_mov_b32 v44, 0
    s_waitcnt lgkmcnt(0)
    buffer_store_dwordx4 v[72:75], v40, s[8:11], s40 offen offset:0 sc1
    buffer_store_dwordx4 v[76:79], v40, s[8:11], s40 offen offset:512 sc1
    buffer_store_dwordx4 v[80:83], v40, s[8:11], s40 offen offset:1024 sc1
    buffer_store_dwordx4 v[84:87], v40, s[8:11], s40 offen offset:1536 sc1
    buffer_store_dwordx4 v[88:91], v40, s[8:11], s40 offen offset:2048 sc1
    buffer_store_dwordx4 v[92:95], v40, s[8:11], s40 offen offset:2560 sc1
    buffer_store_dwordx4 v[96:99], v40, s[8:11], s40 offen offset:3072 sc1
    buffer_store_dwordx4 v[100:103], v40, s[8:11], s40 offen offset:3584 sc1
    v_dot2_f32_bf16 v43, v72, s20, v43
    v_dot2_f32_bf16 v44, v73, s20, v44
    v_dot2_f32_bf16 v43, v74, s20, v43
    v_dot2_f32_bf16 v44, v75, s20, v44
    v_dot2_f32_bf16 v43, v76, s20, v43
    v_dot2_f32_bf16 v44, v77, s20, v44
    v_dot2_f32_bf16 v43, v78, s20, v43
    v_dot2_f32_bf16 v44, v79, s20, v44
    v_dot2_f32_bf16 v43, v80, s20, v43
    v_dot2_f32_bf16 v44, v81, s20, v44
    v_dot2_f32_bf16 v43, v82, s20, v43
    v_dot2_f32_bf16 v44, v83, s20, v44
    v_dot2_f32_bf16 v43, v84, s20, v43
    v_dot2_f32_bf16 v44, v85, s20, v44
    v_dot2_f32_bf16 v43, v86, s20, v43
    v_dot2_f32_bf16 v44, v87, s20, v44
    v_dot2_f32_bf16 v43, v88, s20, v43
    v_dot2_f32_bf16 v44, v89, s20, v44
    v_dot2_f32_bf16 v43, v90, s20, v43
    v_dot2_f32_bf16 v44, v91, s20, v44
    v_dot2_f32_bf16 v43, v92, s20, v43
    v_dot2_f32_bf16 v44, v93, s20, v44
    v_dot2_f32_bf16 v43, v94, s20, v43
    v_dot2_f32_bf16 v44, v95, s20, v44
    v_dot2_f32_bf16 v43, v96, s20, v43
    v_dot2_f32_bf16 v44, v97, s20, v44
    v_dot2_f32_bf16 v43, v98, s20, v43
    v_dot2_f32_bf16 v44, v99, s20, v44
    v_dot2_f32_bf16 v43, v100, s20, v43
    v_dot2_f32_bf16 v44, v101, s20, v44
    v_dot2_f32_bf16 v43, v102, s20, v43
    v_dot2_f32_bf16 v44, v103, s20, v44
    s_nop 2
    v_add_f32 v43, v43, v44
    s_lshl_b32 s40, s86, 1
    s_add_u32 s40, s40, s85
    s_mul_i32 s40, s40, 7168
    s_lshl_b32 s41, s84, 8
    s_add_u32 s40, s40, s41
    s_add_u32 s40, s40, 1572864
    v_lshlrev_b32 v42, 2, v2
    buffer_store_dword v43, v42, s[8:11], s40 offen sc1
L187:
    ds_read_b32 v1, v25 offset:16
    s_waitcnt lgkmcnt(0)
    s_movk_i32 s39, 2
    v_cmp_gt_u32 vcc, s39, v1
    s_cbranch_vccz L190
L191:
    s_sleep 1
    s_add_u32 s38, s38, 1
    s_cmp_gt_u32 s38, 6400000
    s_cbranch_scc1 L190
    ds_read_b32 v1, v25 offset:16
    s_waitcnt lgkmcnt(0)
    v_cmp_gt_u32 vcc, s39, v1
    s_cbranch_vccnz L191
L190:
    s_add_u32 s41, s30, 0
    s_and_b32 s41, s41, 31
    s_mul_i32 s41, s41, 49152
    s_add_u32 s41, s41, s31
    s_add_u32 s40, s41, 0
    s_add_u32 m0, s25, 0
    s_nop 0
    buffer_load_dwordx4 v16, s[44:47], s40 offen lds
    s_add_u32 s41, s30, 4
    s_and_b32 s41, s41, 31
    s_mul_i32 s41, s41, 49152
    s_add_u32 s41, s41, s31
    s_add_u32 s40, s41, 0
    s_add_u32 m0, s25, 4096
    s_nop 0
    buffer_load_dwordx4 v16, s[44:47], s40 offen lds
    s_add_u32 s41, s30, 8
    s_and_b32 s41, s41, 31
    s_mul_i32 s41, s41, 49152
    s_add_u32 s41, s41, s31
    s_add_u32 s40, s41, 0
    s_add_u32 m0, s25, 8192
    s_nop 0
    buffer_load_dwordx4 v16, s[44:47], s40 offen lds
    s_add_u32 s41, s30, 12
    s_and_b32 s41, s41, 31
    s_mul_i32 s41, s41, 49152
    s_add_u32 s41, s41, s31
    s_add_u32 s40, s41, 0
    s_add_u32 m0, s25, 12288
    s_nop 0
    buffer_load_dwordx4 v16, s[44:47], s40 offen lds
    s_add_u32 s41, s30, 16
    s_and_b32 s41, s41, 31
    s_mul_i32 s41, s41, 49152
    s_add_u32 s41, s41, s31
    s_add_u32 s40, s41, 0
    s_add_u32 m0, s25, 16384
    s_nop 0
    buffer_load_dwordx4 v16, s[44:47], s40 offen lds
    s_add_u32 s41, s30, 20
    s_and_b32 s41, s41, 31
    s_mul_i32 s41, s41, 49152
    s_add_u32 s41, s41, s31
    s_add_u32 s40, s41, 0
    s_add_u32 m0, s25, 20480
    s_nop 0
    buffer_load_dwordx4 v16, s[44:47], s40 offen lds
    s_add_u32 s41, s30, 24
    s_and_b32 s41, s41, 31
    s_mul_i32 s41, s41, 49152
    s_add_u32 s41, s41, s31
    s_add_u32 s40, s41, 0
    s_add_u32 m0, s25, 24576
    s_nop 0
    buffer_load_dwordx4 v16, s[44:47], s40 offen lds
    s_add_u32 s41, s30, 28
    s_and_b32 s41, s41, 31
    s_mul_i32 s41, s41, 49152
    s_add_u32 s41, s41, s31
    s_add_u32 s40, s41, 0
    s_add_u32 m0, s25, 28672
    s_nop 0
    buffer_load_dwordx4 v16, s[44:47], s40 offen lds
    s_sub_u32 s40, s6, 1
    s_cmp_lt_u32 s40, 2
    s_cbranch_scc0 L192
    ds_read_b64_tr_b16 v[72:73], v24 offset:16384
    ds_read_b64_tr_b16 v[74:75], v24 offset:16640
    ds_read_b64_tr_b16 v[76:77], v24 offset:17408
    ds_read_b64_tr_b16 v[78:79], v24 offset:17664
    ds_read_b64_tr_b16 v[80:81], v24 offset:18432
    ds_read_b64_tr_b16 v[82:83], v24 offset:18688
    ds_read_b64_tr_b16 v[84:85], v24 offset:19456
    ds_read_b64_tr_b16 v[86:87], v24 offset:19712
    ds_read_b64_tr_b16 v[88:89], v24 offset:20480
    ds_read_b64_tr_b16 v[90:91], v24 offset:20736
    ds_read_b64_tr_b16 v[92:93], v24 offset:21504
    ds_read_b64_tr_b16 v[94:95], v24 offset:21760
    s_waitcnt lgkmcnt(10)
    v_mfma_f32_32x32x16_bf16 v[112:127], v[64:67], v[72:75], v[112:127]
    ds_read_b64_tr_b16 v[96:97], v24 offset:22528
    ds_read_b64_tr_b16 v[98:99], v24 offset:22784
    s_waitcnt lgkmcnt(10)
    v_mfma_f32_32x32x16_bf16 v[112:127], v[64:67], v[76:79], v[112:127]
    ds_read_b64_tr_b16 v[100:101], v24 offset:23552
    ds_read_b64_tr_b16 v[102:103], v24 offset:23808
    s_waitcnt lgkmcnt(10)
    v_mfma_f32_32x32x16_bf16 v[112:127], v[64:67], v[80:83], v[112:127]
    ds_read_b64_tr_b16 v[72:73], v24 offset:24576
    ds_read_b64_tr_b16 v[74:75], v24 offset:24832
    s_waitcnt lgkmcnt(10)
    v_mfma_f32_32x32x16_bf16 v[112:127], v[64:67], v[84:87], v[112:127]
    ds_read_b64_tr_b16 v[76:77], v24 offset:25600
    ds_read_b64_tr_b16 v[78:79], v24 offset:25856
    s_waitcnt lgkmcnt(10)
    v_mfma_f32_32x32x16_bf16 v[112:127], v[64:67], v[88:91], v[112:127]
    ds_read_b64_tr_b16 v[80:81], v24 offset:26624
    ds_read_b64_tr_b16 v[82:83], v24 offset:26880
    s_waitcnt lgkmcnt(10)
    v_mfma_f32_32x32x16_bf16 v[112:127], v[64:67], v[92:95], v[112:127]
    ds_read_b64_tr_b16 v[84:85], v24 offset:27648
    ds_read_b64_tr_b16 v[86:87], v24 offset:27904
    s_waitcnt lgkmcnt(10)
    v_mfma_f32_32x32x16_bf16 v[112:127], v[64:67], v[96:99], v[112:127]
    ds_read_b64_tr_b16 v[88:89], v24 offset:28672
    ds_read_b64_tr_b16 v[90:91], v24 offset:28928
    s_waitcnt lgkmcnt(10)
    v_mfma_f32_32x32x16_bf16 v[112:127], v[64:67], v[100:103], v[112:127]
    ds_read_b64_tr_b16 v[92:93], v24 offset:29696
    ds_read_b64_tr_b16 v[94:95], v24 offset:29952
    s_waitcnt lgkmcnt(10)
    v_mfma_f32_32x32x16_bf16 v[112:127], v[64:67], v[72:75], v[112:127]
    ds_read_b64_tr_b16 v[96:97], v24 offset:30720
    ds_read_b64_tr_b16 v[98:99], v24 offset:30976
    s_waitcnt lgkmcnt(10)
    v_mfma_f32_32x32x16_bf16 v[112:127], v[64:67], v[76:79], v[112:127]
    ds_read_b64_tr_b16 v[100:101], v24 offset:31744
    ds_read_b64_tr_b16 v[102:103], v24 offset:32000
    s_waitcnt lgkmcnt(10)
    v_mfma_f32_32x32x16_bf16 v[112:127], v[64:67], v[80:83], v[112:127]
    s_waitcnt lgkmcnt(8)
    v_mfma_f32_32x32x16_bf16 v[112:127], v[64:67], v[84:87], v[112:127]
    s_waitcnt lgkmcnt(6)
    v_mfma_f32_32x32x16_bf16 v[112:127], v[64:67], v[88:91], v[112:127]
    s_waitcnt lgkmcnt(4)
    v_mfma_f32_32x32x16_bf16 v[112:127], v[64:67], v[92:95], v[112:127]
    s_waitcnt lgkmcnt(2)
    v_mfma_f32_32x32x16_bf16 v[112:127], v[64:67], v[96:99], v[112:127]
    s_waitcnt lgkmcnt(0)
    v_mfma_f32_32x32x16_bf16 v[112:127], v[64:67], v[100:103], v[112:127]
    s_nop 11
    v_cvt_pk_bf16_f32 v104, v112, v112
    v_and_b32 v107, 0xffff, v104
    v_lshlrev_b32 v105, 16, v104
    v_sub_f32 v105, v112, v105
    v_cvt_pk_bf16_f32 v106, v112, v105
    s_lshl_b32 s40, s6, 8
    s_add_u32 s40, s40, 160512
    v_and_b32 v108, 31, v2
    v_lshlrev_b32 v108, 3, v108
    v_add_u32 v108, s40, v108
    ds_write_b64 v108, v[106:107]
    s_waitcnt lgkmcnt(0)
L192:
    v_mov_b32 v13, 5
    ds_max_u32 v0, v13
    s_setprio 0
    s_cmp_eq_u32 s6, 3
    s_cbranch_scc0 L193
    v_lshlrev_b32 v248, 5, v2
    s_mov_b32 s42, 1761280
    s_mov_b32 s41, 0
    buffer_load_dwordx4 v[240:243], v248, s[8:11], s42 offen sc1
    buffer_load_dwordx4 v[244:247], v248, s[8:11], s42 offen offset:16 sc1
    s_branch L196
L194:
    s_sleep 4
    buffer_load_dwordx4 v[240:243], v248, s[8:11], s42 offen sc1
    buffer_load_dwordx4 v[244:247], v248, s[8:11], s42 offen offset:16 sc1
L196:
    s_add_u32 s41, s41, 1
    s_cmp_gt_u32 s41, 400000
    s_cbranch_scc1 L195
    s_waitcnt vmcnt(0)
    v_xor_b32 v240, s91, v240
    v_xor_b32 v241, s93, v241
    v_xor_b32 v242, s91, v242
    v_xor_b32 v243, s93, v243
    v_xor_b32 v244, s91, v244
    v_xor_b32 v245, s93, v245
    v_xor_b32 v246, s91, v246
    v_xor_b32 v247, s93, v247
    v_or3_b32 v240, v240, v242, v244
    v_or_b32 v240, v240, v246
    v_or3_b32 v241, v241, v243, v245
    v_and_b32 v249, -8, v240
    v_or3_b32 v241, v241, v247, v249
    v_cmp_ne_u32 vcc, 0, v241
    s_cbranch_vccnz L194
L195:
    v_cmp_ne_u32 vcc, 0, v240
    s_lshl_b32 s40, s16, 2
    s_lshr_b64 s[42:43], vcc, s40
    s_and_b32 s40, s42, 15
    s_cselect_b32 s40, 1, 0
    v_mov_b32 v26, s40
    v_mov_b32 v27, 163488
    ds_write_b32 v27, v26
    s_waitcnt lgkmcnt(0)
L193:
    s_cmp_lt_u32 s6, 3
    s_cbranch_scc0 L197
    s_sub_u32 s40, 0, s28
    s_and_b32 s40, s40, 31
    s_lshl_b32 s40, s40, 10
    v_add_u32 v26, s40, v20
    v_add_u32 v27, s40, v21
    ds_read_b128 v[160:163], v26 offset:32768
    ds_read_b128 v[192:195], v27 offset:0
    s_sub_u32 s40, 4, s28
    s_and_b32 s40, s40, 31
    s_lshl_b32 s40, s40, 10
    v_add_u32 v26, s40, v20
    v_add_u32 v27, s40, v21
    ds_read_b128 v[164:167], v26 offset:32768
    ds_read_b128 v[196:199], v27 offset:0
    s_sub_u32 s40, 8, s28
    s_and_b32 s40, s40, 31
    s_lshl_b32 s40, s40, 10
    v_add_u32 v26, s40, v20
    v_add_u32 v27, s40, v21
    ds_read_b128 v[168:171], v26 offset:32768
    ds_read_b128 v[200:203], v27 offset:0
    s_sub_u32 s40, 12, s28
    s_and_b32 s40, s40, 31
    s_lshl_b32 s40, s40, 10
    v_add_u32 v26, s40, v20
    v_add_u32 v27, s40, v21
    ds_read_b128 v[172:175], v26 offset:32768
    ds_read_b128 v[204:207], v27 offset:0
    s_waitcnt lgkmcnt(0)
    s_sub_u32 s40, 16, s28
    s_and_b32 s40, s40, 31
    s_lshl_b32 s40, s40, 10
    v_add_u32 v26, s40, v20
    v_add_u32 v27, s40, v21
    ds_read_b128 v[176:179], v26 offset:32768
    ds_read_b128 v[208:211], v27 offset:0
    s_sub_u32 s40, 20, s28
    s_and_b32 s40, s40, 31
    s_lshl_b32 s40, s40, 10
    v_add_u32 v26, s40, v20
    v_add_u32 v27, s40, v21
    ds_read_b128 v[180:183], v26 offset:32768
    ds_read_b128 v[212:215], v27 offset:0
    s_sub_u32 s40, 24, s28
    s_and_b32 s40, s40, 31
    s_lshl_b32 s40, s40, 10
    v_add_u32 v26, s40, v20
    v_add_u32 v27, s40, v21
    ds_read_b128 v[184:187], v26 offset:32768
    ds_read_b128 v[216:219], v27 offset:0
    s_sub_u32 s40, 28, s28
    s_and_b32 s40, s40, 31
    s_lshl_b32 s40, s40, 10
    v_add_u32 v26, s40, v20
    v_add_u32 v27, s40, v21
    ds_read_b128 v[188:191], v26 offset:32768
    ds_read_b128 v[220:223], v27 offset:0
    s_waitcnt lgkmcnt(0)
L197:
    s_waitcnt vmcnt(0)
    v_mov_b32 v13, 6
    ds_max_u32 v0, v13
    s_cmp_eq_u32 s6, 3
    s_cbranch_scc0 L198
    s_sub_u32 s40, 0, s28
    s_and_b32 s40, s40, 31
    s_lshl_b32 s40, s40, 10
    v_add_u32 v26, s40, v20
    v_add_u32 v27, s40, v21
    ds_read_b128 v[160:163], v26 offset:32768
    ds_read_b128 v[192:195], v27 offset:0
    s_sub_u32 s40, 4, s28
    s_and_b32 s40, s40, 31
    s_lshl_b32 s40, s40, 10
    v_add_u32 v26, s40, v20
    v_add_u32 v27, s40, v21
    ds_read_b128 v[164:167], v26 offset:32768
    ds_read_b128 v[196:199], v27 offset:0
    s_sub_u32 s40, 8, s28
    s_and_b32 s40, s40, 31
    s_lshl_b32 s40, s40, 10
    v_add_u32 v26, s40, v20
    v_add_u32 v27, s40, v21
    ds_read_b128 v[168:171], v26 offset:32768
    ds_read_b128 v[200:203], v27 offset:0
    s_sub_u32 s40, 12, s28
    s_and_b32 s40, s40, 31
    s_lshl_b32 s40, s40, 10
    v_add_u32 v26, s40, v20
    v_add_u32 v27, s40, v21
    ds_read_b128 v[172:175], v26 offset:32768
    ds_read_b128 v[204:207], v27 offset:0
    s_waitcnt lgkmcnt(0)
    s_sub_u32 s40, 16, s28
    s_and_b32 s40, s40, 31
    s_lshl_b32 s40, s40, 10
    v_add_u32 v26, s40, v20
    v_add_u32 v27, s40, v21
    ds_read_b128 v[176:179], v26 offset:32768
    ds_read_b128 v[208:211], v27 offset:0
    s_sub_u32 s40, 20, s28
    s_and_b32 s40, s40, 31
    s_lshl_b32 s40, s40, 10
    v_add_u32 v26, s40, v20
    v_add_u32 v27, s40, v21
    ds_read_b128 v[180:183], v26 offset:32768
    ds_read_b128 v[212:215], v27 offset:0
    s_sub_u32 s40, 24, s28
    s_and_b32 s40, s40, 31
    s_lshl_b32 s40, s40, 10
    v_add_u32 v26, s40, v20
    v_add_u32 v27, s40, v21
    ds_read_b128 v[184:187], v26 offset:32768
    ds_read_b128 v[216:219], v27 offset:0
    s_sub_u32 s40, 28, s28
    s_and_b32 s40, s40, 31
    s_lshl_b32 s40, s40, 10
    v_add_u32 v26, s40, v20
    v_add_u32 v27, s40, v21
    ds_read_b128 v[188:191], v26 offset:32768
    ds_read_b128 v[220:223], v27 offset:0
    s_waitcnt lgkmcnt(0)
L198:
    ds_read_b32 v1, v25 offset:0
    s_waitcnt lgkmcnt(0)
    s_movk_i32 s39, 6
    v_cmp_gt_u32 vcc, s39, v1
    s_cbranch_vccz L200
L201:
    s_sleep 1
    s_add_u32 s38, s38, 1
    s_cmp_gt_u32 s38, 6400000
    s_cbranch_scc1 L200
    ds_read_b32 v1, v25 offset:0
    s_waitcnt lgkmcnt(0)
    v_cmp_gt_u32 vcc, s39, v1
    s_cbranch_vccnz L201
L200:
    s_cmp_gt_u32 s87, 0
    s_cbranch_scc0 L202
    s_lshl_b32 s40, s80, 2
    s_add_u32 s40, s40, s88
    v_mov_b32 v26, 1
    s_mov_b64 exec, 1
    buffer_store_dword v26, off, s[8:11], s40 sc1
    s_mov_b64 exec, -1
L202:
    s_mul_i32 s40, s6, 24576
    v_subrev_u32 v109, s40, v24
    s_setprio 3
    ds_read_b64_tr_b16 v[72:73], v109 offset:0
    ds_read_b64_tr_b16 v[74:75], v109 offset:256
    ds_read_b64_tr_b16 v[76:77], v109 offset:1024
    ds_read_b64_tr_b16 v[78:79], v109 offset:1280
    ds_read_b64_tr_b16 v[80:81], v109 offset:2048
    ds_read_b64_tr_b16 v[82:83], v109 offset:2304
    ds_read_b64_tr_b16 v[84:85], v109 offset:3072
    ds_read_b64_tr_b16 v[86:87], v109 offset:3328
    ds_read_b64_tr_b16 v[88:89], v109 offset:4096
    ds_read_b64_tr_b16 v[90:91], v109 offset:4352
    ds_read_b64_tr_b16 v[92:93], v109 offset:5120
    ds_read_b64_tr_b16 v[94:95], v109 offset:5376
    s_waitcnt lgkmcnt(10)
    v_mfma_f32_32x32x16_bf16 v[112:127], v[64:67], v[72:75], 0
    ds_read_b64_tr_b16 v[96:97], v109 offset:6144
    ds_read_b64_tr_b16 v[98:99], v109 offset:6400
    s_waitcnt lgkmcnt(10)
    v_mfma_f32_32x32x16_bf16 v[112:127], v[64:67], v[76:79], v[112:127]
    ds_read_b64_tr_b16 v[100:101], v109 offset:7168
    ds_read_b64_tr_b16 v[102:103], v109 offset:7424
    s_waitcnt lgkmcnt(10)
    v_mfma_f32_32x32x16_bf16 v[112:127], v[64:67], v[80:83], v[112:127]
    s_waitcnt lgkmcnt(8)
    v_mfma_f32_32x32x16_bf16 v[112:127], v[64:67], v[84:87], v[112:127]
    s_waitcnt lgkmcnt(6)
    v_mfma_f32_32x32x16_bf16 v[112:127], v[64:67], v[88:91], v[112:127]
    s_waitcnt lgkmcnt(4)
    v_mfma_f32_32x32x16_bf16 v[112:127], v[64:67], v[92:95], v[112:127]
    s_waitcnt lgkmcnt(2)
    v_mfma_f32_32x32x16_bf16 v[112:127], v[64:67], v[96:99], v[112:127]
    s_waitcnt lgkmcnt(0)
    v_mfma_f32_32x32x16_bf16 v[112:127], v[64:67], v[100:103], v[112:127]
    s_nop 11
    v_cvt_pk_bf16_f32 v104, v112, v112
    v_and_b32 v107, 0xffff, v104
    v_lshlrev_b32 v105, 16, v104
    v_sub_f32 v105, v112, v105
    v_cvt_pk_bf16_f32 v106, v112, v105
    s_lshr_b32 s40, s6, 1
    s_lshl_b32 s40, s40, 9
    s_and_b32 s41, s6, 1
    s_lshl_b32 s41, s41, 3
    s_add_u32 s40, s40, s41
    s_add_u32 s40, s40, 159744
    v_and_b32 v108, 31, v2
    v_lshlrev_b32 v108, 4, v108
    v_add_u32 v108, s40, v108
    ds_write_b64 v108, v[106:107]
    s_waitcnt lgkmcnt(0)
    s_setprio 0
    v_mov_b32 v13, 7
    ds_max_u32 v0, v13
    v_mov_b32 v26, 163496
    ds_read_b64 v[26:27], v26
    s_waitcnt lgkmcnt(0)
    v_readfirstlane_b32 s92, v26
    v_readfirstlane_b32 s93, v27
    s_add_u32 s94, s63, 7931904
    s_cmp_ge_u32 s16, 1
    s_cselect_b32 s94, s94, 0x7ff00000
    s_cselect_b32 s64, -1, 0
    s_add_u32 s95, s63, 7473152
    s_cmp_ge_u32 s16, 2
    s_cselect_b32 s95, s95, 0x7ff00000
    s_cselect_b32 s65, -1, 0
    s_lshl_b32 s82, s16, 11
    s_lshl_b32 s41, s17, 7
    s_add_u32 s82, s82, s41
    s_lshl_b32 s41, s6, 2
    s_add_u32 s82, s82, s41
    s_add_u32 s82, s82, 1720320
    v_lshlrev_b32 v112, 3, v2
    v_add_u32 v112, 4096, v112
    v_add_u32 v113, 110592, v20
    ds_read_b32 v1, v25 offset:16
    s_waitcnt lgkmcnt(0)
    s_movk_i32 s39, 4
    v_cmp_gt_u32 vcc, s39, v1
    s_cbranch_vccz L204
L205:
    s_sleep 1
    s_add_u32 s38, s38, 1
    s_cmp_gt_u32 s38, 6400000
    s_cbranch_scc1 L204
    ds_read_b32 v1, v25 offset:16
    s_waitcnt lgkmcnt(0)
    v_cmp_gt_u32 vcc, s39, v1
    s_cbranch_vccnz L205
L204:
    s_setprio 3
    s_mov_b32 s41, 0
    buffer_load_dwordx4 v[40:43], v3, s[8:11], s94 offen offset:0 sc1
    buffer_load_dwordx4 v[44:47], v3, s[8:11], s94 offen offset:1024 sc1
    buffer_load_dwordx4 v[48:51], v3, s[8:11], s94 offen offset:2048 sc1
    buffer_load_dwordx4 v[52:55], v3, s[8:11], s94 offen offset:3072 sc1
    buffer_load_dwordx2 v[72:73], v112, s[8:11], s94 offen sc1
    buffer_load_dwordx4 v[56:59], v3, s[8:11], s95 offen offset:0 sc1
    buffer_load_dwordx4 v[60:63], v3, s[8:11], s95 offen offset:1024 sc1
    buffer_load_dwordx4 v[64:67], v3, s[8:11], s95 offen offset:2048 sc1
    buffer_load_dwordx4 v[68:71], v3, s[8:11], s95 offen offset:3072 sc1
    buffer_load_dwordx2 v[74:75], v112, s[8:11], s95 offen sc1
L206:
    s_waitcnt vmcnt(5)
    v_bitop3_b32 v72, v72, v40, v41 bitop3:0x96
    v_bitop3_b32 v72, v72, v42, v43 bitop3:0x96
    v_bitop3_b32 v72, v72, v44, v45 bitop3:0x96
    v_bitop3_b32 v72, v72, v46, v47 bitop3:0x96
    v_bitop3_b32 v72, v72, v48, v49 bitop3:0x96
    v_bitop3_b32 v72, v72, v50, v51 bitop3:0x96
    v_bitop3_b32 v72, v72, v52, v53 bitop3:0x96
    v_bitop3_b32 v72, v72, v54, v55 bitop3:0x96
    v_xor_b32 v72, s92, v72
    v_xor_b32 v73, s93, v73
    v_or_b32 v72, v72, v73
    v_and_b32 v72, s64, v72
    s_waitcnt vmcnt(0)
    v_bitop3_b32 v74, v74, v56, v57 bitop3:0x96
    v_bitop3_b32 v74, v74, v58, v59 bitop3:0x96
    v_bitop3_b32 v74, v74, v60, v61 bitop3:0x96
    v_bitop3_b32 v74, v74, v62, v63 bitop3:0x96
    v_bitop3_b32 v74, v74, v64, v65 bitop3:0x96
    v_bitop3_b32 v74, v74, v66, v67 bitop3:0x96
    v_bitop3_b32 v74, v74, v68, v69 bitop3:0x96
    v_bitop3_b32 v74, v74, v70, v71 bitop3:0x96
    v_xor_b32 v74, s92, v74
    v_xor_b32 v75, s93, v75
    v_or_b32 v74, v74, v75
    v_and_b32 v74, s65, v74
    v_or_b32 v72, v72, v74
    v_cmp_ne_u32 vcc, 0, v72
    s_cbranch_vccz L207
    buffer_load_dwordx4 v[40:43], v3, s[8:11], s94 offen offset:0 sc1
    buffer_load_dwordx4 v[44:47], v3, s[8:11], s94 offen offset:1024 sc1
    buffer_load_dwordx4 v[48:51], v3, s[8:11], s94 offen offset:2048 sc1
    buffer_load_dwordx4 v[52:55], v3, s[8:11], s94 offen offset:3072 sc1
    buffer_load_dwordx2 v[72:73], v112, s[8:11], s94 offen sc1
    buffer_load_dwordx4 v[56:59], v3, s[8:11], s95 offen offset:0 sc1
    buffer_load_dwordx4 v[60:63], v3, s[8:11], s95 offen offset:1024 sc1
    buffer_load_dwordx4 v[64:67], v3, s[8:11], s95 offen offset:2048 sc1
    buffer_load_dwordx4 v[68:71], v3, s[8:11], s95 offen offset:3072 sc1
    buffer_load_dwordx2 v[74:75], v112, s[8:11], s95 offen sc1
    s_add_u32 s41, s41, 1
    s_cmp_le_u32 s41, 400000
    s_cbranch_scc1 L206
    s_waitcnt vmcnt(0)
L207:
    ds_write_b128 v113, v[40:43] offset:4096
    ds_write_b128 v113, v[56:59] offset:0
    ds_write_b128 v113, v[48:51] offset:16384
    ds_write_b128 v113, v[64:67] offset:12288
    ds_write_b128 v113, v[44:47] offset:28672
    ds_write_b128 v113, v[60:63] offset:24576
    ds_write_b128 v113, v[52:55] offset:40960
    ds_write_b128 v113, v[68:71] offset:36864
L208:
    v_mov_b32 v13, 8
    ds_max_u32 v0, v13
    v_mov_b32 v26, 1
    s_mov_b64 exec, 1
    buffer_store_dword v26, off, s[8:11], s82 sc1
    s_mov_b64 exec, -1
    s_setprio 0
    s_sub_u32 s40, 0, s28
    s_and_b32 s40, s40, 31
    s_lshl_b32 s40, s40, 10
    v_add_u32 v26, s40, v20
    ds_read_b128 v[224:227], v26 offset:0
    s_sub_u32 s40, 4, s28
    s_and_b32 s40, s40, 31
    s_lshl_b32 s40, s40, 10
    v_add_u32 v26, s40, v20
    ds_read_b128 v[228:231], v26 offset:0
    s_sub_u32 s40, 8, s28
    s_and_b32 s40, s40, 31
    s_lshl_b32 s40, s40, 10
    v_add_u32 v26, s40, v20
    ds_read_b128 v[232:235], v26 offset:0
    s_sub_u32 s40, 12, s28
    s_and_b32 s40, s40, 31
    s_lshl_b32 s40, s40, 10
    v_add_u32 v26, s40, v20
    ds_read_b128 v[236:239], v26 offset:0
    s_waitcnt lgkmcnt(0)
    s_sub_u32 s40, 16, s28
    s_and_b32 s40, s40, 31
    s_lshl_b32 s40, s40, 10
    v_add_u32 v26, s40, v20
    ds_read_b128 v[240:243], v26 offset:0
    s_sub_u32 s40, 20, s28
    s_and_b32 s40, s40, 31
    s_lshl_b32 s40, s40, 10
    v_add_u32 v26, s40, v20
    ds_read_b128 v[244:247], v26 offset:0
    s_sub_u32 s40, 24, s28
    s_and_b32 s40, s40, 31
    s_lshl_b32 s40, s40, 10
    v_add_u32 v26, s40, v20
    ds_read_b128 v[248:251], v26 offset:0
    s_sub_u32 s40, 28, s28
    s_and_b32 s40, s40, 31
    s_lshl_b32 s40, s40, 10
    v_add_u32 v26, s40, v20
    ds_read_b128 v[252:255], v26 offset:0
    s_waitcnt lgkmcnt(0)
    ds_read_b32 v1, v25 offset:0
    s_waitcnt lgkmcnt(0)
    s_movk_i32 s39, 8
    v_cmp_gt_u32 vcc, s39, v1
    s_cbranch_vccz L210
L211:
    s_sleep 1
    s_add_u32 s38, s38, 1
    s_cmp_gt_u32 s38, 6400000
    s_cbranch_scc1 L210
    ds_read_b32 v1, v25 offset:0
    s_waitcnt lgkmcnt(0)
    v_cmp_gt_u32 vcc, s39, v1
    s_cbranch_vccnz L211
L210:
    v_mov_b32 v13, 163488
    ds_read_b32 v13, v13
    s_waitcnt lgkmcnt(0)
    v_readfirstlane_b32 s21, v13
    s_cmp_eq_u32 s6, 2
    s_cbranch_scc0 L212
    v_lshlrev_b32 v26, 10, v2
    s_lshr_b32 s41, s2, 3
    s_mul_i32 s41, s41, 16384
    s_add_u32 s41, s41, 384
    s_mov_b32 exec_lo, 0xffff
    s_mov_b32 exec_hi, 0x0
    buffer_load_dword v31, v26, s[48:51], s41 offen
    s_mov_b64 exec, -1
L212:
    s_cmp_eq_u32 s6, 1
    s_cbranch_scc0 L213
    v_lshlrev_b32 v26, 10, v2
    s_lshr_b32 s41, s2, 3
    s_mul_i32 s41, s41, 57344
    s_add_u32 s41, s41, 384
    s_mov_b32 exec_lo, 0xffffffff
    s_mov_b32 exec_hi, 0xffffff
    buffer_load_dword v31, v26, s[52:55], s41 offen
    s_mov_b64 exec, -1
L213:
    s_cmp_lg_u32 s21, 0
    s_cbranch_scc1 L214
    v_lshlrev_b32 v13, 7, v2
    s_add_u32 s43, s63, 8388608
    s_mov_b32 exec_lo, 0xffff
    s_mov_b32 exec_hi, 0x0
    buffer_load_dword v31, v13, s[8:11], s43 offen sc1
    s_add_u32 s43, s60, 6291456
    s_mov_b32 exec_lo, 0xffff
    s_mov_b32 exec_hi, 0x0
    buffer_load_dword v31, v13, s[8:11], s43 offen sc1
    s_add_u32 s43, s61, 5767168
    s_mov_b32 exec_lo, 0xff
    s_mov_b32 exec_hi, 0x0
    buffer_load_dword v31, v13, s[8:11], s43 offen sc1
    s_mov_b64 exec, -1
L214:
    v_lshlrev_b32 v26, 7, v2
    s_lshl_b32 s41, s2, 13
    s_cmp_eq_u32 s6, 1
    s_cbranch_scc0 L215
    buffer_load_dword v31, v26, s[52:55], s41 offen
L215:
    s_sub_u32 s41, 255, s2
    s_lshl_b32 s41, s41, 13
    s_add_u32 s40, s32, 0
    s_add_u32 m0, s25, 32768
    s_nop 0
    buffer_load_dwordx4 v23, s[48:51], s40 offen lds
    s_add_u32 s40, s32, 32768
    s_add_u32 m0, s25, 36864
    s_nop 0
    buffer_load_dwordx4 v23, s[48:51], s40 offen lds
    s_add_u32 s40, s32, 65536
    s_add_u32 m0, s25, 40960
    s_nop 0
    buffer_load_dwordx4 v23, s[48:51], s40 offen lds
    s_add_u32 s40, s32, 98304
    s_add_u32 m0, s25, 45056
    s_nop 0
    buffer_load_dwordx4 v23, s[48:51], s40 offen lds
    s_add_u32 s40, s32, 131072
    s_add_u32 m0, s25, 49152
    s_nop 0
    buffer_load_dwordx4 v23, s[48:51], s40 offen lds
    s_add_u32 s40, s32, 163840
    s_add_u32 m0, s25, 53248
    s_nop 0
    buffer_load_dwordx4 v23, s[48:51], s40 offen lds
    s_add_u32 s40, s32, 196608
    s_add_u32 m0, s25, 57344
    s_nop 0
    buffer_load_dwordx4 v23, s[48:51], s40 offen lds
    s_waitcnt vmcnt(6)
    s_add_u32 s40, s32, 229376
    s_add_u32 m0, s25, 61440
    s_nop 0
    buffer_load_dwordx4 v23, s[48:51], s40 offen lds
    s_waitcnt vmcnt(6)
    s_add_u32 s40, s32, 16384
    s_add_u32 m0, s25, 65536
    s_nop 0
    buffer_load_dwordx4 v23, s[48:51], s40 offen lds
    s_waitcnt vmcnt(6)
    s_add_u32 s40, s32, 49152
    s_add_u32 m0, s25, 69632
    s_nop 0
    buffer_load_dwordx4 v23, s[48:51], s40 offen lds
    s_waitcnt vmcnt(6)
    s_add_u32 s40, s32, 81920
    s_add_u32 m0, s25, 73728
    s_nop 0
    buffer_load_dwordx4 v23, s[48:51], s40 offen lds
    s_waitcnt vmcnt(6)
    s_add_u32 s40, s32, 114688
    s_add_u32 m0, s25, 77824
    s_nop 0
    buffer_load_dwordx4 v23, s[48:51], s40 offen lds
    s_waitcnt vmcnt(6)
    s_add_u32 s40, s32, 147456
    s_add_u32 m0, s25, 81920
    s_nop 0
    buffer_load_dwordx4 v23, s[48:51], s40 offen lds
    s_waitcnt vmcnt(6)
    s_add_u32 s40, s32, 180224
    s_add_u32 m0, s25, 86016
    s_nop 0
    buffer_load_dwordx4 v23, s[48:51], s40 offen lds
    s_waitcnt vmcnt(6)
    s_add_u32 s40, s32, 212992
    s_add_u32 m0, s25, 90112
    s_nop 0
    buffer_load_dwordx4 v23, s[48:51], s40 offen lds
    s_waitcnt vmcnt(6)
    s_add_u32 s40, s32, 245760
    s_add_u32 m0, s25, 94208
    s_nop 0
    buffer_load_dwordx4 v23, s[48:51], s40 offen lds
    s_waitcnt vmcnt(6)
    s_add_u32 s40, s33, 0
    buffer_load_dwordx4 v[32:35], v23, s[52:55], s40 offen
    s_waitcnt vmcnt(6)
    s_add_u32 s40, s33, 114688
    buffer_load_dwordx4 v[36:39], v23, s[52:55], s40 offen
    s_waitcnt vmcnt(6)
    s_add_u32 s40, s33, 229376
    buffer_load_dwordx4 v[40:43], v23, s[52:55], s40 offen
    s_waitcnt vmcnt(6)
    s_add_u32 s40, s33, 344064
    buffer_load_dwordx4 v[44:47], v23, s[52:55], s40 offen
    s_waitcnt vmcnt(6)
    s_add_u32 s40, s33, 458752
    buffer_load_dwordx4 v[48:51], v23, s[52:55], s40 offen
    s_waitcnt vmcnt(6)
    s_add_u32 s40, s33, 573440
    buffer_load_dwordx4 v[52:55], v23, s[52:55], s40 offen
    s_waitcnt vmcnt(6)
    v_mov_b32 v13, 9
    ds_max_u32 v0, v13
    s_add_u32 s40, s33, 688128
    buffer_load_dwordx4 v[56:59], v23, s[52:55], s40 offen
    s_waitcnt vmcnt(6)
    s_add_u32 s40, s33, 851968
    buffer_load_dwordx4 v[60:63], v23, s[52:55], s40 offen
    s_waitcnt vmcnt(6)
    s_add_u32 s40, s33, 65536
    buffer_load_dwordx4 v[64:67], v23, s[52:55], s40 offen
    s_waitcnt vmcnt(6)
    s_add_u32 s40, s33, 180224
    buffer_load_dwordx4 v[68:71], v23, s[52:55], s40 offen
    s_waitcnt vmcnt(6)
    s_cmp_eq_u32 s6, 3
    s_cbranch_scc0 L216
    s_lshr_b32 s40, s17, 2
    s_lshl_b32 s40, s40, 9
    s_add_u32 s42, s40, 1753088
    v_min_u32 v28, 55, v2
    v_lshlrev_b32 v28, 3, v28
    s_mov_b32 s41, 0
    buffer_load_dwordx2 v[26:27], v28, s[8:11], s42 offen sc1
    s_branch L219
L217:
    s_sleep 4
    buffer_load_dwordx2 v[26:27], v28, s[8:11], s42 offen sc1
L219:
    s_add_u32 s41, s41, 1
    s_cmp_gt_u32 s41, 400000
    s_cbranch_scc1 L218
    s_waitcnt vmcnt(0)
    v_and_b32 v26, v26, v27
    v_cmp_ne_u32 vcc, 1, v26
    s_cbranch_vccnz L217
L218:
L216:
    v_mov_b32 v13, 10
    ds_max_u32 v0, v13
    ds_read_b32 v1, v25 offset:0
    s_waitcnt lgkmcnt(0)
    s_movk_i32 s39, 10
    v_cmp_gt_u32 vcc, s39, v1
    s_cbranch_vccz L221
L222:
    s_sleep 1
    s_add_u32 s38, s38, 1
    s_cmp_gt_u32 s38, 6400000
    s_cbranch_scc1 L221
    ds_read_b32 v1, v25 offset:0
    s_waitcnt lgkmcnt(0)
    v_cmp_gt_u32 vcc, s39, v1
    s_cbranch_vccnz L222
L221:
    ds_read_b32 v1, v25 offset:16
    s_waitcnt lgkmcnt(0)
    s_movk_i32 s39, 5
    v_cmp_gt_u32 vcc, s39, v1
    s_cbranch_vccz L224
L225:
    s_sleep 1
    s_add_u32 s38, s38, 1
    s_cmp_gt_u32 s38, 6400000
    s_cbranch_scc1 L224
    ds_read_b32 v1, v25 offset:16
    s_waitcnt lgkmcnt(0)
    v_cmp_gt_u32 vcc, s39, v1
    s_cbranch_vccnz L225
L224:
    s_add_u32 s40, s29, 0
    s_add_u32 m0, s25, 0
    s_nop 0
    buffer_load_dwordx4 v3, s[8:11], s40 offen sc1 lds
    s_waitcnt vmcnt(6)
    s_add_u32 s40, s29, 4096
    s_add_u32 m0, s25, 4096
    s_nop 0
    buffer_load_dwordx4 v3, s[8:11], s40 offen sc1 lds
    s_waitcnt vmcnt(6)
    s_add_u32 s40, s29, 8192
    s_add_u32 m0, s25, 8192
    s_nop 0
    buffer_load_dwordx4 v3, s[8:11], s40 offen sc1 lds
    s_waitcnt vmcnt(6)
    s_add_u32 s40, s29, 12288
    s_add_u32 m0, s25, 12288
    s_nop 0
    buffer_load_dwordx4 v3, s[8:11], s40 offen sc1 lds
    s_waitcnt vmcnt(6)
    s_add_u32 s40, s29, 16384
    s_add_u32 m0, s25, 16384
    s_nop 0
    buffer_load_dwordx4 v3, s[8:11], s40 offen sc1 lds
    s_waitcnt vmcnt(6)
    s_add_u32 s40, s29, 20480
    s_add_u32 m0, s25, 20480
    s_nop 0
    buffer_load_dwordx4 v3, s[8:11], s40 offen sc1 lds
    s_waitcnt vmcnt(6)
    s_add_u32 s40, s29, 24576
    s_add_u32 m0, s25, 24576
    s_nop 0
    buffer_load_dwordx4 v3, s[8:11], s40 offen sc1 lds
    s_waitcnt vmcnt(6)
    s_add_u32 s40, s29, 28672
    s_add_u32 m0, s25, 28672
    s_nop 0
    buffer_load_dwordx4 v3, s[8:11], s40 offen sc1 lds
    s_waitcnt vmcnt(6)
    s_add_u32 s40, s29, 32768
    s_add_u32 m0, s25, 98304
    s_nop 0
    buffer_load_dwordx4 v3, s[8:11], s40 offen sc1 lds
    s_waitcnt vmcnt(6)
    s_add_u32 s40, s29, 36864
    s_add_u32 m0, s25, 102400
    s_nop 0
    buffer_load_dwordx4 v3, s[8:11], s40 offen sc1 lds
    s_waitcnt vmcnt(6)
    s_add_u32 s40, s29, 40960
    s_add_u32 m0, s25, 106496
    s_nop 0
    buffer_load_dwordx4 v3, s[8:11], s40 offen sc1 lds
    s_waitcnt vmcnt(6)
    ds_read_b32 v1, v25 offset:16
    s_waitcnt lgkmcnt(0)
    s_movk_i32 s39, 6
    v_cmp_gt_u32 vcc, s39, v1
    s_cbranch_vccz L227
L228:
    s_sleep 1
    s_add_u32 s38, s38, 1
    s_cmp_gt_u32 s38, 6400000
    s_cbranch_scc1 L227
    ds_read_b32 v1, v25 offset:16
    s_waitcnt lgkmcnt(0)
    v_cmp_gt_u32 vcc, s39, v1
    s_cbranch_vccnz L228
L227:
    s_add_u32 s40, s29, 45056
    s_add_u32 m0, s25, 110592
    s_nop 0
    buffer_load_dwordx4 v3, s[8:11], s40 offen sc1 lds
    s_waitcnt vmcnt(6)
    s_add_u32 s40, s29, 49152
    s_add_u32 m0, s25, 114688
    s_nop 0
    buffer_load_dwordx4 v3, s[8:11], s40 offen sc1 lds
    s_waitcnt vmcnt(6)
    s_add_u32 s40, s29, 53248
    s_add_u32 m0, s25, 118784
    s_nop 0
    buffer_load_dwordx4 v3, s[8:11], s40 offen sc1 lds
    s_waitcnt vmcnt(6)
    s_add_u32 s40, s29, 57344
    s_add_u32 m0, s25, 122880
    s_nop 0
    buffer_load_dwordx4 v3, s[8:11], s40 offen sc1 lds
    s_waitcnt vmcnt(6)
    s_add_u32 s40, s29, 61440
    s_add_u32 m0, s25, 126976
    s_nop 0
    buffer_load_dwordx4 v3, s[8:11], s40 offen sc1 lds
    s_waitcnt vmcnt(6)
    s_cmp_eq_u32 s6, 3
    s_cbranch_scc0 L229
    v_lshrrev_b32 v144, 5, v2
    v_mul_u32_u24 v145, 7168, v144
    v_and_b32 v146, 31, v2
    v_min_u32 v146, 27, v146
    v_lshl_add_u32 v145, v146, 4, v145
    s_mul_i32 s40, s17, 448
    s_add_u32 s40, s40, 1572864
    buffer_load_dwordx4 v[112:115], v145, s[8:11], s40 offen sc1
    s_add_u32 s40, s40, 14336
    buffer_load_dwordx4 v[116:119], v145, s[8:11], s40 offen sc1
    s_add_u32 s40, s40, 14336
    buffer_load_dwordx4 v[120:123], v145, s[8:11], s40 offen sc1
    s_add_u32 s40, s40, 14336
    buffer_load_dwordx4 v[124:127], v145, s[8:11], s40 offen sc1
    s_add_u32 s40, s40, 14336
    buffer_load_dwordx4 v[128:131], v145, s[8:11], s40 offen sc1
    s_add_u32 s40, s40, 14336
    buffer_load_dwordx4 v[132:135], v145, s[8:11], s40 offen sc1
    s_add_u32 s40, s40, 14336
    buffer_load_dwordx4 v[136:139], v145, s[8:11], s40 offen sc1
    s_add_u32 s40, s40, 14336
    buffer_load_dwordx4 v[140:143], v145, s[8:11], s40 offen sc1
    v_lshrrev_b32 v147, 2, v146
    v_lshlrev_b32 v147, 8, v147
    v_lshl_add_u32 v147, v144, 7, v147
    v_and_b32 v148, 3, v146
    v_lshl_add_u32 v147, v148, 5, v147
    v_add_u32 v147, 161280, v147
    s_waitcnt vmcnt(0)
    v_add_f32 v112, v112, v116
    v_add_f32 v113, v113, v117
    v_add_f32 v114, v114, v118
    v_add_f32 v115, v115, v119
    v_add_f32 v112, v112, v120
    v_add_f32 v113, v113, v121
    v_add_f32 v114, v114, v122
    v_add_f32 v115, v115, v123
    v_add_f32 v112, v112, v124
    v_add_f32 v113, v113, v125
    v_add_f32 v114, v114, v126
    v_add_f32 v115, v115, v127
    v_add_f32 v112, v112, v128
    v_add_f32 v113, v113, v129
    v_add_f32 v114, v114, v130
    v_add_f32 v115, v115, v131
    v_add_f32 v112, v112, v132
    v_add_f32 v113, v113, v133
    v_add_f32 v114, v114, v134
    v_add_f32 v115, v115, v135
    v_add_f32 v112, v112, v136
    v_add_f32 v113, v113, v137
    v_add_f32 v114, v114, v138
    v_add_f32 v115, v115, v139
    v_add_f32 v112, v112, v140
    v_add_f32 v113, v113, v141
    v_add_f32 v114, v114, v142
    v_add_f32 v115, v115, v143
    v_cvt_pk_bf16_f32 v149, v112, v112
    v_and_b32 v121, 0xffff, v149
    v_lshlrev_b32 v149, 16, v149
    v_sub_f32 v149, v112, v149
    v_cvt_pk_bf16_f32 v120, v112, v149
    v_cvt_pk_bf16_f32 v149, v113, v113
    v_and_b32 v123, 0xffff, v149
    v_lshlrev_b32 v149, 16, v149
    v_sub_f32 v149, v113, v149
    v_cvt_pk_bf16_f32 v122, v113, v149
    v_cvt_pk_bf16_f32 v149, v114, v114
    v_and_b32 v125, 0xffff, v149
    v_lshlrev_b32 v149, 16, v149
    v_sub_f32 v149, v114, v149
    v_cvt_pk_bf16_f32 v124, v114, v149
    v_cvt_pk_bf16_f32 v149, v115, v115
    v_and_b32 v127, 0xffff, v149
    v_lshlrev_b32 v149, 16, v149
    v_sub_f32 v149, v115, v149
    v_cvt_pk_bf16_f32 v126, v115, v149
    ds_write_b128 v147, v[120:123]
    ds_write_b128 v147, v[124:127] offset:16
    s_waitcnt lgkmcnt(0)
L229:
    s_add_u32 s40, s33, 294912
    buffer_load_dwordx4 v[72:75], v23, s[52:55], s40 offen
    s_waitcnt vmcnt(6)
    s_add_u32 s40, s33, 409600
    buffer_load_dwordx4 v[76:79], v23, s[52:55], s40 offen
    s_waitcnt vmcnt(6)
    s_add_u32 s40, s33, 524288
    buffer_load_dwordx4 v[80:83], v23, s[52:55], s40 offen
    s_waitcnt vmcnt(6)
    s_add_u32 s40, s33, 638976
    buffer_load_dwordx4 v[84:87], v23, s[52:55], s40 offen
    s_waitcnt vmcnt(6)
    s_add_u32 s40, s33, 753664
    buffer_load_dwordx4 v[88:91], v23, s[52:55], s40 offen
    s_waitcnt vmcnt(6)
    s_add_u32 s40, s33, 868352
    buffer_load_dwordx4 v[92:95], v23, s[52:55], s40 offen
    s_waitcnt vmcnt(6)
    s_add_u32 s40, s33, 81920
    buffer_load_dwordx4 v[96:99], v23, s[52:55], s40 offen
    s_waitcnt vmcnt(6)
    s_add_u32 s40, s33, 196608
    buffer_load_dwordx4 v[100:103], v23, s[52:55], s40 offen
    s_waitcnt vmcnt(6)
    s_add_u32 s40, s33, 311296
    buffer_load_dwordx4 v[104:107], v23, s[52:55], s40 offen
    s_waitcnt vmcnt(6)
    s_add_u32 s40, s33, 425984
    buffer_load_dwordx4 v[108:111], v23, s[52:55], s40 offen
    s_waitcnt vmcnt(6)
    s_add_u32 s40, s33, 540672
    buffer_load_dwordx4 v[112:115], v23, s[52:55], s40 offen
    s_waitcnt vmcnt(6)
    s_add_u32 s40, s33, 655360
    buffer_load_dwordx4 v[116:119], v23, s[52:55], s40 offen
    s_waitcnt vmcnt(6)
    s_add_u32 s40, s33, 770048
    buffer_load_dwordx4 v[120:123], v23, s[52:55], s40 offen
    s_waitcnt vmcnt(6)
    s_add_u32 s40, s33, 884736
    buffer_load_dwordx4 v[124:127], v23, s[52:55], s40 offen
    s_waitcnt vmcnt(6)
    s_add_u32 s40, s33, 98304
    buffer_load_dwordx4 v[128:131], v23, s[52:55], s40 offen
    s_waitcnt vmcnt(6)
    s_add_u32 s40, s33, 212992
    buffer_load_dwordx4 v[132:135], v23, s[52:55], s40 offen
    s_waitcnt vmcnt(6)
    s_add_u32 s40, s33, 327680
    buffer_load_dwordx4 v[136:139], v23, s[52:55], s40 offen
    s_waitcnt vmcnt(6)
    s_add_u32 s40, s33, 442368
    buffer_load_dwordx4 v[140:143], v23, s[52:55], s40 offen
    s_waitcnt vmcnt(6)
    s_add_u32 s40, s33, 557056
    buffer_load_dwordx4 v[144:147], v23, s[52:55], s40 offen
    s_waitcnt vmcnt(6)
    s_add_u32 s40, s33, 671744
    buffer_load_dwordx4 v[148:151], v23, s[52:55], s40 offen
    s_waitcnt vmcnt(6)
    s_add_u32 s40, s33, 786432
    buffer_load_dwordx4 v[152:155], v23, s[52:55], s40 offen
    s_waitcnt vmcnt(6)
    s_add_u32 s40, s33, 901120
    buffer_load_dwordx4 v[156:159], v23, s[52:55], s40 offen
    s_waitcnt vmcnt(6)
    ds_read_b32 v1, v25 offset:16
    s_waitcnt lgkmcnt(0)
    s_movk_i32 s39, 8
    v_cmp_gt_u32 vcc, s39, v1
    s_cbranch_vccz L231
L232:
    s_sleep 1
    s_add_u32 s38, s38, 1
    s_cmp_gt_u32 s38, 6400000
    s_cbranch_scc1 L231
    ds_read_b32 v1, v25 offset:16
    s_waitcnt lgkmcnt(0)
    v_cmp_gt_u32 vcc, s39, v1
    s_cbranch_vccnz L232
L231:
    s_add_u32 s40, s29, 65536
    s_add_u32 m0, s25, 32768
    s_nop 0
    buffer_load_dwordx4 v3, s[8:11], s40 offen sc1 lds
    s_waitcnt vmcnt(6)
    s_add_u32 s40, s29, 69632
    s_add_u32 m0, s25, 36864
    s_nop 0
    buffer_load_dwordx4 v3, s[8:11], s40 offen sc1 lds
    s_waitcnt vmcnt(6)
    s_add_u32 s40, s29, 73728
    s_add_u32 m0, s25, 40960
    s_nop 0
    buffer_load_dwordx4 v3, s[8:11], s40 offen sc1 lds
    s_waitcnt vmcnt(6)
    s_add_u32 s40, s29, 77824
    s_add_u32 m0, s25, 45056
    s_nop 0
    buffer_load_dwordx4 v3, s[8:11], s40 offen sc1 lds
    s_waitcnt vmcnt(6)
    s_add_u32 s40, s29, 81920
    s_add_u32 m0, s25, 49152
    s_nop 0
    buffer_load_dwordx4 v3, s[8:11], s40 offen sc1 lds
    s_waitcnt vmcnt(6)
    s_add_u32 s40, s29, 86016
    s_add_u32 m0, s25, 53248
    s_nop 0
    buffer_load_dwordx4 v3, s[8:11], s40 offen sc1 lds
    s_waitcnt vmcnt(6)
    s_add_u32 s40, s29, 90112
    s_add_u32 m0, s25, 57344
    s_nop 0
    buffer_load_dwordx4 v3, s[8:11], s40 offen sc1 lds
    s_waitcnt vmcnt(6)
    s_add_u32 s40, s29, 94208
    s_add_u32 m0, s25, 61440
    s_nop 0
    buffer_load_dwordx4 v3, s[8:11], s40 offen sc1 lds
    s_waitcnt vmcnt(6)
    ds_read_b32 v1, v25 offset:16
    s_waitcnt lgkmcnt(0)
    s_movk_i32 s39, 10
    v_cmp_gt_u32 vcc, s39, v1
    s_cbranch_vccz L234
    s_waitcnt vmcnt(0)
    v_mov_b32 v13, 14
    ds_max_u32 v0, v13
L235:
    s_sleep 1
    s_add_u32 s38, s38, 1
    s_cmp_gt_u32 s38, 6400000
    s_cbranch_scc1 L234
    ds_read_b32 v1, v25 offset:16
    s_waitcnt lgkmcnt(0)
    v_cmp_gt_u32 vcc, s39, v1
    s_cbranch_vccnz L235
L234:
    s_waitcnt vmcnt(0)
    v_mov_b32 v13, 14
    ds_max_u32 v0, v13
    ds_write_b128 v22, v[32:35] offset:0
    ds_write_b128 v22, v[36:39] offset:4096
    ds_write_b128 v22, v[40:43] offset:8192
    ds_write_b128 v22, v[44:47] offset:12288
    ds_write_b128 v22, v[48:51] offset:16384
    ds_write_b128 v22, v[52:55] offset:20480
    ds_write_b128 v22, v[56:59] offset:24576
    ds_read_b32 v1, v25 offset:16
    s_waitcnt lgkmcnt(0)
    s_movk_i32 s39, 11
    v_cmp_gt_u32 vcc, s39, v1
    s_cbranch_vccz L237
L238:
    s_sleep 1
    s_add_u32 s38, s38, 1
    s_cmp_gt_u32 s38, 6400000
    s_cbranch_scc1 L237
    ds_read_b32 v1, v25 offset:16
    s_waitcnt lgkmcnt(0)
    v_cmp_gt_u32 vcc, s39, v1
    s_cbranch_vccnz L238
L237:
    s_add_u32 s40, s29, 98304
    s_add_u32 m0, s25, 65536
    s_nop 0
    buffer_load_dwordx4 v3, s[8:11], s40 offen sc1 lds
    s_add_u32 s40, s29, 102400
    s_add_u32 m0, s25, 69632
    s_nop 0
    buffer_load_dwordx4 v3, s[8:11], s40 offen sc1 lds
    s_add_u32 s40, s29, 106496
    s_add_u32 m0, s25, 73728
    s_nop 0
    buffer_load_dwordx4 v3, s[8:11], s40 offen sc1 lds
    s_add_u32 s40, s29, 110592
    s_add_u32 m0, s25, 77824
    s_nop 0
    buffer_load_dwordx4 v3, s[8:11], s40 offen sc1 lds
    s_add_u32 s40, s29, 114688
    s_add_u32 m0, s25, 81920
    s_nop 0
    buffer_load_dwordx4 v3, s[8:11], s40 offen sc1 lds
    s_add_u32 s40, s29, 118784
    s_add_u32 m0, s25, 86016
    s_nop 0
    buffer_load_dwordx4 v3, s[8:11], s40 offen sc1 lds
    s_add_u32 s40, s29, 122880
    s_add_u32 m0, s25, 90112
    s_nop 0
    buffer_load_dwordx4 v3, s[8:11], s40 offen sc1 lds
    s_waitcnt vmcnt(6)
    s_add_u32 s40, s29, 126976
    s_add_u32 m0, s25, 94208
    s_nop 0
    buffer_load_dwordx4 v3, s[8:11], s40 offen sc1 lds
    s_waitcnt vmcnt(6)
    ds_read_b32 v1, v25 offset:16
    s_waitcnt lgkmcnt(0)
    s_movk_i32 s39, 12
    v_cmp_gt_u32 vcc, s39, v1
    s_cbranch_vccz L240
    s_waitcnt vmcnt(0)
    v_mov_b32 v13, 15
    ds_max_u32 v0, v13
L241:
    s_sleep 1
    s_add_u32 s38, s38, 1
    s_cmp_gt_u32 s38, 6400000
    s_cbranch_scc1 L240
    ds_read_b32 v1, v25 offset:16
    s_waitcnt lgkmcnt(0)
    v_cmp_gt_u32 vcc, s39, v1
    s_cbranch_vccnz L241
L240:
    s_add_u32 s40, s29, 131072
    s_add_u32 m0, s25, 32768
    s_nop 0
    buffer_load_dwordx4 v3, s[8:11], s40 offen sc1 lds
    s_waitcnt vmcnt(6)
    s_add_u32 s40, s29, 135168
    s_add_u32 m0, s25, 36864
    s_nop 0
    buffer_load_dwordx4 v3, s[8:11], s40 offen sc1 lds
    s_waitcnt vmcnt(6)
    ds_read_b32 v1, v25 offset:16
    s_waitcnt lgkmcnt(0)
    s_movk_i32 s39, 13
    v_cmp_gt_u32 vcc, s39, v1
    s_cbranch_vccz L243
    s_waitcnt vmcnt(2)
    v_mov_b32 v13, 15
    ds_max_u32 v0, v13
L244:
    s_sleep 1
    s_add_u32 s38, s38, 1
    s_cmp_gt_u32 s38, 6400000
    s_cbranch_scc1 L243
    ds_read_b32 v1, v25 offset:16
    s_waitcnt lgkmcnt(0)
    v_cmp_gt_u32 vcc, s39, v1
    s_cbranch_vccnz L244
L243:
    s_add_u32 s40, s29, 139264
    s_add_u32 m0, s25, 40960
    s_nop 0
    buffer_load_dwordx4 v3, s[8:11], s40 offen sc1 lds
    s_waitcnt vmcnt(6)
    s_add_u32 s40, s29, 143360
    s_add_u32 m0, s25, 45056
    s_nop 0
    buffer_load_dwordx4 v3, s[8:11], s40 offen sc1 lds
    s_waitcnt vmcnt(6)
    ds_read_b32 v1, v25 offset:16
    s_waitcnt lgkmcnt(0)
    s_movk_i32 s39, 14
    v_cmp_gt_u32 vcc, s39, v1
    s_cbranch_vccz L246
    s_waitcnt vmcnt(4)
    v_mov_b32 v13, 15
    ds_max_u32 v0, v13
L247:
    s_sleep 1
    s_add_u32 s38, s38, 1
    s_cmp_gt_u32 s38, 6400000
    s_cbranch_scc1 L246
    ds_read_b32 v1, v25 offset:16
    s_waitcnt lgkmcnt(0)
    v_cmp_gt_u32 vcc, s39, v1
    s_cbranch_vccnz L247
L246:
    s_add_u32 s40, s29, 147456
    s_add_u32 m0, s25, 49152
    s_nop 0
    buffer_load_dwordx4 v3, s[8:11], s40 offen sc1 lds
    s_waitcnt vmcnt(6)
    s_add_u32 s40, s29, 151552
    s_add_u32 m0, s25, 53248
    s_nop 0
    buffer_load_dwordx4 v3, s[8:11], s40 offen sc1 lds
    s_waitcnt vmcnt(6)
    v_mov_b32 v13, 15
    ds_max_u32 v0, v13
    ds_read_b32 v1, v25 offset:16
    s_waitcnt lgkmcnt(0)
    s_movk_i32 s39, 15
    v_cmp_gt_u32 vcc, s39, v1
    s_cbranch_vccz L249
L250:
    s_sleep 1
    s_add_u32 s38, s38, 1
    s_cmp_gt_u32 s38, 6400000
    s_cbranch_scc1 L249
    ds_read_b32 v1, v25 offset:16
    s_waitcnt lgkmcnt(0)
    v_cmp_gt_u32 vcc, s39, v1
    s_cbranch_vccnz L250
L249:
    s_add_u32 s40, s29, 155648
    s_add_u32 m0, s25, 57344
    s_nop 0
    buffer_load_dwordx4 v3, s[8:11], s40 offen sc1 lds
    s_waitcnt vmcnt(6)
    s_add_u32 s40, s29, 159744
    s_add_u32 m0, s25, 61440
    s_nop 0
    buffer_load_dwordx4 v3, s[8:11], s40 offen sc1 lds
    s_waitcnt vmcnt(6)
    s_add_u32 s40, s29, 163840
    s_add_u32 m0, s25, 98304
    s_nop 0
    buffer_load_dwordx4 v3, s[8:11], s40 offen sc1 lds
    s_waitcnt vmcnt(6)
    s_add_u32 s40, s29, 167936
    s_add_u32 m0, s25, 102400
    s_nop 0
    buffer_load_dwordx4 v3, s[8:11], s40 offen sc1 lds
    s_waitcnt vmcnt(6)
    s_add_u32 s40, s29, 172032
    s_add_u32 m0, s25, 106496
    s_nop 0
    buffer_load_dwordx4 v3, s[8:11], s40 offen sc1 lds
    s_waitcnt vmcnt(6)
    s_add_u32 s40, s29, 176128
    s_add_u32 m0, s25, 110592
    s_nop 0
    buffer_load_dwordx4 v3, s[8:11], s40 offen sc1 lds
    s_waitcnt vmcnt(6)
    s_add_u32 s40, s29, 180224
    s_add_u32 m0, s25, 114688
    s_nop 0
    buffer_load_dwordx4 v3, s[8:11], s40 offen sc1 lds
    s_waitcnt vmcnt(6)
    s_add_u32 s40, s29, 184320
    s_add_u32 m0, s25, 118784
    s_nop 0
    buffer_load_dwordx4 v3, s[8:11], s40 offen sc1 lds
    s_waitcnt vmcnt(6)
    v_mov_b32 v13, 16
    ds_max_u32 v0, v13
    s_add_u32 s40, s29, 188416
    s_add_u32 m0, s25, 122880
    s_nop 0
    buffer_load_dwordx4 v3, s[8:11], s40 offen sc1 lds
    s_waitcnt vmcnt(6)
    s_add_u32 s40, s29, 192512
    s_add_u32 m0, s25, 126976
    s_nop 0
    buffer_load_dwordx4 v3, s[8:11], s40 offen sc1 lds
    s_waitcnt vmcnt(6)
    s_add_u32 s40, s29, 196608
    s_add_u32 m0, s25, 0
    s_nop 0
    buffer_load_dwordx4 v3, s[8:11], s40 offen sc1 lds
    s_waitcnt vmcnt(6)
    s_add_u32 s40, s29, 200704
    s_add_u32 m0, s25, 4096
    s_nop 0
    buffer_load_dwordx4 v3, s[8:11], s40 offen sc1 lds
    s_waitcnt vmcnt(6)
    s_add_u32 s40, s29, 204800
    s_add_u32 m0, s25, 8192
    s_nop 0
    buffer_load_dwordx4 v3, s[8:11], s40 offen sc1 lds
    s_waitcnt vmcnt(6)
    s_add_u32 s40, s29, 208896
    s_add_u32 m0, s25, 12288
    s_nop 0
    buffer_load_dwordx4 v3, s[8:11], s40 offen sc1 lds
    s_waitcnt vmcnt(6)
    s_add_u32 s40, s29, 212992
    s_add_u32 m0, s25, 16384
    s_nop 0
    buffer_load_dwordx4 v3, s[8:11], s40 offen sc1 lds
    s_waitcnt vmcnt(6)
    s_add_u32 s40, s29, 217088
    s_add_u32 m0, s25, 20480
    s_nop 0
    buffer_load_dwordx4 v3, s[8:11], s40 offen sc1 lds
    s_waitcnt vmcnt(6)
    v_mov_b32 v13, 17
    ds_max_u32 v0, v13
    s_add_u32 s40, s29, 221184
    s_add_u32 m0, s25, 24576
    s_nop 0
    buffer_load_dwordx4 v3, s[8:11], s40 offen sc1 lds
    s_waitcnt vmcnt(6)
    s_add_u32 s40, s29, 225280
    s_add_u32 m0, s25, 28672
    s_nop 0
    buffer_load_dwordx4 v3, s[8:11], s40 offen sc1 lds
    s_waitcnt vmcnt(6)
    ds_read_b32 v1, v25 offset:16
    s_waitcnt lgkmcnt(0)
    s_movk_i32 s39, 16
    v_cmp_gt_u32 vcc, s39, v1
    s_cbranch_vccz L252
    s_waitcnt vmcnt(0)
    v_mov_b32 v13, 18
    ds_max_u32 v0, v13
L253:
    s_sleep 1
    s_add_u32 s38, s38, 1
    s_cmp_gt_u32 s38, 6400000
    s_cbranch_scc1 L252
    ds_read_b32 v1, v25 offset:16
    s_waitcnt lgkmcnt(0)
    v_cmp_gt_u32 vcc, s39, v1
    s_cbranch_vccnz L253
L252:
    s_add_u32 s40, s33, 802816
    s_add_u32 m0, s25, 65536
    s_nop 0
    buffer_load_dwordx4 v23, s[52:55], s40 offen lds
    s_waitcnt vmcnt(6)
    s_add_u32 s40, s33, 16384
    s_add_u32 m0, s25, 69632
    s_nop 0
    buffer_load_dwordx4 v23, s[52:55], s40 offen lds
    s_waitcnt vmcnt(6)
    s_add_u32 s40, s33, 131072
    s_add_u32 m0, s25, 73728
    s_nop 0
    buffer_load_dwordx4 v23, s[52:55], s40 offen lds
    s_waitcnt vmcnt(6)
    s_add_u32 s40, s33, 245760
    s_add_u32 m0, s25, 77824
    s_nop 0
    buffer_load_dwordx4 v23, s[52:55], s40 offen lds
    s_waitcnt vmcnt(6)
    s_add_u32 s40, s33, 360448
    s_add_u32 m0, s25, 81920
    s_nop 0
    buffer_load_dwordx4 v23, s[52:55], s40 offen lds
    s_waitcnt vmcnt(6)
    s_add_u32 s40, s33, 475136
    s_add_u32 m0, s25, 86016
    s_nop 0
    buffer_load_dwordx4 v23, s[52:55], s40 offen lds
    s_waitcnt vmcnt(6)
    v_mov_b32 v13, 18
    ds_max_u32 v0, v13
    s_add_u32 s40, s33, 589824
    s_add_u32 m0, s25, 90112
    s_nop 0
    buffer_load_dwordx4 v23, s[52:55], s40 offen lds
    s_waitcnt vmcnt(6)
    s_add_u32 s40, s33, 704512
    s_add_u32 m0, s25, 94208
    s_nop 0
    buffer_load_dwordx4 v23, s[52:55], s40 offen lds
    s_waitcnt vmcnt(6)
    ds_read_b32 v1, v25 offset:16
    s_waitcnt lgkmcnt(0)
    s_movk_i32 s39, 17
    v_cmp_gt_u32 vcc, s39, v1
    s_cbranch_vccz L255
L256:
    s_sleep 1
    s_add_u32 s38, s38, 1
    s_cmp_gt_u32 s38, 6400000
    s_cbranch_scc1 L255
    ds_read_b32 v1, v25 offset:16
    s_waitcnt lgkmcnt(0)
    v_cmp_gt_u32 vcc, s39, v1
    s_cbranch_vccnz L256
L255:
    s_add_u32 s40, s33, 819200
    s_add_u32 m0, s25, 32768
    s_nop 0
    buffer_load_dwordx4 v23, s[52:55], s40 offen lds
    s_waitcnt vmcnt(6)
    s_add_u32 s40, s33, 32768
    s_add_u32 m0, s25, 36864
    s_nop 0
    buffer_load_dwordx4 v23, s[52:55], s40 offen lds
    s_waitcnt vmcnt(6)
    s_add_u32 s40, s33, 147456
    s_add_u32 m0, s25, 40960
    s_nop 0
    buffer_load_dwordx4 v23, s[52:55], s40 offen lds
    s_waitcnt vmcnt(6)
    s_add_u32 s40, s33, 262144
    s_add_u32 m0, s25, 45056
    s_nop 0
    buffer_load_dwordx4 v23, s[52:55], s40 offen lds
    s_waitcnt vmcnt(6)
    s_add_u32 s40, s33, 376832
    s_add_u32 m0, s25, 49152
    s_nop 0
    buffer_load_dwordx4 v23, s[52:55], s40 offen lds
    s_waitcnt vmcnt(6)
    s_add_u32 s40, s33, 491520
    s_add_u32 m0, s25, 53248
    s_nop 0
    buffer_load_dwordx4 v23, s[52:55], s40 offen lds
    s_waitcnt vmcnt(6)
    s_add_u32 s40, s33, 606208
    s_add_u32 m0, s25, 57344
    s_nop 0
    buffer_load_dwordx4 v23, s[52:55], s40 offen lds
    s_waitcnt vmcnt(6)
    s_add_u32 s40, s33, 720896
    s_add_u32 m0, s25, 61440
    s_nop 0
    buffer_load_dwordx4 v23, s[52:55], s40 offen lds
    s_waitcnt vmcnt(6)
    ds_read_b32 v1, v25 offset:16
    s_waitcnt lgkmcnt(0)
    s_movk_i32 s39, 18
    v_cmp_gt_u32 vcc, s39, v1
    s_cbranch_vccz L258
    s_waitcnt vmcnt(0)
    v_mov_b32 v13, 19
    ds_max_u32 v0, v13
L259:
    s_sleep 1
    s_add_u32 s38, s38, 1
    s_cmp_gt_u32 s38, 6400000
    s_cbranch_scc1 L258
    ds_read_b32 v1, v25 offset:16
    s_waitcnt lgkmcnt(0)
    v_cmp_gt_u32 vcc, s39, v1
    s_cbranch_vccnz L259
L258:
    s_add_u32 s40, s33, 835584
    s_add_u32 m0, s25, 98304
    s_nop 0
    buffer_load_dwordx4 v23, s[52:55], s40 offen lds
    s_waitcnt vmcnt(6)
    s_add_u32 s40, s33, 49152
    s_add_u32 m0, s25, 102400
    s_nop 0
    buffer_load_dwordx4 v23, s[52:55], s40 offen lds
    s_waitcnt vmcnt(6)
    s_add_u32 s40, s33, 163840
    s_add_u32 m0, s25, 106496
    s_nop 0
    buffer_load_dwordx4 v23, s[52:55], s40 offen lds
    s_waitcnt vmcnt(6)
    s_add_u32 s40, s33, 278528
    s_add_u32 m0, s25, 110592
    s_nop 0
    buffer_load_dwordx4 v23, s[52:55], s40 offen lds
    s_waitcnt vmcnt(6)
    s_add_u32 s40, s33, 393216
    s_add_u32 m0, s25, 114688
    s_nop 0
    buffer_load_dwordx4 v23, s[52:55], s40 offen lds
    s_waitcnt vmcnt(6)
    s_add_u32 s40, s33, 507904
    s_add_u32 m0, s25, 118784
    s_nop 0
    buffer_load_dwordx4 v23, s[52:55], s40 offen lds
    s_waitcnt vmcnt(6)
    v_mov_b32 v13, 19
    ds_max_u32 v0, v13
    s_add_u32 s40, s33, 622592
    s_add_u32 m0, s25, 122880
    s_nop 0
    buffer_load_dwordx4 v23, s[52:55], s40 offen lds
    s_waitcnt vmcnt(6)
    s_add_u32 s40, s33, 737280
    s_add_u32 m0, s25, 126976
    s_nop 0
    buffer_load_dwordx4 v23, s[52:55], s40 offen lds
    s_waitcnt vmcnt(6)
    ds_read_b32 v1, v25 offset:16
    s_waitcnt lgkmcnt(0)
    s_movk_i32 s39, 19
    v_cmp_gt_u32 vcc, s39, v1
    s_cbranch_vccz L261
    s_waitcnt vmcnt(0)
    v_mov_b32 v13, 20
    ds_max_u32 v0, v13
L262:
    s_sleep 1
    s_add_u32 s38, s38, 1
    s_cmp_gt_u32 s38, 6400000
    s_cbranch_scc1 L261
    ds_read_b32 v1, v25 offset:16
    s_waitcnt lgkmcnt(0)
    v_cmp_gt_u32 vcc, s39, v1
    s_cbranch_vccnz L262
L261:
    ds_write_b128 v20, v[60:63] offset:0
    ds_write_b128 v20, v[64:67] offset:4096
    ds_write_b128 v20, v[68:71] offset:8192
    ds_write_b128 v20, v[72:75] offset:12288
    ds_write_b128 v20, v[76:79] offset:16384
    ds_write_b128 v20, v[80:83] offset:20480
    ds_write_b128 v20, v[84:87] offset:24576
    ds_write_b128 v20, v[88:91] offset:28672
    ds_read_b32 v1, v25 offset:16
    s_waitcnt lgkmcnt(0)
    s_movk_i32 s39, 20
    v_cmp_gt_u32 vcc, s39, v1
    s_cbranch_vccz L264
    s_waitcnt vmcnt(0)
    v_mov_b32 v13, 20
    ds_max_u32 v0, v13
    s_waitcnt vmcnt(0)
    v_mov_b32 v13, 21
    ds_max_u32 v0, v13
L265:
    s_sleep 1
    s_add_u32 s38, s38, 1
    s_cmp_gt_u32 s38, 6400000
    s_cbranch_scc1 L264
    ds_read_b32 v1, v25 offset:16
    s_waitcnt lgkmcnt(0)
    v_cmp_gt_u32 vcc, s39, v1
    s_cbranch_vccnz L265
L264:
    ds_write_b128 v22, v[92:95] offset:0
    ds_write_b128 v22, v[96:99] offset:4096
    ds_write_b128 v22, v[100:103] offset:8192
    ds_write_b128 v22, v[104:107] offset:12288
    ds_write_b128 v22, v[108:111] offset:16384
    ds_write_b128 v22, v[112:115] offset:20480
    ds_write_b128 v22, v[116:119] offset:24576
    s_waitcnt vmcnt(0)
    v_mov_b32 v13, 22
    ds_max_u32 v0, v13
    ds_read_b32 v1, v25 offset:16
    s_waitcnt lgkmcnt(0)
    s_movk_i32 s39, 21
    v_cmp_gt_u32 vcc, s39, v1
    s_cbranch_vccz L267
L268:
    s_sleep 1
    s_add_u32 s38, s38, 1
    s_cmp_gt_u32 s38, 6400000
    s_cbranch_scc1 L267
    ds_read_b32 v1, v25 offset:16
    s_waitcnt lgkmcnt(0)
    v_cmp_gt_u32 vcc, s39, v1
    s_cbranch_vccnz L268
L267:
    ds_write_b128 v21, v[192:195] offset:0
    ds_write_b128 v21, v[196:199] offset:4096
    ds_write_b128 v21, v[200:203] offset:8192
    ds_write_b128 v21, v[204:207] offset:12288
    ds_write_b128 v21, v[208:211] offset:16384
    ds_write_b128 v21, v[212:215] offset:20480
    ds_write_b128 v21, v[216:219] offset:24576
    ds_write_b128 v21, v[220:223] offset:28672
    ds_read_b32 v1, v25 offset:16
    s_waitcnt lgkmcnt(0)
    s_movk_i32 s39, 22
    v_cmp_gt_u32 vcc, s39, v1
    s_cbranch_vccz L270
L271:
    s_sleep 1
    s_add_u32 s38, s38, 1
    s_cmp_gt_u32 s38, 6400000
    s_cbranch_scc1 L270
    ds_read_b32 v1, v25 offset:16
    s_waitcnt lgkmcnt(0)
    v_cmp_gt_u32 vcc, s39, v1
    s_cbranch_vccnz L271
L270:
    ds_write_b128 v20, v[160:163] offset:32768
    ds_write_b128 v20, v[164:167] offset:36864
    ds_write_b128 v20, v[168:171] offset:40960
    ds_write_b128 v20, v[172:175] offset:45056
    ds_write_b128 v20, v[176:179] offset:49152
    ds_write_b128 v20, v[180:183] offset:53248
    ds_write_b128 v20, v[184:187] offset:57344
    ds_write_b128 v20, v[188:191] offset:61440
    ds_read_b32 v1, v25 offset:16
    s_waitcnt lgkmcnt(0)
    s_movk_i32 s39, 23
    v_cmp_gt_u32 vcc, s39, v1
    s_cbranch_vccz L273
L274:
    s_sleep 1
    s_add_u32 s38, s38, 1
    s_cmp_gt_u32 s38, 6400000
    s_cbranch_scc1 L273
    ds_read_b32 v1, v25 offset:16
    s_waitcnt lgkmcnt(0)
    v_cmp_gt_u32 vcc, s39, v1
    s_cbranch_vccnz L274
L273:
    ds_write_b128 v21, v[120:123] offset:32768
    ds_write_b128 v21, v[124:127] offset:36864
    ds_write_b128 v21, v[128:131] offset:40960
    ds_write_b128 v21, v[132:135] offset:45056
    ds_write_b128 v21, v[136:139] offset:49152
    ds_write_b128 v21, v[140:143] offset:53248
    ds_write_b128 v21, v[144:147] offset:57344
    ds_write_b128 v21, v[148:151] offset:61440
    ds_write_b128 v20, v[152:155] offset:0
    ds_write_b128 v20, v[156:159] offset:4096
    v_mov_b32 v13, 23
    ds_max_u32 v0, v13
    v_mov_b32 v13, 24
    ds_max_u32 v0, v13
    ds_read_b32 v1, v25 offset:16
    s_waitcnt lgkmcnt(0)
    s_movk_i32 s39, 24
    v_cmp_gt_u32 vcc, s39, v1
    s_cbranch_vccz L276
L277:
    s_sleep 1
    s_add_u32 s38, s38, 1
    s_cmp_gt_u32 s38, 6400000
    s_cbranch_scc1 L276
    ds_read_b32 v1, v25 offset:16
    s_waitcnt lgkmcnt(0)
    v_cmp_gt_u32 vcc, s39, v1
    s_cbranch_vccnz L277
L276:
    ds_write_b128 v20, v[232:235] offset:8192
    ds_write_b128 v20, v[236:239] offset:12288
    ds_write_b128 v20, v[240:243] offset:16384
    ds_write_b128 v20, v[244:247] offset:20480
    ds_write_b128 v20, v[248:251] offset:24576
    ds_write_b128 v20, v[252:255] offset:28672
    ds_read_b32 v1, v25 offset:16
    s_waitcnt lgkmcnt(0)
    s_movk_i32 s39, 26
    v_cmp_gt_u32 vcc, s39, v1
    s_cbranch_vccz L279
L280:
    s_sleep 1
    s_add_u32 s38, s38, 1
    s_cmp_gt_u32 s38, 6400000
    s_cbranch_scc1 L279
    ds_read_b32 v1, v25 offset:16
    s_waitcnt lgkmcnt(0)
    v_cmp_gt_u32 vcc, s39, v1
    s_cbranch_vccnz L280
L279:
    ds_write_b128 v20, v[224:227] offset:0
    ds_write_b128 v20, v[228:231] offset:4096
    s_mov_b32 s23, 16
    ds_read_b32 v1, v25 offset:16
    s_waitcnt lgkmcnt(0)
    s_movk_i32 s39, 66
    v_cmp_gt_u32 vcc, s39, v1
    s_cbranch_vccz L282
L283:
    s_sleep 1
    s_add_u32 s38, s38, 1
    s_cmp_gt_u32 s38, 6400000
    s_cbranch_scc1 L282
    ds_read_b32 v1, v25 offset:16
    s_waitcnt lgkmcnt(0)
    v_cmp_gt_u32 vcc, s39, v1
    s_cbranch_vccnz L283
L282:
    v_mov_b32 v13, 71
    ds_max_u32 v0, v13
    s_add_u32 s92, s92, 1
    v_lshlrev_b32 v248, 3, v2
    v_add_u32 v248, 4096, v248
    v_add_u32 v249, 110592, v20
    ds_read_b32 v1, v25 offset:16
    s_waitcnt lgkmcnt(0)
    s_movk_i32 s39, 68
    v_cmp_gt_u32 vcc, s39, v1
    s_cbranch_vccz L285
L286:
    s_sleep 1
    s_add_u32 s38, s38, 1
    s_cmp_gt_u32 s38, 6400000
    s_cbranch_scc1 L285
    ds_read_b32 v1, v25 offset:16
    s_waitcnt lgkmcnt(0)
    v_cmp_gt_u32 vcc, s39, v1
    s_cbranch_vccnz L286
L285:
    s_setprio 3
    s_mov_b32 s41, 0
    buffer_load_dwordx4 v[176:179], v3, s[8:11], s94 offen offset:0 sc1
    buffer_load_dwordx4 v[180:183], v3, s[8:11], s94 offen offset:1024 sc1
    buffer_load_dwordx4 v[184:187], v3, s[8:11], s94 offen offset:2048 sc1
    buffer_load_dwordx4 v[188:191], v3, s[8:11], s94 offen offset:3072 sc1
    buffer_load_dwordx2 v[208:209], v248, s[8:11], s94 offen sc1
    buffer_load_dwordx4 v[192:195], v3, s[8:11], s95 offen offset:0 sc1
    buffer_load_dwordx4 v[196:199], v3, s[8:11], s95 offen offset:1024 sc1
    buffer_load_dwordx4 v[200:203], v3, s[8:11], s95 offen offset:2048 sc1
    buffer_load_dwordx4 v[204:207], v3, s[8:11], s95 offen offset:3072 sc1
    buffer_load_dwordx2 v[210:211], v248, s[8:11], s95 offen sc1
L287:
    s_waitcnt vmcnt(5)
    v_bitop3_b32 v208, v208, v176, v177 bitop3:0x96
    v_bitop3_b32 v208, v208, v178, v179 bitop3:0x96
    v_bitop3_b32 v208, v208, v180, v181 bitop3:0x96
    v_bitop3_b32 v208, v208, v182, v183 bitop3:0x96
    v_bitop3_b32 v208, v208, v184, v185 bitop3:0x96
    v_bitop3_b32 v208, v208, v186, v187 bitop3:0x96
    v_bitop3_b32 v208, v208, v188, v189 bitop3:0x96
    v_bitop3_b32 v208, v208, v190, v191 bitop3:0x96
    v_xor_b32 v208, s92, v208
    v_xor_b32 v209, s93, v209
    v_or_b32 v208, v208, v209
    v_and_b32 v208, s64, v208
    s_waitcnt vmcnt(0)
    v_bitop3_b32 v210, v210, v192, v193 bitop3:0x96
    v_bitop3_b32 v210, v210, v194, v195 bitop3:0x96
    v_bitop3_b32 v210, v210, v196, v197 bitop3:0x96
    v_bitop3_b32 v210, v210, v198, v199 bitop3:0x96
    v_bitop3_b32 v210, v210, v200, v201 bitop3:0x96
    v_bitop3_b32 v210, v210, v202, v203 bitop3:0x96
    v_bitop3_b32 v210, v210, v204, v205 bitop3:0x96
    v_bitop3_b32 v210, v210, v206, v207 bitop3:0x96
    v_xor_b32 v210, s92, v210
    v_xor_b32 v211, s93, v211
    v_or_b32 v210, v210, v211
    v_and_b32 v210, s65, v210
    v_or_b32 v208, v208, v210
    v_cmp_ne_u32 vcc, 0, v208
    s_cbranch_vccz L288
    buffer_load_dwordx4 v[176:179], v3, s[8:11], s94 offen offset:0 sc1
    buffer_load_dwordx4 v[180:183], v3, s[8:11], s94 offen offset:1024 sc1
    buffer_load_dwordx4 v[184:187], v3, s[8:11], s94 offen offset:2048 sc1
    buffer_load_dwordx4 v[188:191], v3, s[8:11], s94 offen offset:3072 sc1
    buffer_load_dwordx2 v[208:209], v248, s[8:11], s94 offen sc1
    buffer_load_dwordx4 v[192:195], v3, s[8:11], s95 offen offset:0 sc1
    buffer_load_dwordx4 v[196:199], v3, s[8:11], s95 offen offset:1024 sc1
    buffer_load_dwordx4 v[200:203], v3, s[8:11], s95 offen offset:2048 sc1
    buffer_load_dwordx4 v[204:207], v3, s[8:11], s95 offen offset:3072 sc1
    buffer_load_dwordx2 v[210:211], v248, s[8:11], s95 offen sc1
    s_add_u32 s41, s41, 1
    s_cmp_le_u32 s41, 400000
    s_cbranch_scc1 L287
    s_waitcnt vmcnt(0)
L288:
    ds_write_b128 v249, v[176:179] offset:4096
    ds_write_b128 v249, v[192:195] offset:0
    ds_write_b128 v249, v[184:187] offset:16384
    ds_write_b128 v249, v[200:203] offset:12288
    ds_write_b128 v249, v[180:183] offset:28672
    ds_write_b128 v249, v[196:199] offset:24576
    ds_write_b128 v249, v[188:191] offset:40960
    ds_write_b128 v249, v[204:207] offset:36864
L289:
    v_mov_b32 v13, 72
    ds_max_u32 v0, v13
    v_mov_b32 v26, 2
    s_mov_b64 exec, 1
    buffer_store_dword v26, off, s[8:11], s82 sc1
    s_mov_b64 exec, -1
    s_setprio 0
    ds_read_b32 v1, v25 offset:0
    s_waitcnt lgkmcnt(0)
    s_movk_i32 s39, 72
    v_cmp_gt_u32 vcc, s39, v1
    s_cbranch_vccz L291
L292:
    s_sleep 1
    s_add_u32 s38, s38, 1
    s_cmp_gt_u32 s38, 6400000
    s_cbranch_scc1 L291
    ds_read_b32 v1, v25 offset:0
    s_waitcnt lgkmcnt(0)
    v_cmp_gt_u32 vcc, s39, v1
    s_cbranch_vccnz L292
L291:
    s_cmp_eq_u32 s6, 2
    s_cbranch_scc0 L293
    v_lshlrev_b32 v26, 10, v2
    s_lshr_b32 s41, s2, 3
    s_mul_i32 s41, s41, 16384
    s_add_u32 s41, s41, 384
    s_mov_b32 exec_lo, 0xffff
    s_mov_b32 exec_hi, 0x0
    buffer_load_dword v31, v26, s[48:51], s41 offen
    s_mov_b64 exec, -1
L293:
    s_cmp_lg_u32 s21, 0
    s_cbranch_scc1 L294
    v_lshlrev_b32 v13, 7, v2
    s_add_u32 s43, s63, 8388608
    s_mov_b32 exec_lo, 0xffff
    s_mov_b32 exec_hi, 0x0
    buffer_load_dword v31, v13, s[8:11], s43 offen sc1
    s_add_u32 s43, s60, 6291456
    s_mov_b32 exec_lo, 0xffff
    s_mov_b32 exec_hi, 0x0
    buffer_load_dword v31, v13, s[8:11], s43 offen sc1
    s_add_u32 s43, s61, 5767168
    s_mov_b32 exec_lo, 0xff
    s_mov_b32 exec_hi, 0x0
    buffer_load_dword v31, v13, s[8:11], s43 offen sc1
    s_mov_b64 exec, -1
L294:
    s_add_u32 s40, s32, 0
    s_add_u32 m0, s25, 32768
    s_nop 0
    buffer_load_dwordx4 v23, s[48:51], s40 offen lds
    s_add_u32 s40, s32, 32768
    s_add_u32 m0, s25, 36864
    s_nop 0
    buffer_load_dwordx4 v23, s[48:51], s40 offen lds
    s_add_u32 s40, s32, 65536
    s_add_u32 m0, s25, 40960
    s_nop 0
    buffer_load_dwordx4 v23, s[48:51], s40 offen lds
    s_add_u32 s40, s32, 98304
    s_add_u32 m0, s25, 45056
    s_nop 0
    buffer_load_dwordx4 v23, s[48:51], s40 offen lds
    s_add_u32 s40, s32, 131072
    s_add_u32 m0, s25, 49152
    s_nop 0
    buffer_load_dwordx4 v23, s[48:51], s40 offen lds
    s_add_u32 s40, s32, 163840
    s_add_u32 m0, s25, 53248
    s_nop 0
    buffer_load_dwordx4 v23, s[48:51], s40 offen lds
    s_add_u32 s40, s32, 196608
    s_add_u32 m0, s25, 57344
    s_nop 0
    buffer_load_dwordx4 v23, s[48:51], s40 offen lds
    s_waitcnt vmcnt(6)
    s_add_u32 s40, s32, 229376
    s_add_u32 m0, s25, 61440
    s_nop 0
    buffer_load_dwordx4 v23, s[48:51], s40 offen lds
    s_waitcnt vmcnt(6)
    s_add_u32 s40, s32, 16384
    s_add_u32 m0, s25, 65536
    s_nop 0
    buffer_load_dwordx4 v23, s[48:51], s40 offen lds
    s_waitcnt vmcnt(6)
    s_add_u32 s40, s32, 49152
    s_add_u32 m0, s25, 69632
    s_nop 0
    buffer_load_dwordx4 v23, s[48:51], s40 offen lds
    s_waitcnt vmcnt(6)
    s_add_u32 s40, s32, 81920
    s_add_u32 m0, s25, 73728
    s_nop 0
    buffer_load_dwordx4 v23, s[48:51], s40 offen lds
    s_waitcnt vmcnt(6)
    s_add_u32 s40, s32, 114688
    s_add_u32 m0, s25, 77824
    s_nop 0
    buffer_load_dwordx4 v23, s[48:51], s40 offen lds
    s_waitcnt vmcnt(6)
    s_add_u32 s40, s32, 147456
    s_add_u32 m0, s25, 81920
    s_nop 0
    buffer_load_dwordx4 v23, s[48:51], s40 offen lds
    s_waitcnt vmcnt(6)
    s_add_u32 s40, s32, 180224
    s_add_u32 m0, s25, 86016
    s_nop 0
    buffer_load_dwordx4 v23, s[48:51], s40 offen lds
    s_waitcnt vmcnt(6)
    s_add_u32 s40, s32, 212992
    s_add_u32 m0, s25, 90112
    s_nop 0
    buffer_load_dwordx4 v23, s[48:51], s40 offen lds
    s_waitcnt vmcnt(6)
    s_add_u32 s40, s32, 245760
    s_add_u32 m0, s25, 94208
    s_nop 0
    buffer_load_dwordx4 v23, s[48:51], s40 offen lds
    s_waitcnt vmcnt(6)
    ds_read_b32 v1, v25 offset:16
    s_waitcnt lgkmcnt(0)
    s_movk_i32 s39, 69
    v_cmp_gt_u32 vcc, s39, v1
    s_cbranch_vccz L296
    s_waitcnt vmcnt(0)
    v_mov_b32 v13, 73
    ds_max_u32 v0, v13
L297:
    s_sleep 1
    s_add_u32 s38, s38, 1
    s_cmp_gt_u32 s38, 6400000
    s_cbranch_scc1 L296
    ds_read_b32 v1, v25 offset:16
    s_waitcnt lgkmcnt(0)
    v_cmp_gt_u32 vcc, s39, v1
    s_cbranch_vccnz L297
L296:
    s_add_u32 s40, s29, 0
    s_add_u32 m0, s25, 0
    s_nop 0
    buffer_load_dwordx4 v3, s[8:11], s40 offen sc1 lds
    s_waitcnt vmcnt(6)
    s_add_u32 s40, s29, 4096
    s_add_u32 m0, s25, 4096
    s_nop 0
    buffer_load_dwordx4 v3, s[8:11], s40 offen sc1 lds
    s_waitcnt vmcnt(6)
    s_add_u32 s40, s29, 8192
    s_add_u32 m0, s25, 8192
    s_nop 0
    buffer_load_dwordx4 v3, s[8:11], s40 offen sc1 lds
    s_waitcnt vmcnt(6)
    s_add_u32 s40, s29, 12288
    s_add_u32 m0, s25, 12288
    s_nop 0
    buffer_load_dwordx4 v3, s[8:11], s40 offen sc1 lds
    s_waitcnt vmcnt(6)
    s_add_u32 s40, s29, 16384
    s_add_u32 m0, s25, 16384
    s_nop 0
    buffer_load_dwordx4 v3, s[8:11], s40 offen sc1 lds
    s_waitcnt vmcnt(6)
    s_add_u32 s40, s29, 20480
    s_add_u32 m0, s25, 20480
    s_nop 0
    buffer_load_dwordx4 v3, s[8:11], s40 offen sc1 lds
    s_waitcnt vmcnt(6)
    v_mov_b32 v13, 73
    ds_max_u32 v0, v13
    s_add_u32 s40, s29, 24576
    s_add_u32 m0, s25, 24576
    s_nop 0
    buffer_load_dwordx4 v3, s[8:11], s40 offen sc1 lds
    s_waitcnt vmcnt(6)
    s_add_u32 s40, s29, 28672
    s_add_u32 m0, s25, 28672
    s_nop 0
    buffer_load_dwordx4 v3, s[8:11], s40 offen sc1 lds
    s_waitcnt vmcnt(6)
    s_add_u32 s40, s29, 32768
    s_add_u32 m0, s25, 98304
    s_nop 0
    buffer_load_dwordx4 v3, s[8:11], s40 offen sc1 lds
    s_waitcnt vmcnt(6)
    s_add_u32 s40, s29, 36864
    s_add_u32 m0, s25, 102400
    s_nop 0
    buffer_load_dwordx4 v3, s[8:11], s40 offen sc1 lds
    s_waitcnt vmcnt(6)
    s_add_u32 s40, s29, 40960
    s_add_u32 m0, s25, 106496
    s_nop 0
    buffer_load_dwordx4 v3, s[8:11], s40 offen sc1 lds
    s_waitcnt vmcnt(6)
    ds_read_b32 v1, v25 offset:16
    s_waitcnt lgkmcnt(0)
    s_movk_i32 s39, 70
    v_cmp_gt_u32 vcc, s39, v1
    s_cbranch_vccz L299
L300:
    s_sleep 1
    s_add_u32 s38, s38, 1
    s_cmp_gt_u32 s38, 6400000
    s_cbranch_scc1 L299
    ds_read_b32 v1, v25 offset:16
    s_waitcnt lgkmcnt(0)
    v_cmp_gt_u32 vcc, s39, v1
    s_cbranch_vccnz L300
L299:
    s_add_u32 s40, s29, 45056
    s_add_u32 m0, s25, 110592
    s_nop 0
    buffer_load_dwordx4 v3, s[8:11], s40 offen sc1 lds
    s_waitcnt vmcnt(6)
    s_add_u32 s40, s29, 49152
    s_add_u32 m0, s25, 114688
    s_nop 0
    buffer_load_dwordx4 v3, s[8:11], s40 offen sc1 lds
    s_waitcnt vmcnt(6)
    s_add_u32 s40, s29, 53248
    s_add_u32 m0, s25, 118784
    s_nop 0
    buffer_load_dwordx4 v3, s[8:11], s40 offen sc1 lds
    s_waitcnt vmcnt(6)
    s_add_u32 s40, s29, 57344
    s_add_u32 m0, s25, 122880
    s_nop 0
    buffer_load_dwordx4 v3, s[8:11], s40 offen sc1 lds
    s_waitcnt vmcnt(6)
    s_add_u32 s40, s29, 61440
    s_add_u32 m0, s25, 126976
    s_nop 0
    buffer_load_dwordx4 v3, s[8:11], s40 offen sc1 lds
    s_waitcnt vmcnt(6)
    s_add_u32 s40, s33, 802816
    buffer_load_dwordx4 v[160:163], v23, s[52:55], s40 offen
    s_waitcnt vmcnt(6)
    s_add_u32 s40, s33, 16384
    buffer_load_dwordx4 v[164:167], v23, s[52:55], s40 offen
    s_waitcnt vmcnt(6)
    s_add_u32 s40, s33, 131072
    buffer_load_dwordx4 v[168:171], v23, s[52:55], s40 offen
    s_waitcnt vmcnt(6)
    s_add_u32 s40, s33, 245760
    buffer_load_dwordx4 v[172:175], v23, s[52:55], s40 offen
    s_waitcnt vmcnt(6)
    s_add_u32 s40, s33, 360448
    buffer_load_dwordx4 v[176:179], v23, s[52:55], s40 offen
    s_waitcnt vmcnt(6)
    s_add_u32 s40, s33, 475136
    buffer_load_dwordx4 v[180:183], v23, s[52:55], s40 offen
    s_waitcnt vmcnt(6)
    s_add_u32 s40, s33, 589824
    buffer_load_dwordx4 v[184:187], v23, s[52:55], s40 offen
    s_waitcnt vmcnt(6)
    s_add_u32 s40, s33, 704512
    buffer_load_dwordx4 v[188:191], v23, s[52:55], s40 offen
    s_waitcnt vmcnt(6)
    ds_read_b32 v1, v25 offset:16
    s_waitcnt lgkmcnt(0)
    s_movk_i32 s39, 72
    v_cmp_gt_u32 vcc, s39, v1
    s_cbranch_vccz L302
L303:
    s_sleep 1
    s_add_u32 s38, s38, 1
    s_cmp_gt_u32 s38, 6400000
    s_cbranch_scc1 L302
    ds_read_b32 v1, v25 offset:16
    s_waitcnt lgkmcnt(0)
    v_cmp_gt_u32 vcc, s39, v1
    s_cbranch_vccnz L303
L302:
    s_add_u32 s40, s29, 65536
    s_add_u32 m0, s25, 32768
    s_nop 0
    buffer_load_dwordx4 v3, s[8:11], s40 offen sc1 lds
    s_waitcnt vmcnt(6)
    s_add_u32 s40, s29, 69632
    s_add_u32 m0, s25, 36864
    s_nop 0
    buffer_load_dwordx4 v3, s[8:11], s40 offen sc1 lds
    s_waitcnt vmcnt(6)
    s_add_u32 s40, s29, 73728
    s_add_u32 m0, s25, 40960
    s_nop 0
    buffer_load_dwordx4 v3, s[8:11], s40 offen sc1 lds
    s_waitcnt vmcnt(6)
    s_add_u32 s40, s29, 77824
    s_add_u32 m0, s25, 45056
    s_nop 0
    buffer_load_dwordx4 v3, s[8:11], s40 offen sc1 lds
    s_waitcnt vmcnt(6)
    s_add_u32 s40, s29, 81920
    s_add_u32 m0, s25, 49152
    s_nop 0
    buffer_load_dwordx4 v3, s[8:11], s40 offen sc1 lds
    s_waitcnt vmcnt(6)
    s_add_u32 s40, s29, 86016
    s_add_u32 m0, s25, 53248
    s_nop 0
    buffer_load_dwordx4 v3, s[8:11], s40 offen sc1 lds
    s_waitcnt vmcnt(6)
    s_add_u32 s40, s29, 90112
    s_add_u32 m0, s25, 57344
    s_nop 0
    buffer_load_dwordx4 v3, s[8:11], s40 offen sc1 lds
    s_waitcnt vmcnt(6)
    s_add_u32 s40, s29, 94208
    s_add_u32 m0, s25, 61440
    s_nop 0
    buffer_load_dwordx4 v3, s[8:11], s40 offen sc1 lds
    s_waitcnt vmcnt(6)
    ds_read_b32 v1, v25 offset:16
    s_waitcnt lgkmcnt(0)
    s_movk_i32 s39, 74
    v_cmp_gt_u32 vcc, s39, v1
    s_cbranch_vccz L305
    s_waitcnt vmcnt(0)
    v_mov_b32 v13, 78
    ds_max_u32 v0, v13
L306:
    s_sleep 1
    s_add_u32 s38, s38, 1
    s_cmp_gt_u32 s38, 6400000
    s_cbranch_scc1 L305
    ds_read_b32 v1, v25 offset:16
    s_waitcnt lgkmcnt(0)
    v_cmp_gt_u32 vcc, s39, v1
    s_cbranch_vccnz L306
L305:
    s_waitcnt vmcnt(0)
    v_mov_b32 v13, 78
    ds_max_u32 v0, v13
    ds_write_b128 v22, v[32:35] offset:0
    ds_write_b128 v22, v[36:39] offset:4096
    ds_write_b128 v22, v[40:43] offset:8192
    ds_write_b128 v22, v[44:47] offset:12288
    ds_write_b128 v22, v[48:51] offset:16384
    ds_write_b128 v22, v[52:55] offset:20480
    ds_write_b128 v22, v[56:59] offset:24576
    ds_read_b32 v1, v25 offset:16
    s_waitcnt lgkmcnt(0)
    s_movk_i32 s39, 75
    v_cmp_gt_u32 vcc, s39, v1
    s_cbranch_vccz L308
L309:
    s_sleep 1
    s_add_u32 s38, s38, 1
    s_cmp_gt_u32 s38, 6400000
    s_cbranch_scc1 L308
    ds_read_b32 v1, v25 offset:16
    s_waitcnt lgkmcnt(0)
    v_cmp_gt_u32 vcc, s39, v1
    s_cbranch_vccnz L309
L308:
    s_add_u32 s40, s29, 98304
    s_add_u32 m0, s25, 65536
    s_nop 0
    buffer_load_dwordx4 v3, s[8:11], s40 offen sc1 lds
    s_add_u32 s40, s29, 102400
    s_add_u32 m0, s25, 69632
    s_nop 0
    buffer_load_dwordx4 v3, s[8:11], s40 offen sc1 lds
    s_add_u32 s40, s29, 106496
    s_add_u32 m0, s25, 73728
    s_nop 0
    buffer_load_dwordx4 v3, s[8:11], s40 offen sc1 lds
    s_add_u32 s40, s29, 110592
    s_add_u32 m0, s25, 77824
    s_nop 0
    buffer_load_dwordx4 v3, s[8:11], s40 offen sc1 lds
    s_add_u32 s40, s29, 114688
    s_add_u32 m0, s25, 81920
    s_nop 0
    buffer_load_dwordx4 v3, s[8:11], s40 offen sc1 lds
    s_add_u32 s40, s29, 118784
    s_add_u32 m0, s25, 86016
    s_nop 0
    buffer_load_dwordx4 v3, s[8:11], s40 offen sc1 lds
    s_add_u32 s40, s29, 122880
    s_add_u32 m0, s25, 90112
    s_nop 0
    buffer_load_dwordx4 v3, s[8:11], s40 offen sc1 lds
    s_waitcnt vmcnt(6)
    s_add_u32 s40, s29, 126976
    s_add_u32 m0, s25, 94208
    s_nop 0
    buffer_load_dwordx4 v3, s[8:11], s40 offen sc1 lds
    s_waitcnt vmcnt(6)
    ds_read_b32 v1, v25 offset:16
    s_waitcnt lgkmcnt(0)
    s_movk_i32 s39, 76
    v_cmp_gt_u32 vcc, s39, v1
    s_cbranch_vccz L311
    s_waitcnt vmcnt(0)
    v_mov_b32 v13, 79
    ds_max_u32 v0, v13
L312:
    s_sleep 1
    s_add_u32 s38, s38, 1
    s_cmp_gt_u32 s38, 6400000
    s_cbranch_scc1 L311
    ds_read_b32 v1, v25 offset:16
    s_waitcnt lgkmcnt(0)
    v_cmp_gt_u32 vcc, s39, v1
    s_cbranch_vccnz L312
L311:
    s_add_u32 s40, s29, 131072
    s_add_u32 m0, s25, 32768
    s_nop 0
    buffer_load_dwordx4 v3, s[8:11], s40 offen sc1 lds
    s_waitcnt vmcnt(6)
    s_add_u32 s40, s29, 135168
    s_add_u32 m0, s25, 36864
    s_nop 0
    buffer_load_dwordx4 v3, s[8:11], s40 offen sc1 lds
    s_waitcnt vmcnt(6)
    ds_read_b32 v1, v25 offset:16
    s_waitcnt lgkmcnt(0)
    s_movk_i32 s39, 77
    v_cmp_gt_u32 vcc, s39, v1
    s_cbranch_vccz L314
    s_waitcnt vmcnt(2)
    v_mov_b32 v13, 79
    ds_max_u32 v0, v13
L315:
    s_sleep 1
    s_add_u32 s38, s38, 1
    s_cmp_gt_u32 s38, 6400000
    s_cbranch_scc1 L314
    ds_read_b32 v1, v25 offset:16
    s_waitcnt lgkmcnt(0)
    v_cmp_gt_u32 vcc, s39, v1
    s_cbranch_vccnz L315
L314:
    s_add_u32 s40, s29, 139264
    s_add_u32 m0, s25, 40960
    s_nop 0
    buffer_load_dwordx4 v3, s[8:11], s40 offen sc1 lds
    s_waitcnt vmcnt(6)
    s_add_u32 s40, s29, 143360
    s_add_u32 m0, s25, 45056
    s_nop 0
    buffer_load_dwordx4 v3, s[8:11], s40 offen sc1 lds
    s_waitcnt vmcnt(6)
    ds_read_b32 v1, v25 offset:16
    s_waitcnt lgkmcnt(0)
    s_movk_i32 s39, 78
    v_cmp_gt_u32 vcc, s39, v1
    s_cbranch_vccz L317
    s_waitcnt vmcnt(4)
    v_mov_b32 v13, 79
    ds_max_u32 v0, v13
L318:
    s_sleep 1
    s_add_u32 s38, s38, 1
    s_cmp_gt_u32 s38, 6400000
    s_cbranch_scc1 L317
    ds_read_b32 v1, v25 offset:16
    s_waitcnt lgkmcnt(0)
    v_cmp_gt_u32 vcc, s39, v1
    s_cbranch_vccnz L318
L317:
    s_add_u32 s40, s29, 147456
    s_add_u32 m0, s25, 49152
    s_nop 0
    buffer_load_dwordx4 v3, s[8:11], s40 offen sc1 lds
    s_waitcnt vmcnt(6)
    s_add_u32 s40, s29, 151552
    s_add_u32 m0, s25, 53248
    s_nop 0
    buffer_load_dwordx4 v3, s[8:11], s40 offen sc1 lds
    s_waitcnt vmcnt(6)
    v_mov_b32 v13, 79
    ds_max_u32 v0, v13
    ds_read_b32 v1, v25 offset:16
    s_waitcnt lgkmcnt(0)
    s_movk_i32 s39, 79
    v_cmp_gt_u32 vcc, s39, v1
    s_cbranch_vccz L320
L321:
    s_sleep 1
    s_add_u32 s38, s38, 1
    s_cmp_gt_u32 s38, 6400000
    s_cbranch_scc1 L320
    ds_read_b32 v1, v25 offset:16
    s_waitcnt lgkmcnt(0)
    v_cmp_gt_u32 vcc, s39, v1
    s_cbranch_vccnz L321
L320:
    s_add_u32 s40, s29, 155648
    s_add_u32 m0, s25, 57344
    s_nop 0
    buffer_load_dwordx4 v3, s[8:11], s40 offen sc1 lds
    s_waitcnt vmcnt(6)
    s_add_u32 s40, s29, 159744
    s_add_u32 m0, s25, 61440
    s_nop 0
    buffer_load_dwordx4 v3, s[8:11], s40 offen sc1 lds
    s_waitcnt vmcnt(6)
    s_add_u32 s40, s29, 163840
    s_add_u32 m0, s25, 98304
    s_nop 0
    buffer_load_dwordx4 v3, s[8:11], s40 offen sc1 lds
    s_waitcnt vmcnt(6)
    s_add_u32 s40, s29, 167936
    s_add_u32 m0, s25, 102400
    s_nop 0
    buffer_load_dwordx4 v3, s[8:11], s40 offen sc1 lds
    s_waitcnt vmcnt(6)
    s_add_u32 s40, s29, 172032
    s_add_u32 m0, s25, 106496
    s_nop 0
    buffer_load_dwordx4 v3, s[8:11], s40 offen sc1 lds
    s_waitcnt vmcnt(6)
    s_add_u32 s40, s29, 176128
    s_add_u32 m0, s25, 110592
    s_nop 0
    buffer_load_dwordx4 v3, s[8:11], s40 offen sc1 lds
    s_waitcnt vmcnt(6)
    s_add_u32 s40, s29, 180224
    s_add_u32 m0, s25, 114688
    s_nop 0
    buffer_load_dwordx4 v3, s[8:11], s40 offen sc1 lds
    s_waitcnt vmcnt(6)
    s_add_u32 s40, s29, 184320
    s_add_u32 m0, s25, 118784
    s_nop 0
    buffer_load_dwordx4 v3, s[8:11], s40 offen sc1 lds
    s_waitcnt vmcnt(6)
    v_mov_b32 v13, 80
    ds_max_u32 v0, v13
    s_add_u32 s40, s29, 188416
    s_add_u32 m0, s25, 122880
    s_nop 0
    buffer_load_dwordx4 v3, s[8:11], s40 offen sc1 lds
    s_waitcnt vmcnt(6)
    s_add_u32 s40, s29, 192512
    s_add_u32 m0, s25, 126976
    s_nop 0
    buffer_load_dwordx4 v3, s[8:11], s40 offen sc1 lds
    s_waitcnt vmcnt(6)
    s_add_u32 s40, s29, 196608
    s_add_u32 m0, s25, 0
    s_nop 0
    buffer_load_dwordx4 v3, s[8:11], s40 offen sc1 lds
    s_waitcnt vmcnt(6)
    s_add_u32 s40, s29, 200704
    s_add_u32 m0, s25, 4096
    s_nop 0
    buffer_load_dwordx4 v3, s[8:11], s40 offen sc1 lds
    s_waitcnt vmcnt(6)
    s_add_u32 s40, s29, 204800
    s_add_u32 m0, s25, 8192
    s_nop 0
    buffer_load_dwordx4 v3, s[8:11], s40 offen sc1 lds
    s_waitcnt vmcnt(6)
    s_add_u32 s40, s29, 208896
    s_add_u32 m0, s25, 12288
    s_nop 0
    buffer_load_dwordx4 v3, s[8:11], s40 offen sc1 lds
    s_waitcnt vmcnt(6)
    s_add_u32 s40, s29, 212992
    s_add_u32 m0, s25, 16384
    s_nop 0
    buffer_load_dwordx4 v3, s[8:11], s40 offen sc1 lds
    s_waitcnt vmcnt(6)
    s_add_u32 s40, s29, 217088
    s_add_u32 m0, s25, 20480
    s_nop 0
    buffer_load_dwordx4 v3, s[8:11], s40 offen sc1 lds
    s_waitcnt vmcnt(6)
    v_mov_b32 v13, 81
    ds_max_u32 v0, v13
    s_add_u32 s40, s29, 221184
    s_add_u32 m0, s25, 24576
    s_nop 0
    buffer_load_dwordx4 v3, s[8:11], s40 offen sc1 lds
    s_waitcnt vmcnt(6)
    s_add_u32 s40, s29, 225280
    s_add_u32 m0, s25, 28672
    s_nop 0
    buffer_load_dwordx4 v3, s[8:11], s40 offen sc1 lds
    s_waitcnt vmcnt(6)
    s_waitcnt vmcnt(0)
    v_mov_b32 v13, 82
    ds_max_u32 v0, v13
    ds_read_b32 v1, v25 offset:16
    s_waitcnt lgkmcnt(0)
    s_movk_i32 s39, 80
    v_cmp_gt_u32 vcc, s39, v1
    s_cbranch_vccz L323
L324:
    s_sleep 1
    s_add_u32 s38, s38, 1
    s_cmp_gt_u32 s38, 6400000
    s_cbranch_scc1 L323
    ds_read_b32 v1, v25 offset:16
    s_waitcnt lgkmcnt(0)
    v_cmp_gt_u32 vcc, s39, v1
    s_cbranch_vccnz L324
L323:
    ds_write_b128 v21, v[160:163] offset:0
    ds_write_b128 v21, v[164:167] offset:4096
    ds_write_b128 v21, v[168:171] offset:8192
    ds_write_b128 v21, v[172:175] offset:12288
    ds_write_b128 v21, v[176:179] offset:16384
    ds_write_b128 v21, v[180:183] offset:20480
    ds_write_b128 v21, v[184:187] offset:24576
    ds_write_b128 v21, v[188:191] offset:28672
    ds_read_b32 v1, v25 offset:16
    s_waitcnt lgkmcnt(0)
    s_movk_i32 s39, 81
    v_cmp_gt_u32 vcc, s39, v1
    s_cbranch_vccz L326
L327:
    s_sleep 1
    s_add_u32 s38, s38, 1
    s_cmp_gt_u32 s38, 6400000
    s_cbranch_scc1 L326
    ds_read_b32 v1, v25 offset:16
    s_waitcnt lgkmcnt(0)
    v_cmp_gt_u32 vcc, s39, v1
    s_cbranch_vccnz L327
L326:
    s_add_u32 s40, s33, 819200
    s_add_u32 m0, s25, 32768
    s_nop 0
    buffer_load_dwordx4 v23, s[52:55], s40 offen lds
    s_add_u32 s40, s33, 32768
    s_add_u32 m0, s25, 36864
    s_nop 0
    buffer_load_dwordx4 v23, s[52:55], s40 offen lds
    s_add_u32 s40, s33, 147456
    s_add_u32 m0, s25, 40960
    s_nop 0
    buffer_load_dwordx4 v23, s[52:55], s40 offen lds
    s_add_u32 s40, s33, 262144
    s_add_u32 m0, s25, 45056
    s_nop 0
    buffer_load_dwordx4 v23, s[52:55], s40 offen lds
    s_add_u32 s40, s33, 376832
    s_add_u32 m0, s25, 49152
    s_nop 0
    buffer_load_dwordx4 v23, s[52:55], s40 offen lds
    s_add_u32 s40, s33, 491520
    s_add_u32 m0, s25, 53248
    s_nop 0
    buffer_load_dwordx4 v23, s[52:55], s40 offen lds
    s_add_u32 s40, s33, 606208
    s_add_u32 m0, s25, 57344
    s_nop 0
    buffer_load_dwordx4 v23, s[52:55], s40 offen lds
    s_waitcnt vmcnt(6)
    s_add_u32 s40, s33, 720896
    s_add_u32 m0, s25, 61440
    s_nop 0
    buffer_load_dwordx4 v23, s[52:55], s40 offen lds
    s_waitcnt vmcnt(6)
    ds_read_b32 v1, v25 offset:16
    s_waitcnt lgkmcnt(0)
    s_movk_i32 s39, 82
    v_cmp_gt_u32 vcc, s39, v1
    s_cbranch_vccz L329
    s_waitcnt vmcnt(0)
    v_mov_b32 v13, 83
    ds_max_u32 v0, v13
L330:
    s_sleep 1
    s_add_u32 s38, s38, 1
    s_cmp_gt_u32 s38, 6400000
    s_cbranch_scc1 L329
    ds_read_b32 v1, v25 offset:16
    s_waitcnt lgkmcnt(0)
    v_cmp_gt_u32 vcc, s39, v1
    s_cbranch_vccnz L330
L329:
    s_add_u32 s40, s33, 835584
    s_add_u32 m0, s25, 98304
    s_nop 0
    buffer_load_dwordx4 v23, s[52:55], s40 offen lds
    s_waitcnt vmcnt(6)
    s_add_u32 s40, s33, 49152
    s_add_u32 m0, s25, 102400
    s_nop 0
    buffer_load_dwordx4 v23, s[52:55], s40 offen lds
    s_waitcnt vmcnt(6)
    s_add_u32 s40, s33, 163840
    s_add_u32 m0, s25, 106496
    s_nop 0
    buffer_load_dwordx4 v23, s[52:55], s40 offen lds
    s_waitcnt vmcnt(6)
    s_add_u32 s40, s33, 278528
    s_add_u32 m0, s25, 110592
    s_nop 0
    buffer_load_dwordx4 v23, s[52:55], s40 offen lds
    s_waitcnt vmcnt(6)
    s_add_u32 s40, s33, 393216
    s_add_u32 m0, s25, 114688
    s_nop 0
    buffer_load_dwordx4 v23, s[52:55], s40 offen lds
    s_waitcnt vmcnt(6)
    s_add_u32 s40, s33, 507904
    s_add_u32 m0, s25, 118784
    s_nop 0
    buffer_load_dwordx4 v23, s[52:55], s40 offen lds
    s_waitcnt vmcnt(6)
    v_mov_b32 v13, 83
    ds_max_u32 v0, v13
    s_add_u32 s40, s33, 622592
    s_add_u32 m0, s25, 122880
    s_nop 0
    buffer_load_dwordx4 v23, s[52:55], s40 offen lds
    s_waitcnt vmcnt(6)
    s_add_u32 s40, s33, 737280
    s_add_u32 m0, s25, 126976
    s_nop 0
    buffer_load_dwordx4 v23, s[52:55], s40 offen lds
    s_waitcnt vmcnt(6)
    ds_read_b32 v1, v25 offset:16
    s_waitcnt lgkmcnt(0)
    s_movk_i32 s39, 83
    v_cmp_gt_u32 vcc, s39, v1
    s_cbranch_vccz L332
    s_waitcnt vmcnt(0)
    v_mov_b32 v13, 84
    ds_max_u32 v0, v13
L333:
    s_sleep 1
    s_add_u32 s38, s38, 1
    s_cmp_gt_u32 s38, 6400000
    s_cbranch_scc1 L332
    ds_read_b32 v1, v25 offset:16
    s_waitcnt lgkmcnt(0)
    v_cmp_gt_u32 vcc, s39, v1
    s_cbranch_vccnz L333
L332:
    ds_write_b128 v20, v[60:63] offset:0
    ds_write_b128 v20, v[64:67] offset:4096
    ds_write_b128 v20, v[68:71] offset:8192
    ds_write_b128 v20, v[72:75] offset:12288
    ds_write_b128 v20, v[76:79] offset:16384
    ds_write_b128 v20, v[80:83] offset:20480
    ds_write_b128 v20, v[84:87] offset:24576
    ds_write_b128 v20, v[88:91] offset:28672
    ds_read_b32 v1, v25 offset:16
    s_waitcnt lgkmcnt(0)
    s_movk_i32 s39, 84
    v_cmp_gt_u32 vcc, s39, v1
    s_cbranch_vccz L335
    s_waitcnt vmcnt(0)
    v_mov_b32 v13, 84
    ds_max_u32 v0, v13
    s_waitcnt vmcnt(0)
    v_mov_b32 v13, 85
    ds_max_u32 v0, v13
L336:
    s_sleep 1
    s_add_u32 s38, s38, 1
    s_cmp_gt_u32 s38, 6400000
    s_cbranch_scc1 L335
    ds_read_b32 v1, v25 offset:16
    s_waitcnt lgkmcnt(0)
    v_cmp_gt_u32 vcc, s39, v1
    s_cbranch_vccnz L336
L335:
    ds_write_b128 v22, v[92:95] offset:0
    ds_write_b128 v22, v[96:99] offset:4096
    ds_write_b128 v22, v[100:103] offset:8192
    ds_write_b128 v22, v[104:107] offset:12288
    ds_write_b128 v22, v[108:111] offset:16384
    ds_write_b128 v22, v[112:115] offset:20480
    ds_write_b128 v22, v[116:119] offset:24576
    s_waitcnt vmcnt(0)
    v_mov_b32 v13, 86
    ds_max_u32 v0, v13
    ds_read_b32 v1, v25 offset:16
    s_waitcnt lgkmcnt(0)
    s_movk_i32 s39, 87
    v_cmp_gt_u32 vcc, s39, v1
    s_cbranch_vccz L338
L339:
    s_sleep 1
    s_add_u32 s38, s38, 1
    s_cmp_gt_u32 s38, 6400000
    s_cbranch_scc1 L338
    ds_read_b32 v1, v25 offset:16
    s_waitcnt lgkmcnt(0)
    v_cmp_gt_u32 vcc, s39, v1
    s_cbranch_vccnz L339
L338:
    ds_write_b128 v21, v[120:123] offset:32768
    ds_write_b128 v21, v[124:127] offset:36864
    ds_write_b128 v21, v[128:131] offset:40960
    ds_write_b128 v21, v[132:135] offset:45056
    ds_write_b128 v21, v[136:139] offset:49152
    ds_write_b128 v21, v[140:143] offset:53248
    ds_write_b128 v21, v[144:147] offset:57344
    ds_write_b128 v21, v[148:151] offset:61440
    ds_write_b128 v20, v[152:155] offset:0
    ds_write_b128 v20, v[156:159] offset:4096
    v_mov_b32 v13, 87
    ds_max_u32 v0, v13
    s_endpgm
L_end:
    s_endpgm
L28:
    buffer_store_dwordx4 v[36:39], v3, s[8:11], s37 offen offset:0 sc1
    s_branch L29
L30:
    buffer_store_dword v13, off, s[8:11], s24 sc1
    s_branch L31
L32:
    buffer_store_dwordx4 v[36:39], v3, s[8:11], s37 offen offset:1024 sc1
    s_branch L33
L36:
    buffer_store_dword v13, off, s[8:11], s24 sc1
    s_branch L37
L40:
    buffer_store_dword v13, off, s[8:11], s24 sc1
    s_branch L41
L60:
    buffer_store_dwordx4 v[36:39], v3, s[8:11], s37 offen offset:0 sc1
    s_branch L61
L62:
    buffer_store_dword v13, off, s[8:11], s24 sc1
    s_branch L63
L82:
    buffer_store_dwordx4 v[36:39], v3, s[8:11], s37 offen offset:1024 sc1
    s_branch L83
L_redo0:
    s_nop 15
    s_waitcnt vmcnt(0) lgkmcnt(0)
    ds_read_b128 v[136:139], v65 offset:0
    ds_read_b128 v[140:143], v65 offset:1024
    ds_read_b128 v[144:147], v65 offset:2048
    ds_read_b128 v[148:151], v65 offset:3072
    ds_read_b128 v[152:155], v65 offset:4096
    ds_read_b128 v[156:159], v65 offset:5120
    ds_read_b128 v[160:163], v65 offset:6144
    ds_read_b128 v[164:167], v65 offset:7168
    ds_read_b128 v[168:171], v65 offset:8192
    s_waitcnt lgkmcnt(0)
    s_sub_i32 s42, 8, s27
    s_cmp_gt_i32 s42, 8
    s_cbranch_scc1 L42
    v_mfma_f32_32x32x16_bf16 v[172:187], v[168:171], v[128:131], 0
    s_nop 11
    v_cndmask_b32_e64 v172, v67, v172, s[64:65]
    v_cndmask_b32_e64 v173, v67, v173, s[66:67]
    v_cndmask_b32_e64 v174, v67, v174, s[68:69]
    v_cndmask_b32_e64 v175, v67, v175, s[70:71]
    v_cndmask_b32_e64 v176, v67, v176, s[72:73]
    v_cndmask_b32_e64 v177, v67, v177, s[74:75]
    v_cndmask_b32_e64 v178, v67, v178, s[76:77]
    v_cndmask_b32_e64 v179, v67, v179, s[78:79]
    v_cndmask_b32_e64 v180, v67, v180, s[80:81]
    v_cndmask_b32_e64 v181, v67, v181, s[82:83]
    v_cndmask_b32_e64 v182, v67, v182, s[84:85]
    v_cndmask_b32_e64 v183, v67, v183, s[86:87]
    v_cndmask_b32_e64 v184, v67, v184, s[88:89]
    v_cndmask_b32_e64 v185, v67, v185, s[90:91]
    v_cndmask_b32_e64 v186, v67, v186, s[92:93]
    v_cndmask_b32_e64 v187, v67, v187, s[94:95]
    v_max3_f32 v252, v172, v173, v174
    v_max3_f32 v253, v175, v176, v177
    v_max3_f32 v252, v252, v178, v179
    v_max3_f32 v253, v253, v180, v181
    v_max3_f32 v252, v252, v182, v183
    v_max3_f32 v253, v253, v184, v185
    v_max3_f32 v252, v252, v186, v187
L42:
    s_cmp_gt_i32 s42, 0
    s_cbranch_scc1 L43
    v_mfma_f32_32x32x16_bf16 v[172:187], v[136:139], v[128:131], 0
    s_nop 11
    v_cndmask_b32_e64 v172, v172, v67, s[64:65]
    v_cndmask_b32_e64 v173, v173, v67, s[66:67]
    v_cndmask_b32_e64 v174, v174, v67, s[68:69]
    v_cndmask_b32_e64 v175, v175, v67, s[70:71]
    v_cndmask_b32_e64 v176, v176, v67, s[72:73]
    v_cndmask_b32_e64 v177, v177, v67, s[74:75]
    v_cndmask_b32_e64 v178, v178, v67, s[76:77]
    v_cndmask_b32_e64 v179, v179, v67, s[78:79]
    v_cndmask_b32_e64 v180, v180, v67, s[80:81]
    v_cndmask_b32_e64 v181, v181, v67, s[82:83]
    v_cndmask_b32_e64 v182, v182, v67, s[84:85]
    v_cndmask_b32_e64 v183, v183, v67, s[86:87]
    v_cndmask_b32_e64 v184, v184, v67, s[88:89]
    v_cndmask_b32_e64 v185, v185, v67, s[90:91]
    v_cndmask_b32_e64 v186, v186, v67, s[92:93]
    v_cndmask_b32_e64 v187, v187, v67, s[94:95]
    v_max3_f32 v252, v252, v172, v173
    v_max3_f32 v253, v253, v174, v175
    v_max3_f32 v252, v252, v176, v177
    v_max3_f32 v253, v253, v178, v179
    v_max3_f32 v252, v252, v180, v181
    v_max3_f32 v253, v253, v182, v183
    v_max3_f32 v252, v252, v184, v185
    v_max3_f32 v253, v253, v186, v187
L43:
    s_cmp_gt_i32 s42, 1
    s_cbranch_scc1 L44
    v_mfma_f32_32x32x16_bf16 v[172:187], v[140:143], v[128:131], 0
    s_nop 11
    v_max3_f32 v252, v252, v172, v173
    v_max3_f32 v253, v253, v174, v175
    v_max3_f32 v252, v252, v176, v177
    v_max3_f32 v253, v253, v178, v179
    v_max3_f32 v252, v252, v180, v181
    v_max3_f32 v253, v253, v182, v183
    v_max3_f32 v252, v252, v184, v185
    v_max3_f32 v253, v253, v186, v187
L44:
    s_cmp_gt_i32 s42, 2
    s_cbranch_scc1 L45
    v_mfma_f32_32x32x16_bf16 v[172:187], v[144:147], v[128:131], 0
    s_nop 11
    v_max3_f32 v252, v252, v172, v173
    v_max3_f32 v253, v253, v174, v175
    v_max3_f32 v252, v252, v176, v177
    v_max3_f32 v253, v253, v178, v179
    v_max3_f32 v252, v252, v180, v181
    v_max3_f32 v253, v253, v182, v183
    v_max3_f32 v252, v252, v184, v185
    v_max3_f32 v253, v253, v186, v187
L45:
    s_cmp_gt_i32 s42, 3
    s_cbranch_scc1 L46
    v_mfma_f32_32x32x16_bf16 v[172:187], v[148:151], v[128:131], 0
    s_nop 11
    v_max3_f32 v252, v252, v172, v173
    v_max3_f32 v253, v253, v174, v175
    v_max3_f32 v252, v252, v176, v177
    v_max3_f32 v253, v253, v178, v179
    v_max3_f32 v252, v252, v180, v181
    v_max3_f32 v253, v253, v182, v183
    v_max3_f32 v252, v252, v184, v185
    v_max3_f32 v253, v253, v186, v187
L46:
    s_cmp_gt_i32 s42, 4
    s_cbranch_scc1 L47
    v_mfma_f32_32x32x16_bf16 v[172:187], v[152:155], v[128:131], 0
    s_nop 11
    v_max3_f32 v252, v252, v172, v173
    v_max3_f32 v253, v253, v174, v175
    v_max3_f32 v252, v252, v176, v177
    v_max3_f32 v253, v253, v178, v179
    v_max3_f32 v252, v252, v180, v181
    v_max3_f32 v253, v253, v182, v183
    v_max3_f32 v252, v252, v184, v185
    v_max3_f32 v253, v253, v186, v187
L47:
    s_cmp_gt_i32 s42, 5
    s_cbranch_scc1 L48
    v_mfma_f32_32x32x16_bf16 v[172:187], v[156:159], v[128:131], 0
    s_nop 11
    v_max3_f32 v252, v252, v172, v173
    v_max3_f32 v253, v253, v174, v175
    v_max3_f32 v252, v252, v176, v177
    v_max3_f32 v253, v253, v178, v179
    v_max3_f32 v252, v252, v180, v181
    v_max3_f32 v253, v253, v182, v183
    v_max3_f32 v252, v252, v184, v185
    v_max3_f32 v253, v253, v186, v187
L48:
    s_cmp_gt_i32 s42, 6
    s_cbranch_scc1 L49
    v_mfma_f32_32x32x16_bf16 v[172:187], v[160:163], v[128:131], 0
    s_nop 11
    v_max3_f32 v252, v252, v172, v173
    v_max3_f32 v253, v253, v174, v175
    v_max3_f32 v252, v252, v176, v177
    v_max3_f32 v253, v253, v178, v179
    v_max3_f32 v252, v252, v180, v181
    v_max3_f32 v253, v253, v182, v183
    v_max3_f32 v252, v252, v184, v185
    v_max3_f32 v253, v253, v186, v187
L49:
    s_cmp_gt_i32 s42, 7
    s_cbranch_scc1 L50
    v_mfma_f32_32x32x16_bf16 v[172:187], v[164:167], v[128:131], 0
    s_nop 11
    v_max3_f32 v252, v252, v172, v173
    v_max3_f32 v253, v253, v174, v175
    v_max3_f32 v252, v252, v176, v177
    v_max3_f32 v253, v253, v178, v179
    v_max3_f32 v252, v252, v180, v181
    v_max3_f32 v253, v253, v182, v183
    v_max3_f32 v252, v252, v184, v185
    v_max3_f32 v253, v253, v186, v187
L50:
    v_max_f32 v252, v252, v253
    v_mov_b32 v253, v252
    s_nop 1
    v_permlane32_swap_b32 v252, v253
    s_nop 1
    v_max_f32 v252, v252, v253
    v_sub_f32 v220, 0, v252
    v_sub_f32 v221, 0, v252
    v_sub_f32 v222, 0, v252
    v_sub_f32 v223, 0, v252
    v_sub_f32 v224, 0, v252
    v_sub_f32 v225, 0, v252
    v_sub_f32 v226, 0, v252
    v_sub_f32 v227, 0, v252
    v_sub_f32 v228, 0, v252
    v_sub_f32 v229, 0, v252
    v_sub_f32 v230, 0, v252
    v_sub_f32 v231, 0, v252
    v_sub_f32 v232, 0, v252
    v_sub_f32 v233, 0, v252
    v_sub_f32 v234, 0, v252
    v_sub_f32 v235, 0, v252
    s_cmp_gt_i32 s42, 8
    s_cbranch_scc1 L51
    v_sub_u32 v254, v64, v66
    ds_read_b64_tr_b16 v[104:105], v254 offset:0
    ds_read_b64_tr_b16 v[106:107], v254 offset:64
    ds_read_b64_tr_b16 v[108:109], v254 offset:256
    ds_read_b64_tr_b16 v[110:111], v254 offset:320
    v_mfma_f32_32x32x16_bf16 v[172:187], v[168:171], v[128:131], v[220:235]
    s_nop 11
    v_cndmask_b32_e64 v172, v67, v172, s[64:65]
    v_cndmask_b32_e64 v173, v67, v173, s[66:67]
    v_cndmask_b32_e64 v174, v67, v174, s[68:69]
    v_cndmask_b32_e64 v175, v67, v175, s[70:71]
    v_cndmask_b32_e64 v176, v67, v176, s[72:73]
    v_cndmask_b32_e64 v177, v67, v177, s[74:75]
    v_cndmask_b32_e64 v178, v67, v178, s[76:77]
    v_cndmask_b32_e64 v179, v67, v179, s[78:79]
    v_cndmask_b32_e64 v180, v67, v180, s[80:81]
    v_cndmask_b32_e64 v181, v67, v181, s[82:83]
    v_cndmask_b32_e64 v182, v67, v182, s[84:85]
    v_cndmask_b32_e64 v183, v67, v183, s[86:87]
    v_cndmask_b32_e64 v184, v67, v184, s[88:89]
    v_cndmask_b32_e64 v185, v67, v185, s[90:91]
    v_cndmask_b32_e64 v186, v67, v186, s[92:93]
    v_cndmask_b32_e64 v187, v67, v187, s[94:95]
    v_exp_f32 v172, v172
    v_exp_f32 v173, v173
    v_exp_f32 v174, v174
    v_exp_f32 v175, v175
    v_exp_f32 v176, v176
    v_exp_f32 v177, v177
    v_exp_f32 v178, v178
    v_exp_f32 v179, v179
    v_exp_f32 v180, v180
    v_exp_f32 v181, v181
    v_exp_f32 v182, v182
    v_exp_f32 v183, v183
    v_exp_f32 v184, v184
    v_exp_f32 v185, v185
    v_exp_f32 v186, v186
    v_exp_f32 v187, v187
    v_cvt_pk_bf16_f32 v120, v172, v173
    v_cvt_pk_bf16_f32 v121, v174, v175
    v_cvt_pk_bf16_f32 v122, v176, v177
    v_cvt_pk_bf16_f32 v123, v178, v179
    v_cvt_pk_bf16_f32 v124, v180, v181
    v_cvt_pk_bf16_f32 v125, v182, v183
    v_cvt_pk_bf16_f32 v126, v184, v185
    v_cvt_pk_bf16_f32 v127, v186, v187
    s_waitcnt lgkmcnt(0)
    v_mfma_f32_32x32x16_bf16 v[72:87], v[104:107], v[120:123], 0
    v_mfma_f32_32x32x16_bf16 v[72:87], v[108:111], v[124:127], v[72:87]
L51:
    s_cmp_gt_i32 s42, 0
    s_cbranch_scc1 L52
    v_sub_u32 v254, v56, v66
    ds_read_b64_tr_b16 v[104:105], v254 offset:0
    ds_read_b64_tr_b16 v[106:107], v254 offset:64
    ds_read_b64_tr_b16 v[108:109], v254 offset:256
    ds_read_b64_tr_b16 v[110:111], v254 offset:320
    v_mfma_f32_32x32x16_bf16 v[172:187], v[136:139], v[128:131], v[220:235]
    s_nop 11
    v_cndmask_b32_e64 v172, v172, v67, s[64:65]
    v_cndmask_b32_e64 v173, v173, v67, s[66:67]
    v_cndmask_b32_e64 v174, v174, v67, s[68:69]
    v_cndmask_b32_e64 v175, v175, v67, s[70:71]
    v_cndmask_b32_e64 v176, v176, v67, s[72:73]
    v_cndmask_b32_e64 v177, v177, v67, s[74:75]
    v_cndmask_b32_e64 v178, v178, v67, s[76:77]
    v_cndmask_b32_e64 v179, v179, v67, s[78:79]
    v_cndmask_b32_e64 v180, v180, v67, s[80:81]
    v_cndmask_b32_e64 v181, v181, v67, s[82:83]
    v_cndmask_b32_e64 v182, v182, v67, s[84:85]
    v_cndmask_b32_e64 v183, v183, v67, s[86:87]
    v_cndmask_b32_e64 v184, v184, v67, s[88:89]
    v_cndmask_b32_e64 v185, v185, v67, s[90:91]
    v_cndmask_b32_e64 v186, v186, v67, s[92:93]
    v_cndmask_b32_e64 v187, v187, v67, s[94:95]
    v_exp_f32 v172, v172
    v_exp_f32 v173, v173
    v_exp_f32 v174, v174
    v_exp_f32 v175, v175
    v_exp_f32 v176, v176
    v_exp_f32 v177, v177
    v_exp_f32 v178, v178
    v_exp_f32 v179, v179
    v_exp_f32 v180, v180
    v_exp_f32 v181, v181
    v_exp_f32 v182, v182
    v_exp_f32 v183, v183
    v_exp_f32 v184, v184
    v_exp_f32 v185, v185
    v_exp_f32 v186, v186
    v_exp_f32 v187, v187
    v_cvt_pk_bf16_f32 v120, v172, v173
    v_cvt_pk_bf16_f32 v121, v174, v175
    v_cvt_pk_bf16_f32 v122, v176, v177
    v_cvt_pk_bf16_f32 v123, v178, v179
    v_cvt_pk_bf16_f32 v124, v180, v181
    v_cvt_pk_bf16_f32 v125, v182, v183
    v_cvt_pk_bf16_f32 v126, v184, v185
    v_cvt_pk_bf16_f32 v127, v186, v187
    s_waitcnt lgkmcnt(0)
    v_mfma_f32_32x32x16_bf16 v[72:87], v[104:107], v[120:123], v[72:87]
    v_mfma_f32_32x32x16_bf16 v[72:87], v[108:111], v[124:127], v[72:87]
L52:
    s_cmp_gt_i32 s42, 1
    s_cbranch_scc1 L53
    v_sub_u32 v254, v57, v66
    ds_read_b64_tr_b16 v[104:105], v254 offset:0
    ds_read_b64_tr_b16 v[106:107], v254 offset:64
    ds_read_b64_tr_b16 v[108:109], v254 offset:256
    ds_read_b64_tr_b16 v[110:111], v254 offset:320
    v_mfma_f32_32x32x16_bf16 v[172:187], v[140:143], v[128:131], v[220:235]
    s_nop 11
    v_exp_f32 v172, v172
    v_exp_f32 v173, v173
    v_exp_f32 v174, v174
    v_exp_f32 v175, v175
    v_exp_f32 v176, v176
    v_exp_f32 v177, v177
    v_exp_f32 v178, v178
    v_exp_f32 v179, v179
    v_exp_f32 v180, v180
    v_exp_f32 v181, v181
    v_exp_f32 v182, v182
    v_exp_f32 v183, v183
    v_exp_f32 v184, v184
    v_exp_f32 v185, v185
    v_exp_f32 v186, v186
    v_exp_f32 v187, v187
    v_cvt_pk_bf16_f32 v120, v172, v173
    v_cvt_pk_bf16_f32 v121, v174, v175
    v_cvt_pk_bf16_f32 v122, v176, v177
    v_cvt_pk_bf16_f32 v123, v178, v179
    v_cvt_pk_bf16_f32 v124, v180, v181
    v_cvt_pk_bf16_f32 v125, v182, v183
    v_cvt_pk_bf16_f32 v126, v184, v185
    v_cvt_pk_bf16_f32 v127, v186, v187
    s_waitcnt lgkmcnt(0)
    v_mfma_f32_32x32x16_bf16 v[72:87], v[104:107], v[120:123], v[72:87]
    v_mfma_f32_32x32x16_bf16 v[72:87], v[108:111], v[124:127], v[72:87]
L53:
    s_cmp_gt_i32 s42, 2
    s_cbranch_scc1 L54
    v_sub_u32 v254, v58, v66
    ds_read_b64_tr_b16 v[104:105], v254 offset:0
    ds_read_b64_tr_b16 v[106:107], v254 offset:64
    ds_read_b64_tr_b16 v[108:109], v254 offset:256
    ds_read_b64_tr_b16 v[110:111], v254 offset:320
    v_mfma_f32_32x32x16_bf16 v[172:187], v[144:147], v[128:131], v[220:235]
    s_nop 11
    v_exp_f32 v172, v172
    v_exp_f32 v173, v173
    v_exp_f32 v174, v174
    v_exp_f32 v175, v175
    v_exp_f32 v176, v176
    v_exp_f32 v177, v177
    v_exp_f32 v178, v178
    v_exp_f32 v179, v179
    v_exp_f32 v180, v180
    v_exp_f32 v181, v181
    v_exp_f32 v182, v182
    v_exp_f32 v183, v183
    v_exp_f32 v184, v184
    v_exp_f32 v185, v185
    v_exp_f32 v186, v186
    v_exp_f32 v187, v187
    v_cvt_pk_bf16_f32 v120, v172, v173
    v_cvt_pk_bf16_f32 v121, v174, v175
    v_cvt_pk_bf16_f32 v122, v176, v177
    v_cvt_pk_bf16_f32 v123, v178, v179
    v_cvt_pk_bf16_f32 v124, v180, v181
    v_cvt_pk_bf16_f32 v125, v182, v183
    v_cvt_pk_bf16_f32 v126, v184, v185
    v_cvt_pk_bf16_f32 v127, v186, v187
    s_waitcnt lgkmcnt(0)
    v_mfma_f32_32x32x16_bf16 v[72:87], v[104:107], v[120:123], v[72:87]
    v_mfma_f32_32x32x16_bf16 v[72:87], v[108:111], v[124:127], v[72:87]
L54:
    s_cmp_gt_i32 s42, 3
    s_cbranch_scc1 L55
    v_sub_u32 v254, v59, v66
    ds_read_b64_tr_b16 v[104:105], v254 offset:0
    ds_read_b64_tr_b16 v[106:107], v254 offset:64
    ds_read_b64_tr_b16 v[108:109], v254 offset:256
    ds_read_b64_tr_b16 v[110:111], v254 offset:320
    v_mfma_f32_32x32x16_bf16 v[172:187], v[148:151], v[128:131], v[220:235]
    s_nop 11
    v_exp_f32 v172, v172
    v_exp_f32 v173, v173
    v_exp_f32 v174, v174
    v_exp_f32 v175, v175
    v_exp_f32 v176, v176
    v_exp_f32 v177, v177
    v_exp_f32 v178, v178
    v_exp_f32 v179, v179
    v_exp_f32 v180, v180
    v_exp_f32 v181, v181
    v_exp_f32 v182, v182
    v_exp_f32 v183, v183
    v_exp_f32 v184, v184
    v_exp_f32 v185, v185
    v_exp_f32 v186, v186
    v_exp_f32 v187, v187
    v_cvt_pk_bf16_f32 v120, v172, v173
    v_cvt_pk_bf16_f32 v121, v174, v175
    v_cvt_pk_bf16_f32 v122, v176, v177
    v_cvt_pk_bf16_f32 v123, v178, v179
    v_cvt_pk_bf16_f32 v124, v180, v181
    v_cvt_pk_bf16_f32 v125, v182, v183
    v_cvt_pk_bf16_f32 v126, v184, v185
    v_cvt_pk_bf16_f32 v127, v186, v187
    s_waitcnt lgkmcnt(0)
    v_mfma_f32_32x32x16_bf16 v[72:87], v[104:107], v[120:123], v[72:87]
    v_mfma_f32_32x32x16_bf16 v[72:87], v[108:111], v[124:127], v[72:87]
L55:
    s_cmp_gt_i32 s42, 4
    s_cbranch_scc1 L56
    v_sub_u32 v254, v60, v66
    ds_read_b64_tr_b16 v[104:105], v254 offset:0
    ds_read_b64_tr_b16 v[106:107], v254 offset:64
    ds_read_b64_tr_b16 v[108:109], v254 offset:256
    ds_read_b64_tr_b16 v[110:111], v254 offset:320
    v_mfma_f32_32x32x16_bf16 v[172:187], v[152:155], v[128:131], v[220:235]
    s_nop 11
    v_exp_f32 v172, v172
    v_exp_f32 v173, v173
    v_exp_f32 v174, v174
    v_exp_f32 v175, v175
    v_exp_f32 v176, v176
    v_exp_f32 v177, v177
    v_exp_f32 v178, v178
    v_exp_f32 v179, v179
    v_exp_f32 v180, v180
    v_exp_f32 v181, v181
    v_exp_f32 v182, v182
    v_exp_f32 v183, v183
    v_exp_f32 v184, v184
    v_exp_f32 v185, v185
    v_exp_f32 v186, v186
    v_exp_f32 v187, v187
    v_cvt_pk_bf16_f32 v120, v172, v173
    v_cvt_pk_bf16_f32 v121, v174, v175
    v_cvt_pk_bf16_f32 v122, v176, v177
    v_cvt_pk_bf16_f32 v123, v178, v179
    v_cvt_pk_bf16_f32 v124, v180, v181
    v_cvt_pk_bf16_f32 v125, v182, v183
    v_cvt_pk_bf16_f32 v126, v184, v185
    v_cvt_pk_bf16_f32 v127, v186, v187
    s_waitcnt lgkmcnt(0)
    v_mfma_f32_32x32x16_bf16 v[72:87], v[104:107], v[120:123], v[72:87]
    v_mfma_f32_32x32x16_bf16 v[72:87], v[108:111], v[124:127], v[72:87]
L56:
    s_cmp_gt_i32 s42, 5
    s_cbranch_scc1 L57
    v_sub_u32 v254, v61, v66
    ds_read_b64_tr_b16 v[104:105], v254 offset:0
    ds_read_b64_tr_b16 v[106:107], v254 offset:64
    ds_read_b64_tr_b16 v[108:109], v254 offset:256
    ds_read_b64_tr_b16 v[110:111], v254 offset:320
    v_mfma_f32_32x32x16_bf16 v[172:187], v[156:159], v[128:131], v[220:235]
    s_nop 11
    v_exp_f32 v172, v172
    v_exp_f32 v173, v173
    v_exp_f32 v174, v174
    v_exp_f32 v175, v175
    v_exp_f32 v176, v176
    v_exp_f32 v177, v177
    v_exp_f32 v178, v178
    v_exp_f32 v179, v179
    v_exp_f32 v180, v180
    v_exp_f32 v181, v181
    v_exp_f32 v182, v182
    v_exp_f32 v183, v183
    v_exp_f32 v184, v184
    v_exp_f32 v185, v185
    v_exp_f32 v186, v186
    v_exp_f32 v187, v187
    v_cvt_pk_bf16_f32 v120, v172, v173
    v_cvt_pk_bf16_f32 v121, v174, v175
    v_cvt_pk_bf16_f32 v122, v176, v177
    v_cvt_pk_bf16_f32 v123, v178, v179
    v_cvt_pk_bf16_f32 v124, v180, v181
    v_cvt_pk_bf16_f32 v125, v182, v183
    v_cvt_pk_bf16_f32 v126, v184, v185
    v_cvt_pk_bf16_f32 v127, v186, v187
    s_waitcnt lgkmcnt(0)
    v_mfma_f32_32x32x16_bf16 v[72:87], v[104:107], v[120:123], v[72:87]
    v_mfma_f32_32x32x16_bf16 v[72:87], v[108:111], v[124:127], v[72:87]
L57:
    s_cmp_gt_i32 s42, 6
    s_cbranch_scc1 L58
    v_sub_u32 v254, v62, v66
    ds_read_b64_tr_b16 v[104:105], v254 offset:0
    ds_read_b64_tr_b16 v[106:107], v254 offset:64
    ds_read_b64_tr_b16 v[108:109], v254 offset:256
    ds_read_b64_tr_b16 v[110:111], v254 offset:320
    v_mfma_f32_32x32x16_bf16 v[172:187], v[160:163], v[128:131], v[220:235]
    s_nop 11
    v_exp_f32 v172, v172
    v_exp_f32 v173, v173
    v_exp_f32 v174, v174
    v_exp_f32 v175, v175
    v_exp_f32 v176, v176
    v_exp_f32 v177, v177
    v_exp_f32 v178, v178
    v_exp_f32 v179, v179
    v_exp_f32 v180, v180
    v_exp_f32 v181, v181
    v_exp_f32 v182, v182
    v_exp_f32 v183, v183
    v_exp_f32 v184, v184
    v_exp_f32 v185, v185
    v_exp_f32 v186, v186
    v_exp_f32 v187, v187
    v_cvt_pk_bf16_f32 v120, v172, v173
    v_cvt_pk_bf16_f32 v121, v174, v175
    v_cvt_pk_bf16_f32 v122, v176, v177
    v_cvt_pk_bf16_f32 v123, v178, v179
    v_cvt_pk_bf16_f32 v124, v180, v181
    v_cvt_pk_bf16_f32 v125, v182, v183
    v_cvt_pk_bf16_f32 v126, v184, v185
    v_cvt_pk_bf16_f32 v127, v186, v187
    s_waitcnt lgkmcnt(0)
    v_mfma_f32_32x32x16_bf16 v[72:87], v[104:107], v[120:123], v[72:87]
    v_mfma_f32_32x32x16_bf16 v[72:87], v[108:111], v[124:127], v[72:87]
L58:
    s_cmp_gt_i32 s42, 7
    s_cbranch_scc1 L59
    v_sub_u32 v254, v63, v66
    ds_read_b64_tr_b16 v[104:105], v254 offset:0
    ds_read_b64_tr_b16 v[106:107], v254 offset:64
    ds_read_b64_tr_b16 v[108:109], v254 offset:256
    ds_read_b64_tr_b16 v[110:111], v254 offset:320
    v_mfma_f32_32x32x16_bf16 v[172:187], v[164:167], v[128:131], v[220:235]
    s_nop 11
    v_exp_f32 v172, v172
    v_exp_f32 v173, v173
    v_exp_f32 v174, v174
    v_exp_f32 v175, v175
    v_exp_f32 v176, v176
    v_exp_f32 v177, v177
    v_exp_f32 v178, v178
    v_exp_f32 v179, v179
    v_exp_f32 v180, v180
    v_exp_f32 v181, v181
    v_exp_f32 v182, v182
    v_exp_f32 v183, v183
    v_exp_f32 v184, v184
    v_exp_f32 v185, v185
    v_exp_f32 v186, v186
    v_exp_f32 v187, v187
    v_cvt_pk_bf16_f32 v120, v172, v173
    v_cvt_pk_bf16_f32 v121, v174, v175
    v_cvt_pk_bf16_f32 v122, v176, v177
    v_cvt_pk_bf16_f32 v123, v178, v179
    v_cvt_pk_bf16_f32 v124, v180, v181
    v_cvt_pk_bf16_f32 v125, v182, v183
    v_cvt_pk_bf16_f32 v126, v184, v185
    v_cvt_pk_bf16_f32 v127, v186, v187
    s_waitcnt lgkmcnt(0)
    v_mfma_f32_32x32x16_bf16 v[72:87], v[104:107], v[120:123], v[72:87]
    v_mfma_f32_32x32x16_bf16 v[72:87], v[108:111], v[124:127], v[72:87]
L59:
    s_nop 11
    v_rcp_f32 v254, v80
    s_nop 0
    v_mul_f32 v72, v254, v72
    v_mul_f32 v73, v254, v73
    v_mul_f32 v74, v254, v74
    v_mul_f32 v75, v254, v75
    v_mul_f32 v76, v254, v76
    v_mul_f32 v77, v254, v77
    v_mul_f32 v78, v254, v78
    v_mul_f32 v79, v254, v79
    v_cvt_pk_bf16_f32 v36, v72, v73
    v_cvt_pk_bf16_f32 v37, v74, v75
    v_cvt_pk_bf16_f32 v38, v76, v77
    v_cvt_pk_bf16_f32 v39, v78, v79
    s_cmp_lg_u32 s21, 0
    s_cbranch_scc1 L60
    buffer_store_dwordx4 v[36:39], v3, s[8:11], s37 offen offset:0
L61:
    v_add_u32 v13, 6, v9
    ds_write_b32 v0, v13
    s_add_u32 s40, s23, 1
    v_mov_b32 v13, s40
    s_waitcnt vmcnt(0)
    s_mov_b64 exec, 1
    s_cmp_lg_u32 s21, 0
    s_cbranch_scc1 L62
    buffer_store_dword v13, off, s[8:11], s24
L63:
    s_mov_b64 exec, -1
L_redo1:
    s_nop 15
    s_waitcnt vmcnt(0) lgkmcnt(0)
    ds_read_b128 v[136:139], v65 offset:24576
    ds_read_b128 v[140:143], v65 offset:25600
    ds_read_b128 v[144:147], v65 offset:26624
    ds_read_b128 v[148:151], v65 offset:27648
    ds_read_b128 v[152:155], v65 offset:28672
    ds_read_b128 v[156:159], v65 offset:29696
    ds_read_b128 v[160:163], v65 offset:30720
    ds_read_b128 v[164:167], v65 offset:31744
    ds_read_b128 v[168:171], v65 offset:32768
    s_waitcnt lgkmcnt(0)
    s_sub_i32 s42, 8, s27
    s_cmp_gt_i32 s42, 8
    s_cbranch_scc1 L64
    v_mfma_f32_32x32x16_bf16 v[172:187], v[168:171], v[132:135], 0
    s_nop 11
    v_cndmask_b32_e64 v172, v67, v172, s[64:65]
    v_cndmask_b32_e64 v173, v67, v173, s[66:67]
    v_cndmask_b32_e64 v174, v67, v174, s[68:69]
    v_cndmask_b32_e64 v175, v67, v175, s[70:71]
    v_cndmask_b32_e64 v176, v67, v176, s[72:73]
    v_cndmask_b32_e64 v177, v67, v177, s[74:75]
    v_cndmask_b32_e64 v178, v67, v178, s[76:77]
    v_cndmask_b32_e64 v179, v67, v179, s[78:79]
    v_cndmask_b32_e64 v180, v67, v180, s[80:81]
    v_cndmask_b32_e64 v181, v67, v181, s[82:83]
    v_cndmask_b32_e64 v182, v67, v182, s[84:85]
    v_cndmask_b32_e64 v183, v67, v183, s[86:87]
    v_cndmask_b32_e64 v184, v67, v184, s[88:89]
    v_cndmask_b32_e64 v185, v67, v185, s[90:91]
    v_cndmask_b32_e64 v186, v67, v186, s[92:93]
    v_cndmask_b32_e64 v187, v67, v187, s[94:95]
    v_max3_f32 v252, v172, v173, v174
    v_max3_f32 v253, v175, v176, v177
    v_max3_f32 v252, v252, v178, v179
    v_max3_f32 v253, v253, v180, v181
    v_max3_f32 v252, v252, v182, v183
    v_max3_f32 v253, v253, v184, v185
    v_max3_f32 v252, v252, v186, v187
L64:
    s_cmp_gt_i32 s42, 0
    s_cbranch_scc1 L65
    v_mfma_f32_32x32x16_bf16 v[172:187], v[136:139], v[132:135], 0
    s_nop 11
    v_cndmask_b32_e64 v172, v172, v67, s[64:65]
    v_cndmask_b32_e64 v173, v173, v67, s[66:67]
    v_cndmask_b32_e64 v174, v174, v67, s[68:69]
    v_cndmask_b32_e64 v175, v175, v67, s[70:71]
    v_cndmask_b32_e64 v176, v176, v67, s[72:73]
    v_cndmask_b32_e64 v177, v177, v67, s[74:75]
    v_cndmask_b32_e64 v178, v178, v67, s[76:77]
    v_cndmask_b32_e64 v179, v179, v67, s[78:79]
    v_cndmask_b32_e64 v180, v180, v67, s[80:81]
    v_cndmask_b32_e64 v181, v181, v67, s[82:83]
    v_cndmask_b32_e64 v182, v182, v67, s[84:85]
    v_cndmask_b32_e64 v183, v183, v67, s[86:87]
    v_cndmask_b32_e64 v184, v184, v67, s[88:89]
    v_cndmask_b32_e64 v185, v185, v67, s[90:91]
    v_cndmask_b32_e64 v186, v186, v67, s[92:93]
    v_cndmask_b32_e64 v187, v187, v67, s[94:95]
    v_max3_f32 v252, v252, v172, v173
    v_max3_f32 v253, v253, v174, v175
    v_max3_f32 v252, v252, v176, v177
    v_max3_f32 v253, v253, v178, v179
    v_max3_f32 v252, v252, v180, v181
    v_max3_f32 v253, v253, v182, v183
    v_max3_f32 v252, v252, v184, v185
    v_max3_f32 v253, v253, v186, v187
L65:
    s_cmp_gt_i32 s42, 1
    s_cbranch_scc1 L66
    v_mfma_f32_32x32x16_bf16 v[172:187], v[140:143], v[132:135], 0
    s_nop 11
    v_max3_f32 v252, v252, v172, v173
    v_max3_f32 v253, v253, v174, v175
    v_max3_f32 v252, v252, v176, v177
    v_max3_f32 v253, v253, v178, v179
    v_max3_f32 v252, v252, v180, v181
    v_max3_f32 v253, v253, v182, v183
    v_max3_f32 v252, v252, v184, v185
    v_max3_f32 v253, v253, v186, v187
L66:
    s_cmp_gt_i32 s42, 2
    s_cbranch_scc1 L67
    v_mfma_f32_32x32x16_bf16 v[172:187], v[144:147], v[132:135], 0
    s_nop 11
    v_max3_f32 v252, v252, v172, v173
    v_max3_f32 v253, v253, v174, v175
    v_max3_f32 v252, v252, v176, v177
    v_max3_f32 v253, v253, v178, v179
    v_max3_f32 v252, v252, v180, v181
    v_max3_f32 v253, v253, v182, v183
    v_max3_f32 v252, v252, v184, v185
    v_max3_f32 v253, v253, v186, v187
L67:
    s_cmp_gt_i32 s42, 3
    s_cbranch_scc1 L68
    v_mfma_f32_32x32x16_bf16 v[172:187], v[148:151], v[132:135], 0
    s_nop 11
    v_max3_f32 v252, v252, v172, v173
    v_max3_f32 v253, v253, v174, v175
    v_max3_f32 v252, v252, v176, v177
    v_max3_f32 v253, v253, v178, v179
    v_max3_f32 v252, v252, v180, v181
    v_max3_f32 v253, v253, v182, v183
    v_max3_f32 v252, v252, v184, v185
    v_max3_f32 v253, v253, v186, v187
L68:
    s_cmp_gt_i32 s42, 4
    s_cbranch_scc1 L69
    v_mfma_f32_32x32x16_bf16 v[172:187], v[152:155], v[132:135], 0
    s_nop 11
    v_max3_f32 v252, v252, v172, v173
    v_max3_f32 v253, v253, v174, v175
    v_max3_f32 v252, v252, v176, v177
    v_max3_f32 v253, v253, v178, v179
    v_max3_f32 v252, v252, v180, v181
    v_max3_f32 v253, v253, v182, v183
    v_max3_f32 v252, v252, v184, v185
    v_max3_f32 v253, v253, v186, v187
L69:
    s_cmp_gt_i32 s42, 5
    s_cbranch_scc1 L70
    v_mfma_f32_32x32x16_bf16 v[172:187], v[156:159], v[132:135], 0
    s_nop 11
    v_max3_f32 v252, v252, v172, v173
    v_max3_f32 v253, v253, v174, v175
    v_max3_f32 v252, v252, v176, v177
    v_max3_f32 v253, v253, v178, v179
    v_max3_f32 v252, v252, v180, v181
    v_max3_f32 v253, v253, v182, v183
    v_max3_f32 v252, v252, v184, v185
    v_max3_f32 v253, v253, v186, v187
L70:
    s_cmp_gt_i32 s42, 6
    s_cbranch_scc1 L71
    v_mfma_f32_32x32x16_bf16 v[172:187], v[160:163], v[132:135], 0
    s_nop 11
    v_max3_f32 v252, v252, v172, v173
    v_max3_f32 v253, v253, v174, v175
    v_max3_f32 v252, v252, v176, v177
    v_max3_f32 v253, v253, v178, v179
    v_max3_f32 v252, v252, v180, v181
    v_max3_f32 v253, v253, v182, v183
    v_max3_f32 v252, v252, v184, v185
    v_max3_f32 v253, v253, v186, v187
L71:
    s_cmp_gt_i32 s42, 7
    s_cbranch_scc1 L72
    v_mfma_f32_32x32x16_bf16 v[172:187], v[164:167], v[132:135], 0
    s_nop 11
    v_max3_f32 v252, v252, v172, v173
    v_max3_f32 v253, v253, v174, v175
    v_max3_f32 v252, v252, v176, v177
    v_max3_f32 v253, v253, v178, v179
    v_max3_f32 v252, v252, v180, v181
    v_max3_f32 v253, v253, v182, v183
    v_max3_f32 v252, v252, v184, v185
    v_max3_f32 v253, v253, v186, v187
L72:
    v_max_f32 v252, v252, v253
    v_mov_b32 v253, v252
    s_nop 1
    v_permlane32_swap_b32 v252, v253
    s_nop 1
    v_max_f32 v252, v252, v253
    v_sub_f32 v236, 0, v252
    v_sub_f32 v237, 0, v252
    v_sub_f32 v238, 0, v252
    v_sub_f32 v239, 0, v252
    v_sub_f32 v240, 0, v252
    v_sub_f32 v241, 0, v252
    v_sub_f32 v242, 0, v252
    v_sub_f32 v243, 0, v252
    v_sub_f32 v244, 0, v252
    v_sub_f32 v245, 0, v252
    v_sub_f32 v246, 0, v252
    v_sub_f32 v247, 0, v252
    v_sub_f32 v248, 0, v252
    v_sub_f32 v249, 0, v252
    v_sub_f32 v250, 0, v252
    v_sub_f32 v251, 0, v252
    s_cmp_gt_i32 s42, 8
    s_cbranch_scc1 L73
    ds_read_b64_tr_b16 v[104:105], v64 offset:0
    ds_read_b64_tr_b16 v[106:107], v64 offset:64
    ds_read_b64_tr_b16 v[108:109], v64 offset:256
    ds_read_b64_tr_b16 v[110:111], v64 offset:320
    v_mfma_f32_32x32x16_bf16 v[172:187], v[168:171], v[132:135], v[236:251]
    s_nop 11
    v_cndmask_b32_e64 v172, v67, v172, s[64:65]
    v_cndmask_b32_e64 v173, v67, v173, s[66:67]
    v_cndmask_b32_e64 v174, v67, v174, s[68:69]
    v_cndmask_b32_e64 v175, v67, v175, s[70:71]
    v_cndmask_b32_e64 v176, v67, v176, s[72:73]
    v_cndmask_b32_e64 v177, v67, v177, s[74:75]
    v_cndmask_b32_e64 v178, v67, v178, s[76:77]
    v_cndmask_b32_e64 v179, v67, v179, s[78:79]
    v_cndmask_b32_e64 v180, v67, v180, s[80:81]
    v_cndmask_b32_e64 v181, v67, v181, s[82:83]
    v_cndmask_b32_e64 v182, v67, v182, s[84:85]
    v_cndmask_b32_e64 v183, v67, v183, s[86:87]
    v_cndmask_b32_e64 v184, v67, v184, s[88:89]
    v_cndmask_b32_e64 v185, v67, v185, s[90:91]
    v_cndmask_b32_e64 v186, v67, v186, s[92:93]
    v_cndmask_b32_e64 v187, v67, v187, s[94:95]
    v_exp_f32 v172, v172
    v_exp_f32 v173, v173
    v_exp_f32 v174, v174
    v_exp_f32 v175, v175
    v_exp_f32 v176, v176
    v_exp_f32 v177, v177
    v_exp_f32 v178, v178
    v_exp_f32 v179, v179
    v_exp_f32 v180, v180
    v_exp_f32 v181, v181
    v_exp_f32 v182, v182
    v_exp_f32 v183, v183
    v_exp_f32 v184, v184
    v_exp_f32 v185, v185
    v_exp_f32 v186, v186
    v_exp_f32 v187, v187
    v_cvt_pk_bf16_f32 v120, v172, v173
    v_cvt_pk_bf16_f32 v121, v174, v175
    v_cvt_pk_bf16_f32 v122, v176, v177
    v_cvt_pk_bf16_f32 v123, v178, v179
    v_cvt_pk_bf16_f32 v124, v180, v181
    v_cvt_pk_bf16_f32 v125, v182, v183
    v_cvt_pk_bf16_f32 v126, v184, v185
    v_cvt_pk_bf16_f32 v127, v186, v187
    s_waitcnt lgkmcnt(0)
    v_mfma_f32_32x32x16_bf16 v[88:103], v[104:107], v[120:123], 0
    v_mfma_f32_32x32x16_bf16 v[88:103], v[108:111], v[124:127], v[88:103]
L73:
    s_cmp_gt_i32 s42, 0
    s_cbranch_scc1 L74
    ds_read_b64_tr_b16 v[104:105], v56 offset:0
    ds_read_b64_tr_b16 v[106:107], v56 offset:64
    ds_read_b64_tr_b16 v[108:109], v56 offset:256
    ds_read_b64_tr_b16 v[110:111], v56 offset:320
    v_mfma_f32_32x32x16_bf16 v[172:187], v[136:139], v[132:135], v[236:251]
    s_nop 11
    v_cndmask_b32_e64 v172, v172, v67, s[64:65]
    v_cndmask_b32_e64 v173, v173, v67, s[66:67]
    v_cndmask_b32_e64 v174, v174, v67, s[68:69]
    v_cndmask_b32_e64 v175, v175, v67, s[70:71]
    v_cndmask_b32_e64 v176, v176, v67, s[72:73]
    v_cndmask_b32_e64 v177, v177, v67, s[74:75]
    v_cndmask_b32_e64 v178, v178, v67, s[76:77]
    v_cndmask_b32_e64 v179, v179, v67, s[78:79]
    v_cndmask_b32_e64 v180, v180, v67, s[80:81]
    v_cndmask_b32_e64 v181, v181, v67, s[82:83]
    v_cndmask_b32_e64 v182, v182, v67, s[84:85]
    v_cndmask_b32_e64 v183, v183, v67, s[86:87]
    v_cndmask_b32_e64 v184, v184, v67, s[88:89]
    v_cndmask_b32_e64 v185, v185, v67, s[90:91]
    v_cndmask_b32_e64 v186, v186, v67, s[92:93]
    v_cndmask_b32_e64 v187, v187, v67, s[94:95]
    v_exp_f32 v172, v172
    v_exp_f32 v173, v173
    v_exp_f32 v174, v174
    v_exp_f32 v175, v175
    v_exp_f32 v176, v176
    v_exp_f32 v177, v177
    v_exp_f32 v178, v178
    v_exp_f32 v179, v179
    v_exp_f32 v180, v180
    v_exp_f32 v181, v181
    v_exp_f32 v182, v182
    v_exp_f32 v183, v183
    v_exp_f32 v184, v184
    v_exp_f32 v185, v185
    v_exp_f32 v186, v186
    v_exp_f32 v187, v187
    v_cvt_pk_bf16_f32 v120, v172, v173
    v_cvt_pk_bf16_f32 v121, v174, v175
    v_cvt_pk_bf16_f32 v122, v176, v177
    v_cvt_pk_bf16_f32 v123, v178, v179
    v_cvt_pk_bf16_f32 v124, v180, v181
    v_cvt_pk_bf16_f32 v125, v182, v183
    v_cvt_pk_bf16_f32 v126, v184, v185
    v_cvt_pk_bf16_f32 v127, v186, v187
    s_waitcnt lgkmcnt(0)
    v_mfma_f32_32x32x16_bf16 v[88:103], v[104:107], v[120:123], v[88:103]
    v_mfma_f32_32x32x16_bf16 v[88:103], v[108:111], v[124:127], v[88:103]
L74:
    s_cmp_gt_i32 s42, 1
    s_cbranch_scc1 L75
    ds_read_b64_tr_b16 v[104:105], v57 offset:0
    ds_read_b64_tr_b16 v[106:107], v57 offset:64
    ds_read_b64_tr_b16 v[108:109], v57 offset:256
    ds_read_b64_tr_b16 v[110:111], v57 offset:320
    v_mfma_f32_32x32x16_bf16 v[172:187], v[140:143], v[132:135], v[236:251]
    s_nop 11
    v_exp_f32 v172, v172
    v_exp_f32 v173, v173
    v_exp_f32 v174, v174
    v_exp_f32 v175, v175
    v_exp_f32 v176, v176
    v_exp_f32 v177, v177
    v_exp_f32 v178, v178
    v_exp_f32 v179, v179
    v_exp_f32 v180, v180
    v_exp_f32 v181, v181
    v_exp_f32 v182, v182
    v_exp_f32 v183, v183
    v_exp_f32 v184, v184
    v_exp_f32 v185, v185
    v_exp_f32 v186, v186
    v_exp_f32 v187, v187
    v_cvt_pk_bf16_f32 v120, v172, v173
    v_cvt_pk_bf16_f32 v121, v174, v175
    v_cvt_pk_bf16_f32 v122, v176, v177
    v_cvt_pk_bf16_f32 v123, v178, v179
    v_cvt_pk_bf16_f32 v124, v180, v181
    v_cvt_pk_bf16_f32 v125, v182, v183
    v_cvt_pk_bf16_f32 v126, v184, v185
    v_cvt_pk_bf16_f32 v127, v186, v187
    s_waitcnt lgkmcnt(0)
    v_mfma_f32_32x32x16_bf16 v[88:103], v[104:107], v[120:123], v[88:103]
    v_mfma_f32_32x32x16_bf16 v[88:103], v[108:111], v[124:127], v[88:103]
L75:
    s_cmp_gt_i32 s42, 2
    s_cbranch_scc1 L76
    ds_read_b64_tr_b16 v[104:105], v58 offset:0
    ds_read_b64_tr_b16 v[106:107], v58 offset:64
    ds_read_b64_tr_b16 v[108:109], v58 offset:256
    ds_read_b64_tr_b16 v[110:111], v58 offset:320
    v_mfma_f32_32x32x16_bf16 v[172:187], v[144:147], v[132:135], v[236:251]
    s_nop 11
    v_exp_f32 v172, v172
    v_exp_f32 v173, v173
    v_exp_f32 v174, v174
    v_exp_f32 v175, v175
    v_exp_f32 v176, v176
    v_exp_f32 v177, v177
    v_exp_f32 v178, v178
    v_exp_f32 v179, v179
    v_exp_f32 v180, v180
    v_exp_f32 v181, v181
    v_exp_f32 v182, v182
    v_exp_f32 v183, v183
    v_exp_f32 v184, v184
    v_exp_f32 v185, v185
    v_exp_f32 v186, v186
    v_exp_f32 v187, v187
    v_cvt_pk_bf16_f32 v120, v172, v173
    v_cvt_pk_bf16_f32 v121, v174, v175
    v_cvt_pk_bf16_f32 v122, v176, v177
    v_cvt_pk_bf16_f32 v123, v178, v179
    v_cvt_pk_bf16_f32 v124, v180, v181
    v_cvt_pk_bf16_f32 v125, v182, v183
    v_cvt_pk_bf16_f32 v126, v184, v185
    v_cvt_pk_bf16_f32 v127, v186, v187
    s_waitcnt lgkmcnt(0)
    v_mfma_f32_32x32x16_bf16 v[88:103], v[104:107], v[120:123], v[88:103]
    v_mfma_f32_32x32x16_bf16 v[88:103], v[108:111], v[124:127], v[88:103]
L76:
    s_cmp_gt_i32 s42, 3
    s_cbranch_scc1 L77
    ds_read_b64_tr_b16 v[104:105], v59 offset:0
    ds_read_b64_tr_b16 v[106:107], v59 offset:64
    ds_read_b64_tr_b16 v[108:109], v59 offset:256
    ds_read_b64_tr_b16 v[110:111], v59 offset:320
    v_mfma_f32_32x32x16_bf16 v[172:187], v[148:151], v[132:135], v[236:251]
    s_nop 11
    v_exp_f32 v172, v172
    v_exp_f32 v173, v173
    v_exp_f32 v174, v174
    v_exp_f32 v175, v175
    v_exp_f32 v176, v176
    v_exp_f32 v177, v177
    v_exp_f32 v178, v178
    v_exp_f32 v179, v179
    v_exp_f32 v180, v180
    v_exp_f32 v181, v181
    v_exp_f32 v182, v182
    v_exp_f32 v183, v183
    v_exp_f32 v184, v184
    v_exp_f32 v185, v185
    v_exp_f32 v186, v186
    v_exp_f32 v187, v187
    v_cvt_pk_bf16_f32 v120, v172, v173
    v_cvt_pk_bf16_f32 v121, v174, v175
    v_cvt_pk_bf16_f32 v122, v176, v177
    v_cvt_pk_bf16_f32 v123, v178, v179
    v_cvt_pk_bf16_f32 v124, v180, v181
    v_cvt_pk_bf16_f32 v125, v182, v183
    v_cvt_pk_bf16_f32 v126, v184, v185
    v_cvt_pk_bf16_f32 v127, v186, v187
    s_waitcnt lgkmcnt(0)
    v_mfma_f32_32x32x16_bf16 v[88:103], v[104:107], v[120:123], v[88:103]
    v_mfma_f32_32x32x16_bf16 v[88:103], v[108:111], v[124:127], v[88:103]
L77:
    s_cmp_gt_i32 s42, 4
    s_cbranch_scc1 L78
    ds_read_b64_tr_b16 v[104:105], v60 offset:0
    ds_read_b64_tr_b16 v[106:107], v60 offset:64
    ds_read_b64_tr_b16 v[108:109], v60 offset:256
    ds_read_b64_tr_b16 v[110:111], v60 offset:320
    v_mfma_f32_32x32x16_bf16 v[172:187], v[152:155], v[132:135], v[236:251]
    s_nop 11
    v_exp_f32 v172, v172
    v_exp_f32 v173, v173
    v_exp_f32 v174, v174
    v_exp_f32 v175, v175
    v_exp_f32 v176, v176
    v_exp_f32 v177, v177
    v_exp_f32 v178, v178
    v_exp_f32 v179, v179
    v_exp_f32 v180, v180
    v_exp_f32 v181, v181
    v_exp_f32 v182, v182
    v_exp_f32 v183, v183
    v_exp_f32 v184, v184
    v_exp_f32 v185, v185
    v_exp_f32 v186, v186
    v_exp_f32 v187, v187
    v_cvt_pk_bf16_f32 v120, v172, v173
    v_cvt_pk_bf16_f32 v121, v174, v175
    v_cvt_pk_bf16_f32 v122, v176, v177
    v_cvt_pk_bf16_f32 v123, v178, v179
    v_cvt_pk_bf16_f32 v124, v180, v181
    v_cvt_pk_bf16_f32 v125, v182, v183
    v_cvt_pk_bf16_f32 v126, v184, v185
    v_cvt_pk_bf16_f32 v127, v186, v187
    s_waitcnt lgkmcnt(0)
    v_mfma_f32_32x32x16_bf16 v[88:103], v[104:107], v[120:123], v[88:103]
    v_mfma_f32_32x32x16_bf16 v[88:103], v[108:111], v[124:127], v[88:103]
L78:
    s_cmp_gt_i32 s42, 5
    s_cbranch_scc1 L79
    ds_read_b64_tr_b16 v[104:105], v61 offset:0
    ds_read_b64_tr_b16 v[106:107], v61 offset:64
    ds_read_b64_tr_b16 v[108:109], v61 offset:256
    ds_read_b64_tr_b16 v[110:111], v61 offset:320
    v_mfma_f32_32x32x16_bf16 v[172:187], v[156:159], v[132:135], v[236:251]
    s_nop 11
    v_exp_f32 v172, v172
    v_exp_f32 v173, v173
    v_exp_f32 v174, v174
    v_exp_f32 v175, v175
    v_exp_f32 v176, v176
    v_exp_f32 v177, v177
    v_exp_f32 v178, v178
    v_exp_f32 v179, v179
    v_exp_f32 v180, v180
    v_exp_f32 v181, v181
    v_exp_f32 v182, v182
    v_exp_f32 v183, v183
    v_exp_f32 v184, v184
    v_exp_f32 v185, v185
    v_exp_f32 v186, v186
    v_exp_f32 v187, v187
    v_cvt_pk_bf16_f32 v120, v172, v173
    v_cvt_pk_bf16_f32 v121, v174, v175
    v_cvt_pk_bf16_f32 v122, v176, v177
    v_cvt_pk_bf16_f32 v123, v178, v179
    v_cvt_pk_bf16_f32 v124, v180, v181
    v_cvt_pk_bf16_f32 v125, v182, v183
    v_cvt_pk_bf16_f32 v126, v184, v185
    v_cvt_pk_bf16_f32 v127, v186, v187
    s_waitcnt lgkmcnt(0)
    v_mfma_f32_32x32x16_bf16 v[88:103], v[104:107], v[120:123], v[88:103]
    v_mfma_f32_32x32x16_bf16 v[88:103], v[108:111], v[124:127], v[88:103]
L79:
    s_cmp_gt_i32 s42, 6
    s_cbranch_scc1 L80
    ds_read_b64_tr_b16 v[104:105], v62 offset:0
    ds_read_b64_tr_b16 v[106:107], v62 offset:64
    ds_read_b64_tr_b16 v[108:109], v62 offset:256
    ds_read_b64_tr_b16 v[110:111], v62 offset:320
    v_mfma_f32_32x32x16_bf16 v[172:187], v[160:163], v[132:135], v[236:251]
    s_nop 11
    v_exp_f32 v172, v172
    v_exp_f32 v173, v173
    v_exp_f32 v174, v174
    v_exp_f32 v175, v175
    v_exp_f32 v176, v176
    v_exp_f32 v177, v177
    v_exp_f32 v178, v178
    v_exp_f32 v179, v179
    v_exp_f32 v180, v180
    v_exp_f32 v181, v181
    v_exp_f32 v182, v182
    v_exp_f32 v183, v183
    v_exp_f32 v184, v184
    v_exp_f32 v185, v185
    v_exp_f32 v186, v186
    v_exp_f32 v187, v187
    v_cvt_pk_bf16_f32 v120, v172, v173
    v_cvt_pk_bf16_f32 v121, v174, v175
    v_cvt_pk_bf16_f32 v122, v176, v177
    v_cvt_pk_bf16_f32 v123, v178, v179
    v_cvt_pk_bf16_f32 v124, v180, v181
    v_cvt_pk_bf16_f32 v125, v182, v183
    v_cvt_pk_bf16_f32 v126, v184, v185
    v_cvt_pk_bf16_f32 v127, v186, v187
    s_waitcnt lgkmcnt(0)
    v_mfma_f32_32x32x16_bf16 v[88:103], v[104:107], v[120:123], v[88:103]
    v_mfma_f32_32x32x16_bf16 v[88:103], v[108:111], v[124:127], v[88:103]
L80:
    s_cmp_gt_i32 s42, 7
    s_cbranch_scc1 L81
    ds_read_b64_tr_b16 v[104:105], v63 offset:0
    ds_read_b64_tr_b16 v[106:107], v63 offset:64
    ds_read_b64_tr_b16 v[108:109], v63 offset:256
    ds_read_b64_tr_b16 v[110:111], v63 offset:320
    v_mfma_f32_32x32x16_bf16 v[172:187], v[164:167], v[132:135], v[236:251]
    s_nop 11
    v_exp_f32 v172, v172
    v_exp_f32 v173, v173
    v_exp_f32 v174, v174
    v_exp_f32 v175, v175
    v_exp_f32 v176, v176
    v_exp_f32 v177, v177
    v_exp_f32 v178, v178
    v_exp_f32 v179, v179
    v_exp_f32 v180, v180
    v_exp_f32 v181, v181
    v_exp_f32 v182, v182
    v_exp_f32 v183, v183
    v_exp_f32 v184, v184
    v_exp_f32 v185, v185
    v_exp_f32 v186, v186
    v_exp_f32 v187, v187
    v_cvt_pk_bf16_f32 v120, v172, v173
    v_cvt_pk_bf16_f32 v121, v174, v175
    v_cvt_pk_bf16_f32 v122, v176, v177
    v_cvt_pk_bf16_f32 v123, v178, v179
    v_cvt_pk_bf16_f32 v124, v180, v181
    v_cvt_pk_bf16_f32 v125, v182, v183
    v_cvt_pk_bf16_f32 v126, v184, v185
    v_cvt_pk_bf16_f32 v127, v186, v187
    s_waitcnt lgkmcnt(0)
    v_mfma_f32_32x32x16_bf16 v[88:103], v[104:107], v[120:123], v[88:103]
    v_mfma_f32_32x32x16_bf16 v[88:103], v[108:111], v[124:127], v[88:103]
L81:
    s_nop 11
    v_rcp_f32 v254, v96
    s_nop 0
    v_mul_f32 v88, v254, v88
    v_mul_f32 v89, v254, v89
    v_mul_f32 v90, v254, v90
    v_mul_f32 v91, v254, v91
    v_mul_f32 v92, v254, v92
    v_mul_f32 v93, v254, v93
    v_mul_f32 v94, v254, v94
    v_mul_f32 v95, v254, v95
    v_cvt_pk_bf16_f32 v36, v88, v89
    v_cvt_pk_bf16_f32 v37, v90, v91
    v_cvt_pk_bf16_f32 v38, v92, v93
    v_cvt_pk_bf16_f32 v39, v94, v95
    s_cmp_lg_u32 s21, 0
    s_cbranch_scc1 L82
    buffer_store_dwordx4 v[36:39], v3, s[8:11], s37 offen offset:1024
L83:
    v_add_u32 v13, 7, v9
    ds_write_b32 v0, v13
    s_waitcnt vmcnt(0)
    s_branch L_att_late
L93:
    buffer_store_dwordx4 v[24:27], v3, s[8:11], s58 offen sc1
    s_branch L94
L95:
    buffer_store_dwordx4 v[28:31], v3, s[8:11], s58 offen offset:1024 sc1
    s_branch L96
L97:
    buffer_store_dword v56, v3, s[8:11], s59 offen sc1
    s_branch L98
L99:
    buffer_store_dword v13, off, s[8:11], s24 sc1
    s_branch L100
L122:
    buffer_store_dword v13, off, s[8:11], s24 sc1
    s_branch L123
L137:
    buffer_store_dword v13, off, s[8:11], s24 sc1
    s_branch L138
L154:
    buffer_store_dwordx4 v[24:27], v3, s[8:11], s58 offen sc1
    s_branch L155
L156:
    buffer_store_dwordx4 v[28:31], v3, s[8:11], s58 offen offset:1024 sc1
    s_branch L157
L158:
    buffer_store_dword v56, v3, s[8:11], s59 offen sc1
    s_branch L159
L160:
    buffer_store_dword v13, off, s[8:11], s24 sc1
    s_branch L161
L_code_end:
    s_endpgm

.section .rodata,"a"
.p2align 6
.amdhsa_kernel interleave_layers__sliding_block__glu_gated_glu__prompt_kernel
  .amdhsa_next_free_vgpr 256
  .amdhsa_next_free_sgpr 102
  .amdhsa_accum_offset 256
  .amdhsa_group_segment_fixed_size 0
  .amdhsa_kernarg_size 80
  .amdhsa_user_sgpr_count 2
  .amdhsa_user_sgpr_kernarg_segment_ptr 1
  .amdhsa_system_sgpr_workgroup_id_x 1
.end_amdhsa_kernel
```
